```python
import torch

def _softmax(x, axis=-1):
    return torch.softmax(x, dim=axis)
def _gelu(x):
    return torch.nn.functional.gelu(x, approximate="tanh")
def _silu(x):
    return torch.nn.functional.silu(x)
def _sigmoid(x):
    return torch.sigmoid(x)
def _layernorm(x, axis=-1, eps=1e-5):
    m = x.mean(dim=axis, keepdim=True)
    v = x.var(dim=axis, keepdim=True, unbiased=False)
    return (x - m) / torch.sqrt(v + eps)
def _scatter_add(tgt, idx, src, axis=0):
    return tgt.clone().index_add_(axis, idx, src)
def _segment_sum(src, seg, n):
    out = torch.zeros((n,) + src.shape[1:], dtype=src.dtype)
    return out.index_add_(0, seg, src)
def _pad(x, pw):
    flat = tuple(v for pair in reversed(pw) for v in pair)
    return torch.nn.functional.pad(x, flat)

kernel_name = 'parallel_sum__softmax_full_mha__dense_activation_silu__prompt'

def setup_inputs():

    _w = (lambda a: (lambda t: t.to(torch.bfloat16) if t.is_floating_point() else t)(torch.as_tensor(a)))
    def _A_setup():
        B, S, D = 1, 2048, 640
        return {
            "x": _w((lambda *s: torch.randn(*s, dtype=torch.bfloat16) * 0.05)(B, S, D)),
            "wqkv": _w((lambda *s: torch.randn(*s, dtype=torch.bfloat16) * 0.05)(D, 3 * D)),
            "wo": _w((lambda *s: torch.randn(*s, dtype=torch.bfloat16) * 0.05)(D, D)),
        }
    _A_in = _A_setup()

    def _B_setup():
        B, S, D, F = 1, 2048, 640, 1728
        return {
            "x": _w((lambda *s: torch.randn(*s, dtype=torch.bfloat16) * 0.05)(B, S, D)),
            "w1": _w((lambda *s: torch.randn(*s, dtype=torch.bfloat16) * 1.6)(D, F) * (D ** -0.5)),
            "w2": _w((lambda *s: torch.randn(*s, dtype=torch.bfloat16) * 0.2)(F, D) * (F ** -0.5)),
        }
    _B_in = _B_setup()

    return {
        "A_x": _A_in["x"],
        "A_wqkv": _A_in["wqkv"],
        "A_wo": _A_in["wo"],
        "B_x": _B_in["x"],
        "B_w1": _B_in["w1"],
        "B_w2": _B_in["w2"],
    }

def reference(A_x, A_wqkv, A_wo, B_x, B_w1, B_w2):
    def _A_ref(x, wqkv, wo):
        B, S, D = x.shape
        H = 32; Dh = D // H
        qkv = (lambda x, *d: x.permute(*d))((x @ wqkv).reshape(B, S, 3, H, Dh), 2, 0, 3, 1, 4)
        q, k, v = qkv[0], qkv[1], qkv[2]
        scale = Dh ** -0.5
        scores = torch.einsum("bhqd,bhkd->bhqk", q, k) * scale
        p = _softmax(scores, axis=-1)
        o = torch.einsum("bhqk,bhkd->bhqd", p, v)
        return (lambda x, *d: x.permute(*d))(o, 0, 2, 1, 3).reshape(B, S, D) @ wo

    def _B_ref(x, w1, w2):
        h = torch.einsum("bsd,df->bsf", x, w1)
        h = _silu(h)
        out = torch.einsum("bsf,fd->bsd", h, w2)
        return out

    x = A_x
    xn = _layernorm(x, axis=-1)
    return x + _A_ref(xn, A_wqkv, A_wo) + _B_ref(xn, B_w1, B_w2)
```

```asm
; @launch grid=(256,1,1) block=(768,1,1) lds=163840
.amdgcn_target "amdgcn-amd-amdhsa--gfx950"
.text
.globl parallel_sum__softmax_full_mha__dense_activation_silu__prompt_kernel
.p2align 8
.type parallel_sum__softmax_full_mha__dense_activation_silu__prompt_kernel,@function
parallel_sum__softmax_full_mha__dense_activation_silu__prompt_kernel:
    s_cmp_ge_u32 s2, 256
    s_cbranch_scc1 L_f_exit_1
    s_load_dwordx4 s[48:51], s[0:1], 0
    s_load_dwordx4 s[56:59], s[0:1], 32
    s_load_dwordx2 s[8:9], s[0:1], 64
    s_load_dwordx2 s[52:53], s[0:1], 16
    s_load_dwordx2 s[54:55], s[0:1], 48
    v_and_b32 v1, 63, v0
    v_lshrrev_b32 v2, 6, v0
    s_mov_b32 s10, 268435456
    v_readfirstlane_b32 s12, v2
    s_mov_b32 s11, 0x00020000
    s_lshl_b32 s60, s2, 5
    s_add_u32 s60, s60, s12
    s_lshl_b32 s60, s60, 2
    s_add_u32 s60, s60, 28622848
    s_mov_b32 s61, 0
    s_cmp_ge_u32 s12, 8
    s_cbranch_scc1 L_f_loader_4
    v_mov_b32 v144, 0
    v_mov_b32 v145, 0
    v_mov_b32 v146, 0
    v_mov_b32 v147, 0
    v_mov_b32 v148, 0
    v_mov_b32 v149, 0
    v_mov_b32 v150, 0
    v_mov_b32 v151, 0
    v_lshlrev_b32 v152, 4, v1
    s_and_b32 s3, s2, 7
    s_lshr_b32 s4, s2, 3
    s_cmp_ge_u32 s4, 30
    s_cbranch_scc0 L_f_gemm_12
    s_lshl_b32 s3, s3, 1
    s_add_u32 s3, s3, s4
    s_sub_u32 s3, s3, 30
    s_branch L_f_spare_11
L_f_gemm_12:
    s_mul_i32 s3, s3, 30
    s_add_u32 s3, s3, s4
    s_cmp_ge_u32 s3, 120
    s_cselect_b32 s4, 120, 0
    s_cselect_b32 s5, 8, 0
    s_sub_u32 s3, s3, s4
    s_lshr_b32 s25, s3, 3
    s_and_b32 s3, s3, 7
    s_add_u32 s24, s3, s5
    s_mul_i32 s4, s25, 5
    s_add_u32 s3, s24, s4
    s_and_b32 s3, s3, 15
    s_mul_i32 s4, s3, 5
    s_lshr_b32 s4, s4, 1
    s_lshr_b32 s30, s4, 2
    s_and_b32 s4, s4, 3
    s_and_b32 s3, s3, 1
    s_lshl_b32 s3, s3, 2
    s_or_b32 s3, s3, 3
    s_lshl_b32 s37, s3, s4
    s_lshl_b32 s40, s24, 4
    s_add_u32 s40, s40, s25
    s_lshl_b32 s40, s40, 3
    s_add_u32 s40, s40, s12
    s_mul_i32 s31, s40, 1280
    s_lshl_b32 s40, s40, 4
    s_add_u32 s44, s40, 28459008
    s_waitcnt lgkmcnt(0)
    s_mov_b32 s16, s48
    s_mov_b32 s17, s49
    s_mov_b32 s18, 2621440
    s_mov_b32 s19, 0x00020000
    s_mov_b32 exec_hi, 0xff
    buffer_load_dwordx4 v[144:147], v152, s[16:19], s31 offen
    buffer_load_dwordx4 v[148:151], v152, s[16:19], s31 offen offset:640
    s_mov_b64 exec, -1
    s_add_u32 s6, s8, 28590080
    s_addc_u32 s7, s9, 0
    s_load_dword s13, s[6:7], 0
    s_waitcnt lgkmcnt(0)
    s_mul_i32 s13, s13, 1664525
    s_add_u32 s13, s13, 1013904223
    v_mov_b32 v2, 163832
    v_mov_b32 v3, s13
    ds_write_b32 v2, v3
    s_mov_b32 s42, 0x3f803f80
    v_mov_b32 v24, 0
    v_mov_b32 v25, 0
    s_waitcnt vmcnt(0)
    v_lshlrev_b32 v26, 16, v144
    v_and_b32 v27, 0xffff0000, v144
    v_add_f32 v24, v24, v26
    v_fmac_f32 v25, v26, v26
    v_add_f32 v24, v24, v27
    v_fmac_f32 v25, v27, v27
    v_lshlrev_b32 v26, 16, v145
    v_and_b32 v27, 0xffff0000, v145
    v_add_f32 v24, v24, v26
    v_fmac_f32 v25, v26, v26
    v_add_f32 v24, v24, v27
    v_fmac_f32 v25, v27, v27
    v_lshlrev_b32 v26, 16, v146
    v_and_b32 v27, 0xffff0000, v146
    v_add_f32 v24, v24, v26
    v_fmac_f32 v25, v26, v26
    v_add_f32 v24, v24, v27
    v_fmac_f32 v25, v27, v27
    v_lshlrev_b32 v26, 16, v147
    v_and_b32 v27, 0xffff0000, v147
    v_add_f32 v24, v24, v26
    v_fmac_f32 v25, v26, v26
    v_add_f32 v24, v24, v27
    v_fmac_f32 v25, v27, v27
    v_lshlrev_b32 v26, 16, v148
    v_and_b32 v27, 0xffff0000, v148
    v_add_f32 v24, v24, v26
    v_fmac_f32 v25, v26, v26
    v_add_f32 v24, v24, v27
    v_fmac_f32 v25, v27, v27
    v_lshlrev_b32 v26, 16, v149
    v_and_b32 v27, 0xffff0000, v149
    v_add_f32 v24, v24, v26
    v_fmac_f32 v25, v26, v26
    v_add_f32 v24, v24, v27
    v_fmac_f32 v25, v27, v27
    v_lshlrev_b32 v26, 16, v150
    v_and_b32 v27, 0xffff0000, v150
    v_add_f32 v24, v24, v26
    v_fmac_f32 v25, v26, v26
    v_add_f32 v24, v24, v27
    v_fmac_f32 v25, v27, v27
    v_lshlrev_b32 v26, 16, v151
    v_and_b32 v27, 0xffff0000, v151
    v_add_f32 v24, v24, v26
    v_fmac_f32 v25, v26, v26
    v_add_f32 v24, v24, v27
    v_fmac_f32 v25, v27, v27
    s_nop 0
    v_add_f32_dpp v24, v24, v24 row_ror:8 row_mask:0xf bank_mask:0xf
    v_add_f32_dpp v25, v25, v25 row_ror:8 row_mask:0xf bank_mask:0xf
    s_nop 0
    v_add_f32_dpp v24, v24, v24 row_ror:4 row_mask:0xf bank_mask:0xf
    v_add_f32_dpp v25, v25, v25 row_ror:4 row_mask:0xf bank_mask:0xf
    s_nop 0
    v_add_f32_dpp v24, v24, v24 row_ror:2 row_mask:0xf bank_mask:0xf
    v_add_f32_dpp v25, v25, v25 row_ror:2 row_mask:0xf bank_mask:0xf
    s_nop 0
    v_add_f32_dpp v24, v24, v24 row_ror:1 row_mask:0xf bank_mask:0xf
    v_add_f32_dpp v25, v25, v25 row_ror:1 row_mask:0xf bank_mask:0xf
    v_mov_b32 v26, v24
    v_mov_b32 v27, v25
    s_nop 0
    v_permlane16_swap_b32 v24, v26
    v_permlane16_swap_b32 v25, v27
    v_add_f32 v24, v24, v26
    v_add_f32 v25, v25, v27
    v_mov_b32 v26, v24
    v_mov_b32 v27, v25
    s_nop 0
    v_permlane32_swap_b32 v24, v26
    v_permlane32_swap_b32 v25, v27
    v_add_f32 v24, v24, v26
    v_add_f32 v25, v25, v27
    v_mul_f32 v24, 0x3acccccd, v24
    v_mul_f32 v25, 0x3acccccd, v25
    v_fma_f32 v25, -v24, v24, v25
    v_max_f32 v25, 0, v25
    v_add_f32 v25, 0x3727c5ac, v25
    v_rsq_f32 v25, v25
    v_sub_f32 v24, 0, v24
    v_mov_b32 v26, s13
    v_mov_b32 v27, s13
    v_mov_b32 v28, 0
    s_mov_b64 exec, 1
    buffer_store_dwordx4 v[24:27], v28, s[8:11], s44 offen sc1
    s_mov_b64 exec, -1
    s_branch L_f_p0_10
L_f_spare_11:
    s_lshl_b32 s40, s3, 4
    s_add_u32 s40, s40, 15
    s_lshl_b32 s40, s40, 3
    s_add_u32 s40, s40, s12
    s_mul_i32 s31, s40, 1280
    s_lshl_b32 s40, s40, 4
    s_add_u32 s44, s40, 28459008
    s_waitcnt lgkmcnt(0)
    s_mov_b32 s16, s48
    s_mov_b32 s17, s49
    s_mov_b32 s18, 2621440
    s_mov_b32 s19, 0x00020000
    s_mov_b32 exec_hi, 0xff
    buffer_load_dwordx4 v[144:147], v152, s[16:19], s31 offen
    buffer_load_dwordx4 v[148:151], v152, s[16:19], s31 offen offset:640
    s_mov_b64 exec, -1
    s_add_u32 s6, s8, 28590080
    s_addc_u32 s7, s9, 0
    s_load_dword s13, s[6:7], 0
    s_waitcnt lgkmcnt(0)
    s_mul_i32 s13, s13, 1664525
    s_add_u32 s13, s13, 1013904223
    v_mov_b32 v2, 163832
    v_mov_b32 v3, s13
    ds_write_b32 v2, v3
    s_mov_b32 s42, 0x3f803f80
    v_mov_b32 v24, 0
    v_mov_b32 v25, 0
    s_waitcnt vmcnt(0)
    v_lshlrev_b32 v26, 16, v144
    v_and_b32 v27, 0xffff0000, v144
    v_add_f32 v24, v24, v26
    v_fmac_f32 v25, v26, v26
    v_add_f32 v24, v24, v27
    v_fmac_f32 v25, v27, v27
    v_lshlrev_b32 v26, 16, v145
    v_and_b32 v27, 0xffff0000, v145
    v_add_f32 v24, v24, v26
    v_fmac_f32 v25, v26, v26
    v_add_f32 v24, v24, v27
    v_fmac_f32 v25, v27, v27
    v_lshlrev_b32 v26, 16, v146
    v_and_b32 v27, 0xffff0000, v146
    v_add_f32 v24, v24, v26
    v_fmac_f32 v25, v26, v26
    v_add_f32 v24, v24, v27
    v_fmac_f32 v25, v27, v27
    v_lshlrev_b32 v26, 16, v147
    v_and_b32 v27, 0xffff0000, v147
    v_add_f32 v24, v24, v26
    v_fmac_f32 v25, v26, v26
    v_add_f32 v24, v24, v27
    v_fmac_f32 v25, v27, v27
    v_lshlrev_b32 v26, 16, v148
    v_and_b32 v27, 0xffff0000, v148
    v_add_f32 v24, v24, v26
    v_fmac_f32 v25, v26, v26
    v_add_f32 v24, v24, v27
    v_fmac_f32 v25, v27, v27
    v_lshlrev_b32 v26, 16, v149
    v_and_b32 v27, 0xffff0000, v149
    v_add_f32 v24, v24, v26
    v_fmac_f32 v25, v26, v26
    v_add_f32 v24, v24, v27
    v_fmac_f32 v25, v27, v27
    v_lshlrev_b32 v26, 16, v150
    v_and_b32 v27, 0xffff0000, v150
    v_add_f32 v24, v24, v26
    v_fmac_f32 v25, v26, v26
    v_add_f32 v24, v24, v27
    v_fmac_f32 v25, v27, v27
    v_lshlrev_b32 v26, 16, v151
    v_and_b32 v27, 0xffff0000, v151
    v_add_f32 v24, v24, v26
    v_fmac_f32 v25, v26, v26
    v_add_f32 v24, v24, v27
    v_fmac_f32 v25, v27, v27
    s_nop 0
    v_add_f32_dpp v24, v24, v24 row_ror:8 row_mask:0xf bank_mask:0xf
    v_add_f32_dpp v25, v25, v25 row_ror:8 row_mask:0xf bank_mask:0xf
    s_nop 0
    v_add_f32_dpp v24, v24, v24 row_ror:4 row_mask:0xf bank_mask:0xf
    v_add_f32_dpp v25, v25, v25 row_ror:4 row_mask:0xf bank_mask:0xf
    s_nop 0
    v_add_f32_dpp v24, v24, v24 row_ror:2 row_mask:0xf bank_mask:0xf
    v_add_f32_dpp v25, v25, v25 row_ror:2 row_mask:0xf bank_mask:0xf
    s_nop 0
    v_add_f32_dpp v24, v24, v24 row_ror:1 row_mask:0xf bank_mask:0xf
    v_add_f32_dpp v25, v25, v25 row_ror:1 row_mask:0xf bank_mask:0xf
    v_mov_b32 v26, v24
    v_mov_b32 v27, v25
    s_nop 0
    v_permlane16_swap_b32 v24, v26
    v_permlane16_swap_b32 v25, v27
    v_add_f32 v24, v24, v26
    v_add_f32 v25, v25, v27
    v_mov_b32 v26, v24
    v_mov_b32 v27, v25
    s_nop 0
    v_permlane32_swap_b32 v24, v26
    v_permlane32_swap_b32 v25, v27
    v_add_f32 v24, v24, v26
    v_add_f32 v25, v25, v27
    v_mul_f32 v24, 0x3acccccd, v24
    v_mul_f32 v25, 0x3acccccd, v25
    v_fma_f32 v25, -v24, v24, v25
    v_max_f32 v25, 0, v25
    v_add_f32 v25, 0x3727c5ac, v25
    v_rsq_f32 v25, v25
    v_sub_f32 v24, 0, v24
    v_mov_b32 v26, s13
    v_mov_b32 v27, s13
    v_mov_b32 v28, 0
    s_mov_b64 exec, 1
    buffer_store_dwordx4 v[24:27], v28, s[8:11], s44 offen sc1
    s_mov_b64 exec, -1
    s_branch L_f_retile_5
L_f_p0_10:
    v_mov_b32 v160, 0
    v_mov_b32 v161, 0
    v_mov_b32 v162, 0
    v_mov_b32 v163, 0
    v_mov_b32 v164, 0
    v_mov_b32 v165, 0
    v_mov_b32 v166, 0
    v_mov_b32 v167, 0
    v_mov_b32 v16, 0
    v_mov_b32 v17, 0
    v_mov_b32 v18, 0
    v_mov_b32 v19, 0
    v_mov_b32 v20, 0
    v_mov_b32 v21, 0
    v_mov_b32 v22, 0
    v_mov_b32 v23, 0
    v_mov_b32 v24, 0
    v_mov_b32 v25, 0
    v_mov_b32 v26, 0
    v_mov_b32 v27, 0
    v_mov_b32 v28, 0
    v_mov_b32 v29, 0
    v_mov_b32 v30, 0
    v_mov_b32 v31, 0
    s_mov_b32 exec_lo, 0x11111111
    s_mov_b32 exec_hi, 0x0
    v_mov_b32 v160, 0x3f803f80
    v_mov_b32 v161, 0x3f803f80
    v_mov_b32 v162, 0x3f803f80
    v_mov_b32 v163, 0x3f803f80
    s_mov_b32 exec_lo, 0x0
    s_mov_b32 exec_hi, 0x11111111
    v_mov_b32 v164, 0x3f803f80
    v_mov_b32 v165, 0x3f803f80
    v_mov_b32 v166, 0x3f803f80
    v_mov_b32 v167, 0x3f803f80
    s_mov_b64 exec, -1
    s_and_b32 s27, s12, 1
    s_bfe_u32 s28, s12, 0x10001
    s_lshr_b32 s29, s12, 2
    v_and_b32 v12, 15, v1
    v_lshrrev_b32 v13, 4, v1
    v_bfe_u32 v14, v1, 1, 3
    v_xor_b32 v14, v14, v13
    s_lshl_b32 s41, s27, 13
    v_lshlrev_b32 v15, 7, v12
    v_add_u32 v15, s41, v15
    v_lshl_add_u32 v2, v14, 4, v15
    v_xor_b32 v3, 64, v2
    v_bfe_u32 v14, v1, 2, 2
    v_lshl_add_u32 v15, v13, 3, v14
    v_lshlrev_b32 v15, 8, v15
    v_and_b32 v13, 1, v13
    v_lshl_add_u32 v15, v13, 5, v15
    v_and_b32 v12, 3, v1
    v_lshl_add_u32 v15, v12, 3, v15
    s_lshl_b32 s41, s29, 14
    s_add_u32 s41, s41, 16384
    v_add_u32 v15, s41, v15
    s_lshl_b32 s42, s28, 1
    s_add_u32 s43, s42, 0
    v_xor_b32 v12, s43, v14
    v_lshl_add_u32 v4, v12, 6, v15
    v_xor_b32 v5, 32, v4
    s_add_u32 s43, s42, 1
    v_xor_b32 v12, s43, v14
    v_lshl_add_u32 v6, v12, 6, v15
    v_xor_b32 v7, 32, v6
    s_lshl_b32 s42, s24, 1
    s_add_u32 s42, s42, s27
    s_mul_i32 s42, s42, 81920
    s_cmp_lt_u32 s25, 5
    s_cselect_b32 s41, 0, 2580480
    s_cselect_b32 s31, 0x3ea52b5c, 1.0
    s_add_u32 s41, s41, 0
    s_add_u32 s41, s41, s42
    s_lshl_b32 s42, s25, 13
    s_add_u32 s41, s41, s42
    s_lshl_b32 s42, s28, 12
    s_add_u32 s33, s41, s42
    s_add_u32 s34, s33, 40960
    s_lshl_b32 s41, s12, 11
    s_add_u32 s41, s41, 149504
    v_lshrrev_b32 v8, 4, v1
    v_lshlrev_b32 v8, 8, v8
    v_and_b32 v9, 15, v1
    v_lshl_add_u32 v8, v9, 3, v8
    v_add_u32 v8, s41, v8
    v_lshlrev_b32 v9, 4, v1
    v_add_u32 v10, s41, v9
    s_lshl_b32 s32, s25, 4
    s_add_u32 s32, s32, s24
    s_lshl_b32 s32, s32, 5
    s_add_u32 s32, s32, s12
    s_lshl_b32 s32, s32, 2
    s_add_u32 s32, s32, 28491776
    s_waitcnt lgkmcnt(0)
    s_barrier
    s_lshl_b32 s40, s25, 1
    s_add_u32 s40, s40, s28
    s_cmp_ge_u32 s40, 27
    s_cselect_b32 s40, s29, 0
    s_cmp_eq_u32 s40, 1
    s_cbranch_scc1 L_f_idle_8
    ds_read_b64_tr_b16 v[48:49], v4 offset:0
    ds_read_b64_tr_b16 v[50:51], v4 offset:1024
    ds_read_b128 v[32:35], v2 offset:0
    ds_read_b128 v[36:39], v2 offset:2048
    ds_read_b128 v[40:43], v2 offset:4096
    ds_read_b128 v[44:47], v2 offset:6144
    ds_read_b64_tr_b16 v[52:53], v5 offset:0
    ds_read_b64_tr_b16 v[54:55], v5 offset:1024
    ds_read_b64_tr_b16 v[56:57], v6 offset:0
    ds_read_b64_tr_b16 v[58:59], v6 offset:1024
    ds_read_b64_tr_b16 v[60:61], v7 offset:0
    ds_read_b64_tr_b16 v[62:63], v7 offset:1024
    s_cmp_ge_u32 s25, 10
    s_cselect_b32 s40, 1, 0
    s_cmp_eq_u32 s29, 0
    s_cselect_b32 s40, s40, 0
    s_cmp_eq_u32 s40, 1
    s_cbranch_scc1 L_f_vpart_6
    s_waitcnt lgkmcnt(0)
    s_bitcmp1_b32 s37, 0
    s_cbranch_scc1 L_f_cs_13
L_f_csb_14:
    s_bitcmp1_b32 s37, 1
    s_cbranch_scc1 L_f_cs_15
L_f_csb_16:
    s_setprio 1
    v_mfma_f32_16x16x32_bf16 v[64:67], v[48:51], v[32:35], 0
    ds_read_b64_tr_b16 v[144:145], v4 offset:8192
    ds_read_b64_tr_b16 v[146:147], v4 offset:9216
    v_mfma_f32_16x16x32_bf16 v[68:71], v[48:51], v[36:39], 0
    ds_read_b128 v[128:131], v3 offset:0
    ds_read_b128 v[132:135], v3 offset:2048
    v_mfma_f32_16x16x32_bf16 v[72:75], v[48:51], v[40:43], 0
    ds_read_b128 v[136:139], v3 offset:4096
    ds_read_b128 v[140:143], v3 offset:6144
    v_mfma_f32_16x16x32_bf16 v[76:79], v[48:51], v[44:47], 0
    ds_read_b64_tr_b16 v[148:149], v5 offset:8192
    ds_read_b64_tr_b16 v[150:151], v5 offset:9216
    v_mfma_f32_16x16x32_bf16 v[80:83], v[52:55], v[32:35], 0
    ds_read_b64_tr_b16 v[152:153], v6 offset:8192
    ds_read_b64_tr_b16 v[154:155], v6 offset:9216
    v_mfma_f32_16x16x32_bf16 v[84:87], v[52:55], v[36:39], 0
    ds_read_b64_tr_b16 v[156:157], v7 offset:8192
    ds_read_b64_tr_b16 v[158:159], v7 offset:9216
    v_mfma_f32_16x16x32_bf16 v[88:91], v[52:55], v[40:43], 0
    v_add_u32 v2, 49152, v2
    v_add_u32 v3, 49152, v3
    v_mfma_f32_16x16x32_bf16 v[92:95], v[52:55], v[44:47], 0
    v_add_u32 v4, 49152, v4
    v_add_u32 v5, 49152, v5
    s_setprio 0
    v_mfma_f32_16x16x32_bf16 v[96:99], v[56:59], v[32:35], 0
    v_add_u32 v6, 49152, v6
    v_add_u32 v7, 49152, v7
    v_mfma_f32_16x16x32_bf16 v[100:103], v[56:59], v[36:39], 0
    v_mfma_f32_16x16x32_bf16 v[104:107], v[56:59], v[40:43], 0
    v_mfma_f32_16x16x32_bf16 v[108:111], v[56:59], v[44:47], 0
    v_mfma_f32_16x16x32_bf16 v[112:115], v[60:63], v[32:35], 0
    v_mfma_f32_16x16x32_bf16 v[116:119], v[60:63], v[36:39], 0
    v_mfma_f32_16x16x32_bf16 v[120:123], v[60:63], v[40:43], 0
    v_mfma_f32_16x16x32_bf16 v[124:127], v[60:63], v[44:47], 0
    s_waitcnt lgkmcnt(0)
    s_barrier
    s_bitcmp1_b32 s37, 2
    s_cbranch_scc1 L_f_cs_17
L_f_csb_18:
    s_bitcmp1_b32 s37, 3
    s_cbranch_scc1 L_f_cs_19
L_f_csb_20:
    s_setprio 3
    v_mfma_f32_16x16x32_bf16 v[64:67], v[144:147], v[128:131], v[64:67]
    ds_read_b64_tr_b16 v[48:49], v4 offset:0
    ds_read_b64_tr_b16 v[50:51], v4 offset:1024
    v_mfma_f32_16x16x32_bf16 v[68:71], v[144:147], v[132:135], v[68:71]
    ds_read_b128 v[32:35], v2 offset:0
    ds_read_b128 v[36:39], v2 offset:2048
    v_mfma_f32_16x16x32_bf16 v[72:75], v[144:147], v[136:139], v[72:75]
    ds_read_b128 v[40:43], v2 offset:4096
    ds_read_b128 v[44:47], v2 offset:6144
    v_mfma_f32_16x16x32_bf16 v[76:79], v[144:147], v[140:143], v[76:79]
    ds_read_b64_tr_b16 v[52:53], v5 offset:0
    ds_read_b64_tr_b16 v[54:55], v5 offset:1024
    v_mfma_f32_16x16x32_bf16 v[80:83], v[148:151], v[128:131], v[80:83]
    ds_read_b64_tr_b16 v[56:57], v6 offset:0
    ds_read_b64_tr_b16 v[58:59], v6 offset:1024
    v_mfma_f32_16x16x32_bf16 v[84:87], v[148:151], v[132:135], v[84:87]
    ds_read_b64_tr_b16 v[60:61], v7 offset:0
    ds_read_b64_tr_b16 v[62:63], v7 offset:1024
    v_mfma_f32_16x16x32_bf16 v[88:91], v[148:151], v[136:139], v[88:91]
    v_mfma_f32_16x16x32_bf16 v[92:95], v[148:151], v[140:143], v[92:95]
    s_setprio 2
    v_mfma_f32_16x16x32_bf16 v[96:99], v[152:155], v[128:131], v[96:99]
    v_mfma_f32_16x16x32_bf16 v[100:103], v[152:155], v[132:135], v[100:103]
    v_mfma_f32_16x16x32_bf16 v[104:107], v[152:155], v[136:139], v[104:107]
    v_mfma_f32_16x16x32_bf16 v[108:111], v[152:155], v[140:143], v[108:111]
    v_mfma_f32_16x16x32_bf16 v[112:115], v[156:159], v[128:131], v[112:115]
    v_mfma_f32_16x16x32_bf16 v[116:119], v[156:159], v[132:135], v[116:119]
    v_mfma_f32_16x16x32_bf16 v[120:123], v[156:159], v[136:139], v[120:123]
    v_mfma_f32_16x16x32_bf16 v[124:127], v[156:159], v[140:143], v[124:127]
    s_waitcnt lgkmcnt(0)
    s_bitcmp1_b32 s37, 4
    s_cbranch_scc1 L_f_cs_21
L_f_csb_22:
    s_bitcmp1_b32 s37, 5
    s_cbranch_scc1 L_f_cs_23
L_f_csb_24:
    s_setprio 1
    v_mfma_f32_16x16x32_bf16 v[64:67], v[48:51], v[32:35], v[64:67]
    ds_read_b64_tr_b16 v[144:145], v4 offset:8192
    ds_read_b64_tr_b16 v[146:147], v4 offset:9216
    v_mfma_f32_16x16x32_bf16 v[68:71], v[48:51], v[36:39], v[68:71]
    ds_read_b128 v[128:131], v3 offset:0
    ds_read_b128 v[132:135], v3 offset:2048
    v_mfma_f32_16x16x32_bf16 v[72:75], v[48:51], v[40:43], v[72:75]
    ds_read_b128 v[136:139], v3 offset:4096
    ds_read_b128 v[140:143], v3 offset:6144
    v_mfma_f32_16x16x32_bf16 v[76:79], v[48:51], v[44:47], v[76:79]
    ds_read_b64_tr_b16 v[148:149], v5 offset:8192
    ds_read_b64_tr_b16 v[150:151], v5 offset:9216
    v_mfma_f32_16x16x32_bf16 v[80:83], v[52:55], v[32:35], v[80:83]
    ds_read_b64_tr_b16 v[152:153], v6 offset:8192
    ds_read_b64_tr_b16 v[154:155], v6 offset:9216
    v_mfma_f32_16x16x32_bf16 v[84:87], v[52:55], v[36:39], v[84:87]
    ds_read_b64_tr_b16 v[156:157], v7 offset:8192
    ds_read_b64_tr_b16 v[158:159], v7 offset:9216
    v_mfma_f32_16x16x32_bf16 v[88:91], v[52:55], v[40:43], v[88:91]
    v_add_u32 v2, 49152, v2
    v_add_u32 v3, 49152, v3
    v_mfma_f32_16x16x32_bf16 v[92:95], v[52:55], v[44:47], v[92:95]
    v_add_u32 v4, 49152, v4
    v_add_u32 v5, 49152, v5
    s_setprio 0
    v_mfma_f32_16x16x32_bf16 v[96:99], v[56:59], v[32:35], v[96:99]
    v_add_u32 v6, 49152, v6
    v_add_u32 v7, 49152, v7
    v_mfma_f32_16x16x32_bf16 v[100:103], v[56:59], v[36:39], v[100:103]
    v_mfma_f32_16x16x32_bf16 v[104:107], v[56:59], v[40:43], v[104:107]
    v_mfma_f32_16x16x32_bf16 v[108:111], v[56:59], v[44:47], v[108:111]
    v_mfma_f32_16x16x32_bf16 v[112:115], v[60:63], v[32:35], v[112:115]
    v_mfma_f32_16x16x32_bf16 v[116:119], v[60:63], v[36:39], v[116:119]
    v_mfma_f32_16x16x32_bf16 v[120:123], v[60:63], v[40:43], v[120:123]
    v_mfma_f32_16x16x32_bf16 v[124:127], v[60:63], v[44:47], v[124:127]
    s_waitcnt lgkmcnt(0)
    s_barrier
    s_setprio 3
    v_mfma_f32_16x16x32_bf16 v[64:67], v[144:147], v[128:131], v[64:67]
    ds_read_b64_tr_b16 v[48:49], v4 offset:0
    ds_read_b64_tr_b16 v[50:51], v4 offset:1024
    v_mfma_f32_16x16x32_bf16 v[68:71], v[144:147], v[132:135], v[68:71]
    ds_read_b128 v[32:35], v2 offset:0
    ds_read_b128 v[36:39], v2 offset:2048
    v_mfma_f32_16x16x32_bf16 v[72:75], v[144:147], v[136:139], v[72:75]
    ds_read_b128 v[40:43], v2 offset:4096
    ds_read_b128 v[44:47], v2 offset:6144
    v_mfma_f32_16x16x32_bf16 v[76:79], v[144:147], v[140:143], v[76:79]
    ds_read_b64_tr_b16 v[52:53], v5 offset:0
    ds_read_b64_tr_b16 v[54:55], v5 offset:1024
    v_mfma_f32_16x16x32_bf16 v[80:83], v[148:151], v[128:131], v[80:83]
    ds_read_b64_tr_b16 v[56:57], v6 offset:0
    ds_read_b64_tr_b16 v[58:59], v6 offset:1024
    v_mfma_f32_16x16x32_bf16 v[84:87], v[148:151], v[132:135], v[84:87]
    ds_read_b64_tr_b16 v[60:61], v7 offset:0
    ds_read_b64_tr_b16 v[62:63], v7 offset:1024
    v_mfma_f32_16x16x32_bf16 v[88:91], v[148:151], v[136:139], v[88:91]
    v_mfma_f32_16x16x32_bf16 v[92:95], v[148:151], v[140:143], v[92:95]
    s_setprio 2
    v_mfma_f32_16x16x32_bf16 v[96:99], v[152:155], v[128:131], v[96:99]
    v_mfma_f32_16x16x32_bf16 v[100:103], v[152:155], v[132:135], v[100:103]
    v_mfma_f32_16x16x32_bf16 v[104:107], v[152:155], v[136:139], v[104:107]
    v_mfma_f32_16x16x32_bf16 v[108:111], v[152:155], v[140:143], v[108:111]
    v_mfma_f32_16x16x32_bf16 v[112:115], v[156:159], v[128:131], v[112:115]
    v_mfma_f32_16x16x32_bf16 v[116:119], v[156:159], v[132:135], v[116:119]
    v_mfma_f32_16x16x32_bf16 v[120:123], v[156:159], v[136:139], v[120:123]
    v_mfma_f32_16x16x32_bf16 v[124:127], v[156:159], v[140:143], v[124:127]
    s_waitcnt lgkmcnt(0)
    s_setprio 1
    v_mfma_f32_16x16x32_bf16 v[64:67], v[48:51], v[32:35], v[64:67]
    ds_read_b64_tr_b16 v[144:145], v4 offset:8192
    ds_read_b64_tr_b16 v[146:147], v4 offset:9216
    ds_read_b128 v[128:131], v3 offset:0
    v_mfma_f32_16x16x32_bf16 v[68:71], v[48:51], v[36:39], v[68:71]
    ds_read_b128 v[132:135], v3 offset:2048
    ds_read_b128 v[136:139], v3 offset:4096
    ds_read_b128 v[140:143], v3 offset:6144
    v_mfma_f32_16x16x32_bf16 v[72:75], v[48:51], v[40:43], v[72:75]
    ds_read_b64_tr_b16 v[148:149], v5 offset:8192
    ds_read_b64_tr_b16 v[150:151], v5 offset:9216
    ds_read_b64_tr_b16 v[152:153], v6 offset:8192
    v_mfma_f32_16x16x32_bf16 v[76:79], v[48:51], v[44:47], v[76:79]
    ds_read_b64_tr_b16 v[154:155], v6 offset:9216
    ds_read_b64_tr_b16 v[156:157], v7 offset:8192
    ds_read_b64_tr_b16 v[158:159], v7 offset:9216
    v_mfma_f32_16x16x32_bf16 v[80:83], v[52:55], v[32:35], v[80:83]
    v_add_u32 v2, 4294868992, v2
    v_add_u32 v3, 4294868992, v3
    v_add_u32 v4, 4294868992, v4
    v_mfma_f32_16x16x32_bf16 v[84:87], v[52:55], v[36:39], v[84:87]
    v_add_u32 v5, 4294868992, v5
    v_add_u32 v6, 4294868992, v6
    v_add_u32 v7, 4294868992, v7
    v_mfma_f32_16x16x32_bf16 v[88:91], v[52:55], v[40:43], v[88:91]
    s_mul_i32 s40, s24, 2048
    s_lshl_b32 s41, s25, 15
    s_add_u32 s40, s40, s41
    v_mfma_f32_16x16x32_bf16 v[92:95], v[52:55], v[44:47], v[92:95]
    s_lshr_b32 s41, s12, 1
    s_lshl_b32 s41, s41, 9
    s_add_u32 s40, s40, s41
    s_setprio 0
    v_mfma_f32_16x16x32_bf16 v[96:99], v[56:59], v[32:35], v[96:99]
    s_add_u32 s40, s40, 28721152
    v_lshlrev_b32 v12, 3, v1
    v_mov_b32 v17, s13
    v_mfma_f32_16x16x32_bf16 v[100:103], v[56:59], v[36:39], v[100:103]
    s_mov_b32 exec_lo, 0xffff0000
    v_mov_b32 v16, v20
    s_mov_b32 exec_lo, 0
    v_mov_b32 v16, v24
    s_mov_b32 exec_hi, 0xffff0000
    v_mov_b32 v16, v28
    s_mov_b64 exec, -1
    buffer_store_dwordx2 v[16:17], v12, s[8:11], s40 offen sc1
    v_mfma_f32_16x16x32_bf16 v[104:107], v[56:59], v[40:43], v[104:107]
    v_mfma_f32_16x16x32_bf16 v[108:111], v[56:59], v[44:47], v[108:111]
    v_mfma_f32_16x16x32_bf16 v[112:115], v[60:63], v[32:35], v[112:115]
    v_mfma_f32_16x16x32_bf16 v[116:119], v[60:63], v[36:39], v[116:119]
    v_mfma_f32_16x16x32_bf16 v[120:123], v[60:63], v[40:43], v[120:123]
    v_mfma_f32_16x16x32_bf16 v[124:127], v[60:63], v[44:47], v[124:127]
    s_waitcnt lgkmcnt(0)
    s_barrier
    s_setprio 3
    v_mfma_f32_16x16x32_bf16 v[64:67], v[144:147], v[128:131], v[64:67]
    ds_read_b64_tr_b16 v[48:49], v4 offset:0
    ds_read_b64_tr_b16 v[50:51], v4 offset:1024
    v_mfma_f32_16x16x32_bf16 v[68:71], v[144:147], v[132:135], v[68:71]
    ds_read_b128 v[32:35], v2 offset:0
    ds_read_b128 v[36:39], v2 offset:2048
    v_mfma_f32_16x16x32_bf16 v[72:75], v[144:147], v[136:139], v[72:75]
    ds_read_b128 v[40:43], v2 offset:4096
    ds_read_b128 v[44:47], v2 offset:6144
    v_mfma_f32_16x16x32_bf16 v[76:79], v[144:147], v[140:143], v[76:79]
    ds_read_b64_tr_b16 v[52:53], v5 offset:0
    ds_read_b64_tr_b16 v[54:55], v5 offset:1024
    v_mfma_f32_16x16x32_bf16 v[80:83], v[148:151], v[128:131], v[80:83]
    ds_read_b64_tr_b16 v[56:57], v6 offset:0
    ds_read_b64_tr_b16 v[58:59], v6 offset:1024
    v_mfma_f32_16x16x32_bf16 v[84:87], v[148:151], v[132:135], v[84:87]
    ds_read_b64_tr_b16 v[60:61], v7 offset:0
    ds_read_b64_tr_b16 v[62:63], v7 offset:1024
    v_mfma_f32_16x16x32_bf16 v[88:91], v[148:151], v[136:139], v[88:91]
    v_mfma_f32_16x16x32_bf16 v[92:95], v[148:151], v[140:143], v[92:95]
    s_setprio 2
    v_mfma_f32_16x16x32_bf16 v[96:99], v[152:155], v[128:131], v[96:99]
    v_mfma_f32_16x16x32_bf16 v[100:103], v[152:155], v[132:135], v[100:103]
    v_mfma_f32_16x16x32_bf16 v[104:107], v[152:155], v[136:139], v[104:107]
    v_mfma_f32_16x16x32_bf16 v[108:111], v[152:155], v[140:143], v[108:111]
    v_mfma_f32_16x16x32_bf16 v[112:115], v[156:159], v[128:131], v[112:115]
    v_mfma_f32_16x16x32_bf16 v[116:119], v[156:159], v[132:135], v[116:119]
    v_mfma_f32_16x16x32_bf16 v[120:123], v[156:159], v[136:139], v[120:123]
    v_mfma_f32_16x16x32_bf16 v[124:127], v[156:159], v[140:143], v[124:127]
    s_waitcnt lgkmcnt(0)
    s_setprio 1
    v_mfma_f32_16x16x32_bf16 v[64:67], v[48:51], v[32:35], v[64:67]
    ds_read_b64_tr_b16 v[144:145], v4 offset:8192
    ds_read_b64_tr_b16 v[146:147], v4 offset:9216
    v_mfma_f32_16x16x32_bf16 v[68:71], v[48:51], v[36:39], v[68:71]
    ds_read_b128 v[128:131], v3 offset:0
    ds_read_b128 v[132:135], v3 offset:2048
    v_mfma_f32_16x16x32_bf16 v[72:75], v[48:51], v[40:43], v[72:75]
    ds_read_b128 v[136:139], v3 offset:4096
    ds_read_b128 v[140:143], v3 offset:6144
    v_mfma_f32_16x16x32_bf16 v[76:79], v[48:51], v[44:47], v[76:79]
    ds_read_b64_tr_b16 v[148:149], v5 offset:8192
    ds_read_b64_tr_b16 v[150:151], v5 offset:9216
    v_mfma_f32_16x16x32_bf16 v[80:83], v[52:55], v[32:35], v[80:83]
    ds_read_b64_tr_b16 v[152:153], v6 offset:8192
    ds_read_b64_tr_b16 v[154:155], v6 offset:9216
    v_mfma_f32_16x16x32_bf16 v[84:87], v[52:55], v[36:39], v[84:87]
    ds_read_b64_tr_b16 v[156:157], v7 offset:8192
    ds_read_b64_tr_b16 v[158:159], v7 offset:9216
    v_mfma_f32_16x16x32_bf16 v[88:91], v[52:55], v[40:43], v[88:91]
    v_add_u32 v2, 49152, v2
    v_add_u32 v3, 49152, v3
    v_mfma_f32_16x16x32_bf16 v[92:95], v[52:55], v[44:47], v[92:95]
    v_add_u32 v4, 49152, v4
    v_add_u32 v5, 49152, v5
    s_setprio 0
    v_mfma_f32_16x16x32_bf16 v[96:99], v[56:59], v[32:35], v[96:99]
    v_add_u32 v6, 49152, v6
    v_add_u32 v7, 49152, v7
    v_mfma_f32_16x16x32_bf16 v[100:103], v[56:59], v[36:39], v[100:103]
    v_mfma_f32_16x16x32_bf16 v[104:107], v[56:59], v[40:43], v[104:107]
    v_mfma_f32_16x16x32_bf16 v[108:111], v[56:59], v[44:47], v[108:111]
    v_mfma_f32_16x16x32_bf16 v[112:115], v[60:63], v[32:35], v[112:115]
    v_mfma_f32_16x16x32_bf16 v[116:119], v[60:63], v[36:39], v[116:119]
    v_mfma_f32_16x16x32_bf16 v[120:123], v[60:63], v[40:43], v[120:123]
    v_mfma_f32_16x16x32_bf16 v[124:127], v[60:63], v[44:47], v[124:127]
    s_waitcnt lgkmcnt(0)
    s_barrier
    s_setprio 3
    v_mfma_f32_16x16x32_bf16 v[64:67], v[144:147], v[128:131], v[64:67]
    ds_read_b64_tr_b16 v[48:49], v4 offset:0
    ds_read_b64_tr_b16 v[50:51], v4 offset:1024
    v_mfma_f32_16x16x32_bf16 v[68:71], v[144:147], v[132:135], v[68:71]
    ds_read_b128 v[32:35], v2 offset:0
    ds_read_b128 v[36:39], v2 offset:2048
    v_mfma_f32_16x16x32_bf16 v[72:75], v[144:147], v[136:139], v[72:75]
    ds_read_b128 v[40:43], v2 offset:4096
    ds_read_b128 v[44:47], v2 offset:6144
    v_mfma_f32_16x16x32_bf16 v[76:79], v[144:147], v[140:143], v[76:79]
    ds_read_b64_tr_b16 v[52:53], v5 offset:0
    ds_read_b64_tr_b16 v[54:55], v5 offset:1024
    v_mfma_f32_16x16x32_bf16 v[80:83], v[148:151], v[128:131], v[80:83]
    ds_read_b64_tr_b16 v[56:57], v6 offset:0
    ds_read_b64_tr_b16 v[58:59], v6 offset:1024
    v_mfma_f32_16x16x32_bf16 v[84:87], v[148:151], v[132:135], v[84:87]
    ds_read_b64_tr_b16 v[60:61], v7 offset:0
    ds_read_b64_tr_b16 v[62:63], v7 offset:1024
    v_mfma_f32_16x16x32_bf16 v[88:91], v[148:151], v[136:139], v[88:91]
    v_mfma_f32_16x16x32_bf16 v[92:95], v[148:151], v[140:143], v[92:95]
    s_setprio 2
    v_mfma_f32_16x16x32_bf16 v[96:99], v[152:155], v[128:131], v[96:99]
    v_mfma_f32_16x16x32_bf16 v[100:103], v[152:155], v[132:135], v[100:103]
    v_mfma_f32_16x16x32_bf16 v[104:107], v[152:155], v[136:139], v[104:107]
    v_mfma_f32_16x16x32_bf16 v[108:111], v[152:155], v[140:143], v[108:111]
    v_mfma_f32_16x16x32_bf16 v[112:115], v[156:159], v[128:131], v[112:115]
    v_mfma_f32_16x16x32_bf16 v[116:119], v[156:159], v[132:135], v[116:119]
    v_mfma_f32_16x16x32_bf16 v[120:123], v[156:159], v[136:139], v[120:123]
    v_mfma_f32_16x16x32_bf16 v[124:127], v[156:159], v[140:143], v[124:127]
    s_waitcnt lgkmcnt(0)
    s_setprio 1
    v_mfma_f32_16x16x32_bf16 v[64:67], v[48:51], v[32:35], v[64:67]
    ds_read_b64_tr_b16 v[144:145], v4 offset:8192
    ds_read_b64_tr_b16 v[146:147], v4 offset:9216
    v_mfma_f32_16x16x32_bf16 v[68:71], v[48:51], v[36:39], v[68:71]
    ds_read_b128 v[128:131], v3 offset:0
    ds_read_b128 v[132:135], v3 offset:2048
    v_mfma_f32_16x16x32_bf16 v[72:75], v[48:51], v[40:43], v[72:75]
    ds_read_b128 v[136:139], v3 offset:4096
    ds_read_b128 v[140:143], v3 offset:6144
    v_mfma_f32_16x16x32_bf16 v[76:79], v[48:51], v[44:47], v[76:79]
    ds_read_b64_tr_b16 v[148:149], v5 offset:8192
    ds_read_b64_tr_b16 v[150:151], v5 offset:9216
    v_mfma_f32_16x16x32_bf16 v[80:83], v[52:55], v[32:35], v[80:83]
    ds_read_b64_tr_b16 v[152:153], v6 offset:8192
    ds_read_b64_tr_b16 v[154:155], v6 offset:9216
    v_mfma_f32_16x16x32_bf16 v[84:87], v[52:55], v[36:39], v[84:87]
    ds_read_b64_tr_b16 v[156:157], v7 offset:8192
    ds_read_b64_tr_b16 v[158:159], v7 offset:9216
    v_mfma_f32_16x16x32_bf16 v[88:91], v[52:55], v[40:43], v[88:91]
    v_add_u32 v2, 49152, v2
    v_add_u32 v3, 49152, v3
    v_mfma_f32_16x16x32_bf16 v[92:95], v[52:55], v[44:47], v[92:95]
    v_add_u32 v4, 49152, v4
    v_add_u32 v5, 49152, v5
    s_setprio 0
    v_mfma_f32_16x16x32_bf16 v[96:99], v[56:59], v[32:35], v[96:99]
    v_add_u32 v6, 49152, v6
    v_add_u32 v7, 49152, v7
    v_mfma_f32_16x16x32_bf16 v[100:103], v[56:59], v[36:39], v[100:103]
    v_mfma_f32_16x16x32_bf16 v[104:107], v[56:59], v[40:43], v[104:107]
    v_mfma_f32_16x16x32_bf16 v[108:111], v[56:59], v[44:47], v[108:111]
    v_mfma_f32_16x16x32_bf16 v[112:115], v[60:63], v[32:35], v[112:115]
    v_mfma_f32_16x16x32_bf16 v[116:119], v[60:63], v[36:39], v[116:119]
    v_mfma_f32_16x16x32_bf16 v[120:123], v[60:63], v[40:43], v[120:123]
    v_mfma_f32_16x16x32_bf16 v[124:127], v[60:63], v[44:47], v[124:127]
    s_waitcnt lgkmcnt(0)
    s_barrier
    s_setprio 3
    v_mfma_f32_16x16x32_bf16 v[64:67], v[144:147], v[128:131], v[64:67]
    ds_read_b64_tr_b16 v[48:49], v4 offset:0
    ds_read_b64_tr_b16 v[50:51], v4 offset:1024
    v_mfma_f32_16x16x32_bf16 v[68:71], v[144:147], v[132:135], v[68:71]
    ds_read_b128 v[32:35], v2 offset:0
    ds_read_b128 v[36:39], v2 offset:2048
    v_mfma_f32_16x16x32_bf16 v[72:75], v[144:147], v[136:139], v[72:75]
    ds_read_b128 v[40:43], v2 offset:4096
    ds_read_b128 v[44:47], v2 offset:6144
    v_mfma_f32_16x16x32_bf16 v[76:79], v[144:147], v[140:143], v[76:79]
    ds_read_b64_tr_b16 v[52:53], v5 offset:0
    ds_read_b64_tr_b16 v[54:55], v5 offset:1024
    v_mfma_f32_16x16x32_bf16 v[80:83], v[148:151], v[128:131], v[80:83]
    ds_read_b64_tr_b16 v[56:57], v6 offset:0
    ds_read_b64_tr_b16 v[58:59], v6 offset:1024
    v_mfma_f32_16x16x32_bf16 v[84:87], v[148:151], v[132:135], v[84:87]
    ds_read_b64_tr_b16 v[60:61], v7 offset:0
    ds_read_b64_tr_b16 v[62:63], v7 offset:1024
    v_mfma_f32_16x16x32_bf16 v[88:91], v[148:151], v[136:139], v[88:91]
    v_mfma_f32_16x16x32_bf16 v[92:95], v[148:151], v[140:143], v[92:95]
    s_setprio 2
    v_mfma_f32_16x16x32_bf16 v[96:99], v[152:155], v[128:131], v[96:99]
    v_mfma_f32_16x16x32_bf16 v[100:103], v[152:155], v[132:135], v[100:103]
    v_mfma_f32_16x16x32_bf16 v[104:107], v[152:155], v[136:139], v[104:107]
    v_mfma_f32_16x16x32_bf16 v[108:111], v[152:155], v[140:143], v[108:111]
    v_mfma_f32_16x16x32_bf16 v[112:115], v[156:159], v[128:131], v[112:115]
    v_mfma_f32_16x16x32_bf16 v[116:119], v[156:159], v[132:135], v[116:119]
    v_mfma_f32_16x16x32_bf16 v[120:123], v[156:159], v[136:139], v[120:123]
    v_mfma_f32_16x16x32_bf16 v[124:127], v[156:159], v[140:143], v[124:127]
    s_waitcnt lgkmcnt(0)
    s_setprio 1
    v_mfma_f32_16x16x32_bf16 v[64:67], v[48:51], v[32:35], v[64:67]
    ds_read_b64_tr_b16 v[144:145], v4 offset:8192
    ds_read_b64_tr_b16 v[146:147], v4 offset:9216
    v_mfma_f32_16x16x32_bf16 v[68:71], v[48:51], v[36:39], v[68:71]
    ds_read_b128 v[128:131], v3 offset:0
    ds_read_b128 v[132:135], v3 offset:2048
    v_mfma_f32_16x16x32_bf16 v[72:75], v[48:51], v[40:43], v[72:75]
    ds_read_b128 v[136:139], v3 offset:4096
    ds_read_b128 v[140:143], v3 offset:6144
    v_mfma_f32_16x16x32_bf16 v[76:79], v[48:51], v[44:47], v[76:79]
    ds_read_b64_tr_b16 v[148:149], v5 offset:8192
    ds_read_b64_tr_b16 v[150:151], v5 offset:9216
    v_mfma_f32_16x16x32_bf16 v[80:83], v[52:55], v[32:35], v[80:83]
    ds_read_b64_tr_b16 v[152:153], v6 offset:8192
    ds_read_b64_tr_b16 v[154:155], v6 offset:9216
    v_mfma_f32_16x16x32_bf16 v[84:87], v[52:55], v[36:39], v[84:87]
    ds_read_b64_tr_b16 v[156:157], v7 offset:8192
    ds_read_b64_tr_b16 v[158:159], v7 offset:9216
    v_mfma_f32_16x16x32_bf16 v[88:91], v[52:55], v[40:43], v[88:91]
    v_add_u32 v2, 4294868992, v2
    v_add_u32 v3, 4294868992, v3
    v_mfma_f32_16x16x32_bf16 v[92:95], v[52:55], v[44:47], v[92:95]
    v_add_u32 v4, 4294868992, v4
    v_add_u32 v5, 4294868992, v5
    s_setprio 0
    v_mfma_f32_16x16x32_bf16 v[96:99], v[56:59], v[32:35], v[96:99]
    v_add_u32 v6, 4294868992, v6
    v_add_u32 v7, 4294868992, v7
    v_mfma_f32_16x16x32_bf16 v[100:103], v[56:59], v[36:39], v[100:103]
    v_mfma_f32_16x16x32_bf16 v[104:107], v[56:59], v[40:43], v[104:107]
    v_mfma_f32_16x16x32_bf16 v[108:111], v[56:59], v[44:47], v[108:111]
    v_mfma_f32_16x16x32_bf16 v[112:115], v[60:63], v[32:35], v[112:115]
    v_mfma_f32_16x16x32_bf16 v[116:119], v[60:63], v[36:39], v[116:119]
    v_mfma_f32_16x16x32_bf16 v[120:123], v[60:63], v[40:43], v[120:123]
    v_mfma_f32_16x16x32_bf16 v[124:127], v[60:63], v[44:47], v[124:127]
    s_waitcnt lgkmcnt(0)
    s_barrier
    s_setprio 3
    v_mfma_f32_16x16x32_bf16 v[64:67], v[144:147], v[128:131], v[64:67]
    ds_read_b64_tr_b16 v[48:49], v4 offset:0
    ds_read_b64_tr_b16 v[50:51], v4 offset:1024
    v_mfma_f32_16x16x32_bf16 v[68:71], v[144:147], v[132:135], v[68:71]
    ds_read_b128 v[32:35], v2 offset:0
    ds_read_b128 v[36:39], v2 offset:2048
    v_mfma_f32_16x16x32_bf16 v[72:75], v[144:147], v[136:139], v[72:75]
    ds_read_b128 v[40:43], v2 offset:4096
    ds_read_b128 v[44:47], v2 offset:6144
    v_mfma_f32_16x16x32_bf16 v[76:79], v[144:147], v[140:143], v[76:79]
    ds_read_b64_tr_b16 v[52:53], v5 offset:0
    ds_read_b64_tr_b16 v[54:55], v5 offset:1024
    v_mfma_f32_16x16x32_bf16 v[80:83], v[148:151], v[128:131], v[80:83]
    ds_read_b64_tr_b16 v[56:57], v6 offset:0
    ds_read_b64_tr_b16 v[58:59], v6 offset:1024
    v_mfma_f32_16x16x32_bf16 v[84:87], v[148:151], v[132:135], v[84:87]
    ds_read_b64_tr_b16 v[60:61], v7 offset:0
    ds_read_b64_tr_b16 v[62:63], v7 offset:1024
    v_mfma_f32_16x16x32_bf16 v[88:91], v[148:151], v[136:139], v[88:91]
    v_mfma_f32_16x16x32_bf16 v[92:95], v[148:151], v[140:143], v[92:95]
    s_setprio 2
    v_mfma_f32_16x16x32_bf16 v[96:99], v[152:155], v[128:131], v[96:99]
    v_mfma_f32_16x16x32_bf16 v[100:103], v[152:155], v[132:135], v[100:103]
    v_mfma_f32_16x16x32_bf16 v[104:107], v[152:155], v[136:139], v[104:107]
    v_mfma_f32_16x16x32_bf16 v[108:111], v[152:155], v[140:143], v[108:111]
    v_mfma_f32_16x16x32_bf16 v[112:115], v[156:159], v[128:131], v[112:115]
    v_mfma_f32_16x16x32_bf16 v[116:119], v[156:159], v[132:135], v[116:119]
    v_mfma_f32_16x16x32_bf16 v[120:123], v[156:159], v[136:139], v[120:123]
    v_mfma_f32_16x16x32_bf16 v[124:127], v[156:159], v[140:143], v[124:127]
    s_waitcnt lgkmcnt(0)
    s_setprio 1
    v_mfma_f32_16x16x32_bf16 v[64:67], v[48:51], v[32:35], v[64:67]
    ds_read_b64_tr_b16 v[144:145], v4 offset:8192
    ds_read_b64_tr_b16 v[146:147], v4 offset:9216
    v_mfma_f32_16x16x32_bf16 v[68:71], v[48:51], v[36:39], v[68:71]
    ds_read_b128 v[128:131], v3 offset:0
    ds_read_b128 v[132:135], v3 offset:2048
    v_mfma_f32_16x16x32_bf16 v[72:75], v[48:51], v[40:43], v[72:75]
    ds_read_b128 v[136:139], v3 offset:4096
    ds_read_b128 v[140:143], v3 offset:6144
    v_mfma_f32_16x16x32_bf16 v[76:79], v[48:51], v[44:47], v[76:79]
    ds_read_b64_tr_b16 v[148:149], v5 offset:8192
    ds_read_b64_tr_b16 v[150:151], v5 offset:9216
    v_mfma_f32_16x16x32_bf16 v[80:83], v[52:55], v[32:35], v[80:83]
    ds_read_b64_tr_b16 v[152:153], v6 offset:8192
    ds_read_b64_tr_b16 v[154:155], v6 offset:9216
    v_mfma_f32_16x16x32_bf16 v[84:87], v[52:55], v[36:39], v[84:87]
    ds_read_b64_tr_b16 v[156:157], v7 offset:8192
    ds_read_b64_tr_b16 v[158:159], v7 offset:9216
    v_mfma_f32_16x16x32_bf16 v[88:91], v[52:55], v[40:43], v[88:91]
    v_add_u32 v2, 49152, v2
    v_add_u32 v3, 49152, v3
    v_mfma_f32_16x16x32_bf16 v[92:95], v[52:55], v[44:47], v[92:95]
    v_add_u32 v4, 49152, v4
    v_add_u32 v5, 49152, v5
    s_setprio 0
    v_mfma_f32_16x16x32_bf16 v[96:99], v[56:59], v[32:35], v[96:99]
    v_add_u32 v6, 49152, v6
    v_add_u32 v7, 49152, v7
    v_mfma_f32_16x16x32_bf16 v[100:103], v[56:59], v[36:39], v[100:103]
    v_mfma_f32_16x16x32_bf16 v[104:107], v[56:59], v[40:43], v[104:107]
    v_mfma_f32_16x16x32_bf16 v[108:111], v[56:59], v[44:47], v[108:111]
    v_mfma_f32_16x16x32_bf16 v[112:115], v[60:63], v[32:35], v[112:115]
    v_mfma_f32_16x16x32_bf16 v[116:119], v[60:63], v[36:39], v[116:119]
    v_mfma_f32_16x16x32_bf16 v[120:123], v[60:63], v[40:43], v[120:123]
    v_mfma_f32_16x16x32_bf16 v[124:127], v[60:63], v[44:47], v[124:127]
    s_waitcnt lgkmcnt(0)
    s_barrier
    s_setprio 3
    v_mfma_f32_16x16x32_bf16 v[64:67], v[144:147], v[128:131], v[64:67]
    ds_read_b64_tr_b16 v[48:49], v4 offset:0
    ds_read_b64_tr_b16 v[50:51], v4 offset:1024
    v_mfma_f32_16x16x32_bf16 v[68:71], v[144:147], v[132:135], v[68:71]
    ds_read_b128 v[32:35], v2 offset:0
    ds_read_b128 v[36:39], v2 offset:2048
    v_mfma_f32_16x16x32_bf16 v[72:75], v[144:147], v[136:139], v[72:75]
    ds_read_b128 v[40:43], v2 offset:4096
    ds_read_b128 v[44:47], v2 offset:6144
    v_mfma_f32_16x16x32_bf16 v[76:79], v[144:147], v[140:143], v[76:79]
    ds_read_b64_tr_b16 v[52:53], v5 offset:0
    ds_read_b64_tr_b16 v[54:55], v5 offset:1024
    v_mfma_f32_16x16x32_bf16 v[80:83], v[148:151], v[128:131], v[80:83]
    ds_read_b64_tr_b16 v[56:57], v6 offset:0
    ds_read_b64_tr_b16 v[58:59], v6 offset:1024
    v_mfma_f32_16x16x32_bf16 v[84:87], v[148:151], v[132:135], v[84:87]
    ds_read_b64_tr_b16 v[60:61], v7 offset:0
    ds_read_b64_tr_b16 v[62:63], v7 offset:1024
    v_mfma_f32_16x16x32_bf16 v[88:91], v[148:151], v[136:139], v[88:91]
    v_mfma_f32_16x16x32_bf16 v[92:95], v[148:151], v[140:143], v[92:95]
    s_setprio 2
    v_mfma_f32_16x16x32_bf16 v[96:99], v[152:155], v[128:131], v[96:99]
    v_mfma_f32_16x16x32_bf16 v[100:103], v[152:155], v[132:135], v[100:103]
    v_mfma_f32_16x16x32_bf16 v[104:107], v[152:155], v[136:139], v[104:107]
    v_mfma_f32_16x16x32_bf16 v[108:111], v[152:155], v[140:143], v[108:111]
    v_mfma_f32_16x16x32_bf16 v[112:115], v[156:159], v[128:131], v[112:115]
    v_mfma_f32_16x16x32_bf16 v[116:119], v[156:159], v[132:135], v[116:119]
    v_mfma_f32_16x16x32_bf16 v[120:123], v[156:159], v[136:139], v[120:123]
    v_mfma_f32_16x16x32_bf16 v[124:127], v[156:159], v[140:143], v[124:127]
    s_waitcnt lgkmcnt(0)
    s_setprio 1
    v_mfma_f32_16x16x32_bf16 v[64:67], v[48:51], v[32:35], v[64:67]
    ds_read_b64_tr_b16 v[144:145], v4 offset:8192
    ds_read_b64_tr_b16 v[146:147], v4 offset:9216
    v_mfma_f32_16x16x32_bf16 v[68:71], v[48:51], v[36:39], v[68:71]
    ds_read_b128 v[128:131], v3 offset:0
    ds_read_b128 v[132:135], v3 offset:2048
    v_mfma_f32_16x16x32_bf16 v[72:75], v[48:51], v[40:43], v[72:75]
    ds_read_b128 v[136:139], v3 offset:4096
    ds_read_b128 v[140:143], v3 offset:6144
    v_mfma_f32_16x16x32_bf16 v[76:79], v[48:51], v[44:47], v[76:79]
    ds_read_b64_tr_b16 v[148:149], v5 offset:8192
    ds_read_b64_tr_b16 v[150:151], v5 offset:9216
    v_mfma_f32_16x16x32_bf16 v[80:83], v[52:55], v[32:35], v[80:83]
    ds_read_b64_tr_b16 v[152:153], v6 offset:8192
    ds_read_b64_tr_b16 v[154:155], v6 offset:9216
    v_mfma_f32_16x16x32_bf16 v[84:87], v[52:55], v[36:39], v[84:87]
    ds_read_b64_tr_b16 v[156:157], v7 offset:8192
    ds_read_b64_tr_b16 v[158:159], v7 offset:9216
    v_mfma_f32_16x16x32_bf16 v[88:91], v[52:55], v[40:43], v[88:91]
    v_add_u32 v2, 49152, v2
    v_add_u32 v3, 49152, v3
    v_mfma_f32_16x16x32_bf16 v[92:95], v[52:55], v[44:47], v[92:95]
    v_add_u32 v4, 49152, v4
    v_add_u32 v5, 49152, v5
    s_setprio 0
    v_mfma_f32_16x16x32_bf16 v[96:99], v[56:59], v[32:35], v[96:99]
    v_add_u32 v6, 49152, v6
    v_add_u32 v7, 49152, v7
    v_mfma_f32_16x16x32_bf16 v[100:103], v[56:59], v[36:39], v[100:103]
    v_mfma_f32_16x16x32_bf16 v[104:107], v[56:59], v[40:43], v[104:107]
    v_mfma_f32_16x16x32_bf16 v[108:111], v[56:59], v[44:47], v[108:111]
    v_mfma_f32_16x16x32_bf16 v[112:115], v[60:63], v[32:35], v[112:115]
    v_mfma_f32_16x16x32_bf16 v[116:119], v[60:63], v[36:39], v[116:119]
    v_mfma_f32_16x16x32_bf16 v[120:123], v[60:63], v[40:43], v[120:123]
    v_mfma_f32_16x16x32_bf16 v[124:127], v[60:63], v[44:47], v[124:127]
    s_waitcnt lgkmcnt(0)
    s_barrier
    s_setprio 3
    v_mfma_f32_16x16x32_bf16 v[64:67], v[144:147], v[128:131], v[64:67]
    ds_read_b64_tr_b16 v[48:49], v4 offset:0
    ds_read_b64_tr_b16 v[50:51], v4 offset:1024
    v_mfma_f32_16x16x32_bf16 v[68:71], v[144:147], v[132:135], v[68:71]
    ds_read_b128 v[32:35], v2 offset:0
    ds_read_b128 v[36:39], v2 offset:2048
    v_mfma_f32_16x16x32_bf16 v[72:75], v[144:147], v[136:139], v[72:75]
    ds_read_b128 v[40:43], v2 offset:4096
    ds_read_b128 v[44:47], v2 offset:6144
    v_mfma_f32_16x16x32_bf16 v[76:79], v[144:147], v[140:143], v[76:79]
    ds_read_b64_tr_b16 v[52:53], v5 offset:0
    ds_read_b64_tr_b16 v[54:55], v5 offset:1024
    v_mfma_f32_16x16x32_bf16 v[80:83], v[148:151], v[128:131], v[80:83]
    ds_read_b64_tr_b16 v[56:57], v6 offset:0
    ds_read_b64_tr_b16 v[58:59], v6 offset:1024
    v_mfma_f32_16x16x32_bf16 v[84:87], v[148:151], v[132:135], v[84:87]
    ds_read_b64_tr_b16 v[60:61], v7 offset:0
    ds_read_b64_tr_b16 v[62:63], v7 offset:1024
    v_mfma_f32_16x16x32_bf16 v[88:91], v[148:151], v[136:139], v[88:91]
    v_mfma_f32_16x16x32_bf16 v[92:95], v[148:151], v[140:143], v[92:95]
    s_setprio 2
    v_mfma_f32_16x16x32_bf16 v[96:99], v[152:155], v[128:131], v[96:99]
    v_mfma_f32_16x16x32_bf16 v[100:103], v[152:155], v[132:135], v[100:103]
    v_mfma_f32_16x16x32_bf16 v[104:107], v[152:155], v[136:139], v[104:107]
    v_mfma_f32_16x16x32_bf16 v[108:111], v[152:155], v[140:143], v[108:111]
    v_mfma_f32_16x16x32_bf16 v[112:115], v[156:159], v[128:131], v[112:115]
    v_mfma_f32_16x16x32_bf16 v[116:119], v[156:159], v[132:135], v[116:119]
    v_mfma_f32_16x16x32_bf16 v[120:123], v[156:159], v[136:139], v[120:123]
    v_mfma_f32_16x16x32_bf16 v[124:127], v[156:159], v[140:143], v[124:127]
    s_waitcnt lgkmcnt(0)
    s_barrier
    s_setprio 0
    s_cmp_lt_u32 s12, 4
    s_cbranch_scc1 f_loTrue
    s_barrier
f_loTrue:
    v_mfma_f32_16x16x32_bf16 v[64:67], v[48:51], v[32:35], v[64:67]
    ds_read_b64_tr_b16 v[144:145], v4 offset:8192
    ds_read_b64_tr_b16 v[146:147], v4 offset:9216
    v_mfma_f32_16x16x32_bf16 v[68:71], v[48:51], v[36:39], v[68:71]
    ds_read_b128 v[128:131], v3 offset:0
    ds_read_b128 v[132:135], v3 offset:2048
    v_mfma_f32_16x16x32_bf16 v[72:75], v[48:51], v[40:43], v[72:75]
    ds_read_b128 v[136:139], v3 offset:4096
    ds_read_b128 v[140:143], v3 offset:6144
    v_mfma_f32_16x16x32_bf16 v[76:79], v[48:51], v[44:47], v[76:79]
    ds_read_b64_tr_b16 v[148:149], v5 offset:8192
    ds_read_b64_tr_b16 v[150:151], v5 offset:9216
    v_mfma_f32_16x16x32_bf16 v[80:83], v[52:55], v[32:35], v[80:83]
    ds_read_b64_tr_b16 v[152:153], v6 offset:8192
    ds_read_b64_tr_b16 v[154:155], v6 offset:9216
    v_mfma_f32_16x16x32_bf16 v[84:87], v[52:55], v[36:39], v[84:87]
    ds_read_b64_tr_b16 v[156:157], v7 offset:8192
    ds_read_b64_tr_b16 v[158:159], v7 offset:9216
    v_mfma_f32_16x16x32_bf16 v[88:91], v[52:55], v[40:43], v[88:91]
    v_add_u32 v2, 4294868992, v2
    v_add_u32 v3, 4294868992, v3
    v_mfma_f32_16x16x32_bf16 v[92:95], v[52:55], v[44:47], v[92:95]
    v_add_u32 v4, 4294868992, v4
    v_add_u32 v5, 4294868992, v5
    v_mfma_f32_16x16x32_bf16 v[96:99], v[56:59], v[32:35], v[96:99]
    v_add_u32 v6, 4294868992, v6
    v_add_u32 v7, 4294868992, v7
    v_mfma_f32_16x16x32_bf16 v[100:103], v[56:59], v[36:39], v[100:103]
    v_mfma_f32_16x16x32_bf16 v[104:107], v[56:59], v[40:43], v[104:107]
    v_mfma_f32_16x16x32_bf16 v[108:111], v[56:59], v[44:47], v[108:111]
    v_mfma_f32_16x16x32_bf16 v[112:115], v[60:63], v[32:35], v[112:115]
    v_mfma_f32_16x16x32_bf16 v[116:119], v[60:63], v[36:39], v[116:119]
    v_mfma_f32_16x16x32_bf16 v[120:123], v[60:63], v[40:43], v[120:123]
    v_mfma_f32_16x16x32_bf16 v[124:127], v[60:63], v[44:47], v[124:127]
    s_waitcnt lgkmcnt(0)
    v_mfma_f32_16x16x32_bf16 v[64:67], v[144:147], v[128:131], v[64:67]
    ds_read_b64_tr_b16 v[48:49], v4 offset:0
    ds_read_b64_tr_b16 v[50:51], v4 offset:1024
    v_mfma_f32_16x16x32_bf16 v[68:71], v[144:147], v[132:135], v[68:71]
    ds_read_b128 v[32:35], v2 offset:0
    ds_read_b128 v[36:39], v2 offset:2048
    v_mfma_f32_16x16x32_bf16 v[72:75], v[144:147], v[136:139], v[72:75]
    ds_read_b128 v[40:43], v2 offset:4096
    ds_read_b128 v[44:47], v2 offset:6144
    v_mfma_f32_16x16x32_bf16 v[76:79], v[144:147], v[140:143], v[76:79]
    ds_read_b64_tr_b16 v[52:53], v5 offset:0
    ds_read_b64_tr_b16 v[54:55], v5 offset:1024
    v_mfma_f32_16x16x32_bf16 v[80:83], v[148:151], v[128:131], v[80:83]
    ds_read_b64_tr_b16 v[56:57], v6 offset:0
    ds_read_b64_tr_b16 v[58:59], v6 offset:1024
    v_mfma_f32_16x16x32_bf16 v[84:87], v[148:151], v[132:135], v[84:87]
    ds_read_b64_tr_b16 v[60:61], v7 offset:0
    ds_read_b64_tr_b16 v[62:63], v7 offset:1024
    v_mfma_f32_16x16x32_bf16 v[88:91], v[148:151], v[136:139], v[88:91]
    v_mfma_f32_16x16x32_bf16 v[92:95], v[148:151], v[140:143], v[92:95]
    v_mfma_f32_16x16x32_bf16 v[96:99], v[152:155], v[128:131], v[96:99]
    v_mfma_f32_16x16x32_bf16 v[100:103], v[152:155], v[132:135], v[100:103]
    v_mfma_f32_16x16x32_bf16 v[104:107], v[152:155], v[136:139], v[104:107]
    v_mfma_f32_16x16x32_bf16 v[108:111], v[152:155], v[140:143], v[108:111]
    v_mfma_f32_16x16x32_bf16 v[112:115], v[156:159], v[128:131], v[112:115]
    v_mfma_f32_16x16x32_bf16 v[116:119], v[156:159], v[132:135], v[116:119]
    v_mfma_f32_16x16x32_bf16 v[120:123], v[156:159], v[136:139], v[120:123]
    v_mfma_f32_16x16x32_bf16 v[124:127], v[156:159], v[140:143], v[124:127]
    s_waitcnt lgkmcnt(0)
    v_mfma_f32_16x16x32_bf16 v[64:67], v[48:51], v[32:35], v[64:67]
    ds_read_b64_tr_b16 v[144:145], v4 offset:8192
    ds_read_b64_tr_b16 v[146:147], v4 offset:9216
    ds_read_b128 v[128:131], v3 offset:0
    v_mfma_f32_16x16x32_bf16 v[68:71], v[48:51], v[36:39], v[68:71]
    ds_read_b128 v[132:135], v3 offset:2048
    ds_read_b128 v[136:139], v3 offset:4096
    ds_read_b128 v[140:143], v3 offset:6144
    v_mfma_f32_16x16x32_bf16 v[72:75], v[48:51], v[40:43], v[72:75]
    ds_read_b64_tr_b16 v[148:149], v5 offset:8192
    ds_read_b64_tr_b16 v[150:151], v5 offset:9216
    ds_read_b64_tr_b16 v[152:153], v6 offset:8192
    v_mfma_f32_16x16x32_bf16 v[76:79], v[48:51], v[44:47], v[76:79]
    ds_read_b64_tr_b16 v[154:155], v6 offset:9216
    ds_read_b64_tr_b16 v[156:157], v7 offset:8192
    ds_read_b64_tr_b16 v[158:159], v7 offset:9216
    v_mfma_f32_16x16x32_bf16 v[80:83], v[52:55], v[32:35], v[80:83]
    v_and_b32 v12, 15, v1
    v_lshlrev_b32 v12, 2, v12
    s_lshl_b32 s40, s27, 8
    v_mfma_f32_16x16x32_bf16 v[84:87], v[52:55], v[36:39], v[84:87]
    s_add_u32 s40, s40, 148480
    v_add_u32 v12, s40, v12
    v_lshrrev_b32 v13, 4, v1
    v_mfma_f32_16x16x32_bf16 v[88:91], v[52:55], v[40:43], v[88:91]
    v_lshlrev_b32 v13, 4, v13
    s_lshr_b32 s40, s12, 1
    s_lshl_b32 s40, s40, 8
    v_mfma_f32_16x16x32_bf16 v[92:95], v[52:55], v[44:47], v[92:95]
    s_add_u32 s40, s40, 147456
    v_add_u32 v13, s40, v13
    ds_read2_b32 v[16:17], v12 offset0:0 offset1:16
    v_mfma_f32_16x16x32_bf16 v[96:99], v[56:59], v[32:35], v[96:99]
    ds_read2_b32 v[20:21], v12 offset0:128 offset1:144
    ds_read2_b32 v[18:19], v12 offset0:32 offset1:48
    ds_read2_b32 v[22:23], v12 offset0:160 offset1:176
    v_mfma_f32_16x16x32_bf16 v[100:103], v[56:59], v[36:39], v[100:103]
    ds_read_b128 v[24:27], v13 offset:0
    ds_read_b128 v[28:31], v13 offset:64
    ds_read_b128 v[160:163], v13 offset:128
    v_mfma_f32_16x16x32_bf16 v[104:107], v[56:59], v[40:43], v[104:107]
    ds_read_b128 v[164:167], v13 offset:192
    v_mfma_f32_16x16x32_bf16 v[108:111], v[56:59], v[44:47], v[108:111]
    v_mfma_f32_16x16x32_bf16 v[112:115], v[60:63], v[32:35], v[112:115]
    v_mfma_f32_16x16x32_bf16 v[116:119], v[60:63], v[36:39], v[116:119]
    v_mfma_f32_16x16x32_bf16 v[120:123], v[60:63], v[40:43], v[120:123]
    v_mfma_f32_16x16x32_bf16 v[124:127], v[60:63], v[44:47], v[124:127]
    s_waitcnt lgkmcnt(0)
    v_mfma_f32_16x16x32_bf16 v[64:67], v[144:147], v[128:131], v[64:67]
    v_mfma_f32_16x16x32_bf16 v[68:71], v[144:147], v[132:135], v[68:71]
    v_mfma_f32_16x16x32_bf16 v[72:75], v[144:147], v[136:139], v[72:75]
    v_mfma_f32_16x16x32_bf16 v[76:79], v[144:147], v[140:143], v[76:79]
    v_mfma_f32_16x16x32_bf16 v[80:83], v[148:151], v[128:131], v[80:83]
    v_mfma_f32_16x16x32_bf16 v[84:87], v[148:151], v[132:135], v[84:87]
    v_mfma_f32_16x16x32_bf16 v[88:91], v[148:151], v[136:139], v[88:91]
    v_mfma_f32_16x16x32_bf16 v[92:95], v[148:151], v[140:143], v[92:95]
    v_mfma_f32_16x16x32_bf16 v[96:99], v[152:155], v[128:131], v[96:99]
    v_mfma_f32_16x16x32_bf16 v[100:103], v[152:155], v[132:135], v[100:103]
    v_mfma_f32_16x16x32_bf16 v[104:107], v[152:155], v[136:139], v[104:107]
    v_mfma_f32_16x16x32_bf16 v[108:111], v[152:155], v[140:143], v[108:111]
    v_mfma_f32_16x16x32_bf16 v[112:115], v[156:159], v[128:131], v[112:115]
    v_mfma_f32_16x16x32_bf16 v[116:119], v[156:159], v[132:135], v[116:119]
    v_mfma_f32_16x16x32_bf16 v[120:123], v[156:159], v[136:139], v[120:123]
    v_mfma_f32_16x16x32_bf16 v[124:127], v[156:159], v[140:143], v[124:127]
    s_cmp_eq_u32 s29, 1
    s_cbranch_scc1 L_f_fpart_7
    v_mul_f32 v20, s31, v20
    v_mul_f32 v21, s31, v21
    v_mul_f32 v22, s31, v22
    v_mul_f32 v23, s31, v23
    v_pk_fma_f32 v[64:65], v[16:17], v[24:25], v[64:65] op_sel:[0,0,0] op_sel_hi:[0,1,1]
    v_pk_fma_f32 v[66:67], v[16:17], v[26:27], v[66:67] op_sel:[0,0,0] op_sel_hi:[0,1,1]
    v_pk_fma_f32 v[68:69], v[16:17], v[24:25], v[68:69] op_sel:[1,0,0] op_sel_hi:[1,1,1]
    v_pk_fma_f32 v[70:71], v[16:17], v[26:27], v[70:71] op_sel:[1,0,0] op_sel_hi:[1,1,1]
    v_pk_fma_f32 v[80:81], v[16:17], v[28:29], v[80:81] op_sel:[0,0,0] op_sel_hi:[0,1,1]
    v_pk_fma_f32 v[82:83], v[16:17], v[30:31], v[82:83] op_sel:[0,0,0] op_sel_hi:[0,1,1]
    v_pk_fma_f32 v[84:85], v[16:17], v[28:29], v[84:85] op_sel:[1,0,0] op_sel_hi:[1,1,1]
    v_pk_fma_f32 v[86:87], v[16:17], v[30:31], v[86:87] op_sel:[1,0,0] op_sel_hi:[1,1,1]
    v_pk_mul_f32 v[64:65], v[20:21], v[64:65] op_sel:[0,0] op_sel_hi:[0,1]
    v_pk_mul_f32 v[66:67], v[20:21], v[66:67] op_sel:[0,0] op_sel_hi:[0,1]
    v_pk_mul_f32 v[68:69], v[20:21], v[68:69] op_sel:[1,0] op_sel_hi:[1,1]
    v_pk_mul_f32 v[70:71], v[20:21], v[70:71] op_sel:[1,0] op_sel_hi:[1,1]
    v_pk_mul_f32 v[80:81], v[20:21], v[80:81] op_sel:[0,0] op_sel_hi:[0,1]
    v_pk_mul_f32 v[82:83], v[20:21], v[82:83] op_sel:[0,0] op_sel_hi:[0,1]
    v_pk_mul_f32 v[84:85], v[20:21], v[84:85] op_sel:[1,0] op_sel_hi:[1,1]
    v_pk_mul_f32 v[86:87], v[20:21], v[86:87] op_sel:[1,0] op_sel_hi:[1,1]
    v_cvt_pk_bf16_f32 v64, v64, v65
    v_cvt_pk_bf16_f32 v65, v66, v67
    ds_write_b64 v8, v[64:65] offset:0
    v_cvt_pk_bf16_f32 v68, v68, v69
    v_cvt_pk_bf16_f32 v69, v70, v71
    ds_write_b64 v8, v[68:69] offset:128
    v_cvt_pk_bf16_f32 v80, v80, v81
    v_cvt_pk_bf16_f32 v81, v82, v83
    ds_write_b64 v8, v[80:81] offset:1024
    v_cvt_pk_bf16_f32 v84, v84, v85
    v_cvt_pk_bf16_f32 v85, v86, v87
    ds_write_b64 v8, v[84:85] offset:1152
    ds_read_b128 v[128:131], v10 offset:0
    ds_read_b128 v[132:135], v10 offset:1024
    v_pk_fma_f32 v[96:97], v[16:17], v[160:161], v[96:97] op_sel:[0,0,0] op_sel_hi:[0,1,1]
    v_pk_fma_f32 v[98:99], v[16:17], v[162:163], v[98:99] op_sel:[0,0,0] op_sel_hi:[0,1,1]
    v_pk_fma_f32 v[100:101], v[16:17], v[160:161], v[100:101] op_sel:[1,0,0] op_sel_hi:[1,1,1]
    v_pk_fma_f32 v[102:103], v[16:17], v[162:163], v[102:103] op_sel:[1,0,0] op_sel_hi:[1,1,1]
    v_pk_fma_f32 v[112:113], v[16:17], v[164:165], v[112:113] op_sel:[0,0,0] op_sel_hi:[0,1,1]
    v_pk_fma_f32 v[114:115], v[16:17], v[166:167], v[114:115] op_sel:[0,0,0] op_sel_hi:[0,1,1]
    v_pk_fma_f32 v[116:117], v[16:17], v[164:165], v[116:117] op_sel:[1,0,0] op_sel_hi:[1,1,1]
    v_pk_fma_f32 v[118:119], v[16:17], v[166:167], v[118:119] op_sel:[1,0,0] op_sel_hi:[1,1,1]
    v_pk_mul_f32 v[96:97], v[20:21], v[96:97] op_sel:[0,0] op_sel_hi:[0,1]
    v_pk_mul_f32 v[98:99], v[20:21], v[98:99] op_sel:[0,0] op_sel_hi:[0,1]
    v_pk_mul_f32 v[100:101], v[20:21], v[100:101] op_sel:[1,0] op_sel_hi:[1,1]
    v_pk_mul_f32 v[102:103], v[20:21], v[102:103] op_sel:[1,0] op_sel_hi:[1,1]
    v_pk_mul_f32 v[112:113], v[20:21], v[112:113] op_sel:[0,0] op_sel_hi:[0,1]
    v_pk_mul_f32 v[114:115], v[20:21], v[114:115] op_sel:[0,0] op_sel_hi:[0,1]
    v_pk_mul_f32 v[116:117], v[20:21], v[116:117] op_sel:[1,0] op_sel_hi:[1,1]
    v_pk_mul_f32 v[118:119], v[20:21], v[118:119] op_sel:[1,0] op_sel_hi:[1,1]
    s_waitcnt lgkmcnt(0)
    buffer_store_dwordx4 v[128:131], v9, s[8:11], s33 offen offset:0 sc1
    buffer_store_dwordx4 v[132:135], v9, s[8:11], s33 offen offset:1024 sc1
    v_cvt_pk_bf16_f32 v96, v96, v97
    v_cvt_pk_bf16_f32 v97, v98, v99
    ds_write_b64 v8, v[96:97] offset:0
    v_cvt_pk_bf16_f32 v100, v100, v101
    v_cvt_pk_bf16_f32 v101, v102, v103
    ds_write_b64 v8, v[100:101] offset:128
    v_cvt_pk_bf16_f32 v112, v112, v113
    v_cvt_pk_bf16_f32 v113, v114, v115
    ds_write_b64 v8, v[112:113] offset:1024
    v_cvt_pk_bf16_f32 v116, v116, v117
    v_cvt_pk_bf16_f32 v117, v118, v119
    ds_write_b64 v8, v[116:117] offset:1152
    ds_read_b128 v[136:139], v10 offset:0
    ds_read_b128 v[140:143], v10 offset:1024
    v_pk_fma_f32 v[72:73], v[18:19], v[24:25], v[72:73] op_sel:[0,0,0] op_sel_hi:[0,1,1]
    v_pk_fma_f32 v[74:75], v[18:19], v[26:27], v[74:75] op_sel:[0,0,0] op_sel_hi:[0,1,1]
    v_pk_fma_f32 v[76:77], v[18:19], v[24:25], v[76:77] op_sel:[1,0,0] op_sel_hi:[1,1,1]
    v_pk_fma_f32 v[78:79], v[18:19], v[26:27], v[78:79] op_sel:[1,0,0] op_sel_hi:[1,1,1]
    v_pk_fma_f32 v[88:89], v[18:19], v[28:29], v[88:89] op_sel:[0,0,0] op_sel_hi:[0,1,1]
    v_pk_fma_f32 v[90:91], v[18:19], v[30:31], v[90:91] op_sel:[0,0,0] op_sel_hi:[0,1,1]
    v_pk_fma_f32 v[92:93], v[18:19], v[28:29], v[92:93] op_sel:[1,0,0] op_sel_hi:[1,1,1]
    v_pk_fma_f32 v[94:95], v[18:19], v[30:31], v[94:95] op_sel:[1,0,0] op_sel_hi:[1,1,1]
    v_pk_mul_f32 v[72:73], v[22:23], v[72:73] op_sel:[0,0] op_sel_hi:[0,1]
    v_pk_mul_f32 v[74:75], v[22:23], v[74:75] op_sel:[0,0] op_sel_hi:[0,1]
    v_pk_mul_f32 v[76:77], v[22:23], v[76:77] op_sel:[1,0] op_sel_hi:[1,1]
    v_pk_mul_f32 v[78:79], v[22:23], v[78:79] op_sel:[1,0] op_sel_hi:[1,1]
    v_pk_mul_f32 v[88:89], v[22:23], v[88:89] op_sel:[0,0] op_sel_hi:[0,1]
    v_pk_mul_f32 v[90:91], v[22:23], v[90:91] op_sel:[0,0] op_sel_hi:[0,1]
    v_pk_mul_f32 v[92:93], v[22:23], v[92:93] op_sel:[1,0] op_sel_hi:[1,1]
    v_pk_mul_f32 v[94:95], v[22:23], v[94:95] op_sel:[1,0] op_sel_hi:[1,1]
    s_waitcnt lgkmcnt(0)
    buffer_store_dwordx4 v[136:139], v9, s[8:11], s33 offen offset:2048 sc1
    buffer_store_dwordx4 v[140:143], v9, s[8:11], s33 offen offset:3072 sc1
    v_cvt_pk_bf16_f32 v72, v72, v73
    v_cvt_pk_bf16_f32 v73, v74, v75
    ds_write_b64 v8, v[72:73] offset:0
    v_cvt_pk_bf16_f32 v76, v76, v77
    v_cvt_pk_bf16_f32 v77, v78, v79
    ds_write_b64 v8, v[76:77] offset:128
    v_cvt_pk_bf16_f32 v88, v88, v89
    v_cvt_pk_bf16_f32 v89, v90, v91
    ds_write_b64 v8, v[88:89] offset:1024
    v_cvt_pk_bf16_f32 v92, v92, v93
    v_cvt_pk_bf16_f32 v93, v94, v95
    ds_write_b64 v8, v[92:93] offset:1152
    ds_read_b128 v[144:147], v10 offset:0
    ds_read_b128 v[148:151], v10 offset:1024
    v_pk_fma_f32 v[104:105], v[18:19], v[160:161], v[104:105] op_sel:[0,0,0] op_sel_hi:[0,1,1]
    v_pk_fma_f32 v[106:107], v[18:19], v[162:163], v[106:107] op_sel:[0,0,0] op_sel_hi:[0,1,1]
    v_pk_fma_f32 v[108:109], v[18:19], v[160:161], v[108:109] op_sel:[1,0,0] op_sel_hi:[1,1,1]
    v_pk_fma_f32 v[110:111], v[18:19], v[162:163], v[110:111] op_sel:[1,0,0] op_sel_hi:[1,1,1]
    v_pk_fma_f32 v[120:121], v[18:19], v[164:165], v[120:121] op_sel:[0,0,0] op_sel_hi:[0,1,1]
    v_pk_fma_f32 v[122:123], v[18:19], v[166:167], v[122:123] op_sel:[0,0,0] op_sel_hi:[0,1,1]
    v_pk_fma_f32 v[124:125], v[18:19], v[164:165], v[124:125] op_sel:[1,0,0] op_sel_hi:[1,1,1]
    v_pk_fma_f32 v[126:127], v[18:19], v[166:167], v[126:127] op_sel:[1,0,0] op_sel_hi:[1,1,1]
    v_pk_mul_f32 v[104:105], v[22:23], v[104:105] op_sel:[0,0] op_sel_hi:[0,1]
    v_pk_mul_f32 v[106:107], v[22:23], v[106:107] op_sel:[0,0] op_sel_hi:[0,1]
    v_pk_mul_f32 v[108:109], v[22:23], v[108:109] op_sel:[1,0] op_sel_hi:[1,1]
    v_pk_mul_f32 v[110:111], v[22:23], v[110:111] op_sel:[1,0] op_sel_hi:[1,1]
    v_pk_mul_f32 v[120:121], v[22:23], v[120:121] op_sel:[0,0] op_sel_hi:[0,1]
    v_pk_mul_f32 v[122:123], v[22:23], v[122:123] op_sel:[0,0] op_sel_hi:[0,1]
    v_pk_mul_f32 v[124:125], v[22:23], v[124:125] op_sel:[1,0] op_sel_hi:[1,1]
    v_pk_mul_f32 v[126:127], v[22:23], v[126:127] op_sel:[1,0] op_sel_hi:[1,1]
    s_waitcnt lgkmcnt(0)
    buffer_store_dwordx4 v[144:147], v9, s[8:11], s34 offen offset:0 sc1
    buffer_store_dwordx4 v[148:151], v9, s[8:11], s34 offen offset:1024 sc1
    v_cvt_pk_bf16_f32 v104, v104, v105
    v_cvt_pk_bf16_f32 v105, v106, v107
    ds_write_b64 v8, v[104:105] offset:0
    v_cvt_pk_bf16_f32 v108, v108, v109
    v_cvt_pk_bf16_f32 v109, v110, v111
    ds_write_b64 v8, v[108:109] offset:128
    v_cvt_pk_bf16_f32 v120, v120, v121
    v_cvt_pk_bf16_f32 v121, v122, v123
    ds_write_b64 v8, v[120:121] offset:1024
    v_cvt_pk_bf16_f32 v124, v124, v125
    v_cvt_pk_bf16_f32 v125, v126, v127
    ds_write_b64 v8, v[124:125] offset:1152
    ds_read_b128 v[152:155], v10 offset:0
    ds_read_b128 v[156:159], v10 offset:1024
    s_waitcnt lgkmcnt(0)
    buffer_store_dwordx4 v[152:155], v9, s[8:11], s34 offen offset:2048 sc1
    buffer_store_dwordx4 v[156:159], v9, s[8:11], s34 offen offset:3072 sc1
    s_barrier
    v_mov_b32 v12, s13
    v_mov_b32 v13, 0
    s_waitcnt vmcnt(0)
    s_mov_b64 exec, 1
    buffer_store_dword v12, v13, s[8:11], s32 offen sc1
    s_mov_b64 exec, -1
    s_setprio 0
    s_barrier
    s_branch L_f_adone_2
L_f_fpart_7:
    s_lshl_b32 s42, s24, 1
    s_add_u32 s42, s42, s27
    s_mul_i32 s42, s42, 221184
    s_lshl_b32 s40, s25, 1
    s_add_u32 s40, s40, s28
    s_lshl_b32 s43, s40, 12
    s_add_u32 s41, s43, s42
    s_add_u32 s61, s41, 7864320
    s_mov_b32 s43, 0xbfb8aa3b
    s_lshl_b32 s60, s25, 4
    s_add_u32 s60, s60, s24
    s_lshl_b32 s60, s60, 5
    s_add_u32 s60, s60, s12
    s_lshl_b32 s60, s60, 2
    s_add_u32 s60, s60, 28491776
    v_mov_b32 v12, s43
    v_mul_f32 v20, s43, v20
    v_mul_f32 v21, s43, v21
    v_mul_f32 v22, s43, v22
    v_mul_f32 v23, s43, v23
    v_pk_fma_f32 v[64:65], v[16:17], v[24:25], v[64:65] op_sel:[0,0,0] op_sel_hi:[0,1,1]
    v_pk_fma_f32 v[66:67], v[16:17], v[26:27], v[66:67] op_sel:[0,0,0] op_sel_hi:[0,1,1]
    v_pk_fma_f32 v[80:81], v[16:17], v[28:29], v[80:81] op_sel:[0,0,0] op_sel_hi:[0,1,1]
    v_pk_fma_f32 v[82:83], v[16:17], v[30:31], v[82:83] op_sel:[0,0,0] op_sel_hi:[0,1,1]
    v_pk_mul_f32 v[64:65], v[20:21], v[64:65] op_sel:[0,0] op_sel_hi:[0,1]
    v_pk_mul_f32 v[66:67], v[20:21], v[66:67] op_sel:[0,0] op_sel_hi:[0,1]
    v_pk_mul_f32 v[80:81], v[20:21], v[80:81] op_sel:[0,0] op_sel_hi:[0,1]
    v_pk_mul_f32 v[82:83], v[20:21], v[82:83] op_sel:[0,0] op_sel_hi:[0,1]
    v_exp_f32 v32, v64
    v_exp_f32 v33, v65
    v_exp_f32 v34, v66
    v_exp_f32 v35, v67
    v_exp_f32 v36, v80
    v_exp_f32 v37, v81
    v_exp_f32 v38, v82
    v_exp_f32 v39, v83
    v_pk_fma_f32 v[32:33], v[32:33], v[12:13], v[12:13] op_sel_hi:[1,0,0]
    v_pk_fma_f32 v[34:35], v[34:35], v[12:13], v[12:13] op_sel_hi:[1,0,0]
    v_pk_fma_f32 v[36:37], v[36:37], v[12:13], v[12:13] op_sel_hi:[1,0,0]
    v_pk_fma_f32 v[38:39], v[38:39], v[12:13], v[12:13] op_sel_hi:[1,0,0]
    v_rcp_f32 v32, v32
    v_rcp_f32 v33, v33
    v_rcp_f32 v34, v34
    v_rcp_f32 v35, v35
    v_rcp_f32 v36, v36
    v_rcp_f32 v37, v37
    v_rcp_f32 v38, v38
    v_rcp_f32 v39, v39
    v_pk_mul_f32 v[64:65], v[64:65], v[32:33]
    v_pk_mul_f32 v[66:67], v[66:67], v[34:35]
    v_pk_mul_f32 v[80:81], v[80:81], v[36:37]
    v_pk_mul_f32 v[82:83], v[82:83], v[38:39]
    v_cvt_pk_bf16_f32 v128, v64, v65
    v_cvt_pk_bf16_f32 v129, v66, v67
    v_cvt_pk_bf16_f32 v130, v80, v81
    v_cvt_pk_bf16_f32 v131, v82, v83
    v_pk_fma_f32 v[68:69], v[16:17], v[24:25], v[68:69] op_sel:[1,0,0] op_sel_hi:[1,1,1]
    v_pk_fma_f32 v[70:71], v[16:17], v[26:27], v[70:71] op_sel:[1,0,0] op_sel_hi:[1,1,1]
    v_pk_fma_f32 v[84:85], v[16:17], v[28:29], v[84:85] op_sel:[1,0,0] op_sel_hi:[1,1,1]
    v_pk_fma_f32 v[86:87], v[16:17], v[30:31], v[86:87] op_sel:[1,0,0] op_sel_hi:[1,1,1]
    v_pk_mul_f32 v[68:69], v[20:21], v[68:69] op_sel:[1,0] op_sel_hi:[1,1]
    v_pk_mul_f32 v[70:71], v[20:21], v[70:71] op_sel:[1,0] op_sel_hi:[1,1]
    v_pk_mul_f32 v[84:85], v[20:21], v[84:85] op_sel:[1,0] op_sel_hi:[1,1]
    v_pk_mul_f32 v[86:87], v[20:21], v[86:87] op_sel:[1,0] op_sel_hi:[1,1]
    v_exp_f32 v32, v68
    v_exp_f32 v33, v69
    v_exp_f32 v34, v70
    v_exp_f32 v35, v71
    v_exp_f32 v36, v84
    v_exp_f32 v37, v85
    v_exp_f32 v38, v86
    v_exp_f32 v39, v87
    v_pk_fma_f32 v[32:33], v[32:33], v[12:13], v[12:13] op_sel_hi:[1,0,0]
    v_pk_fma_f32 v[34:35], v[34:35], v[12:13], v[12:13] op_sel_hi:[1,0,0]
    v_pk_fma_f32 v[36:37], v[36:37], v[12:13], v[12:13] op_sel_hi:[1,0,0]
    v_pk_fma_f32 v[38:39], v[38:39], v[12:13], v[12:13] op_sel_hi:[1,0,0]
    v_rcp_f32 v32, v32
    v_rcp_f32 v33, v33
    v_rcp_f32 v34, v34
    v_rcp_f32 v35, v35
    v_rcp_f32 v36, v36
    v_rcp_f32 v37, v37
    v_rcp_f32 v38, v38
    v_rcp_f32 v39, v39
    v_pk_mul_f32 v[68:69], v[68:69], v[32:33]
    v_pk_mul_f32 v[70:71], v[70:71], v[34:35]
    v_pk_mul_f32 v[84:85], v[84:85], v[36:37]
    v_pk_mul_f32 v[86:87], v[86:87], v[38:39]
    v_cvt_pk_bf16_f32 v132, v68, v69
    v_cvt_pk_bf16_f32 v133, v70, v71
    v_cvt_pk_bf16_f32 v134, v84, v85
    v_cvt_pk_bf16_f32 v135, v86, v87
    v_pk_fma_f32 v[72:73], v[18:19], v[24:25], v[72:73] op_sel:[0,0,0] op_sel_hi:[0,1,1]
    v_pk_fma_f32 v[74:75], v[18:19], v[26:27], v[74:75] op_sel:[0,0,0] op_sel_hi:[0,1,1]
    v_pk_fma_f32 v[88:89], v[18:19], v[28:29], v[88:89] op_sel:[0,0,0] op_sel_hi:[0,1,1]
    v_pk_fma_f32 v[90:91], v[18:19], v[30:31], v[90:91] op_sel:[0,0,0] op_sel_hi:[0,1,1]
    v_pk_mul_f32 v[72:73], v[22:23], v[72:73] op_sel:[0,0] op_sel_hi:[0,1]
    v_pk_mul_f32 v[74:75], v[22:23], v[74:75] op_sel:[0,0] op_sel_hi:[0,1]
    v_pk_mul_f32 v[88:89], v[22:23], v[88:89] op_sel:[0,0] op_sel_hi:[0,1]
    v_pk_mul_f32 v[90:91], v[22:23], v[90:91] op_sel:[0,0] op_sel_hi:[0,1]
    v_exp_f32 v32, v72
    v_exp_f32 v33, v73
    v_exp_f32 v34, v74
    v_exp_f32 v35, v75
    v_exp_f32 v36, v88
    v_exp_f32 v37, v89
    v_exp_f32 v38, v90
    v_exp_f32 v39, v91
    v_pk_fma_f32 v[32:33], v[32:33], v[12:13], v[12:13] op_sel_hi:[1,0,0]
    v_pk_fma_f32 v[34:35], v[34:35], v[12:13], v[12:13] op_sel_hi:[1,0,0]
    v_pk_fma_f32 v[36:37], v[36:37], v[12:13], v[12:13] op_sel_hi:[1,0,0]
    v_pk_fma_f32 v[38:39], v[38:39], v[12:13], v[12:13] op_sel_hi:[1,0,0]
    v_rcp_f32 v32, v32
    v_rcp_f32 v33, v33
    v_rcp_f32 v34, v34
    v_rcp_f32 v35, v35
    v_rcp_f32 v36, v36
    v_rcp_f32 v37, v37
    v_rcp_f32 v38, v38
    v_rcp_f32 v39, v39
    v_pk_mul_f32 v[72:73], v[72:73], v[32:33]
    v_pk_mul_f32 v[74:75], v[74:75], v[34:35]
    v_pk_mul_f32 v[88:89], v[88:89], v[36:37]
    v_pk_mul_f32 v[90:91], v[90:91], v[38:39]
    v_cvt_pk_bf16_f32 v136, v72, v73
    v_cvt_pk_bf16_f32 v137, v74, v75
    v_cvt_pk_bf16_f32 v138, v88, v89
    v_cvt_pk_bf16_f32 v139, v90, v91
    v_pk_fma_f32 v[76:77], v[18:19], v[24:25], v[76:77] op_sel:[1,0,0] op_sel_hi:[1,1,1]
    v_pk_fma_f32 v[78:79], v[18:19], v[26:27], v[78:79] op_sel:[1,0,0] op_sel_hi:[1,1,1]
    v_pk_fma_f32 v[92:93], v[18:19], v[28:29], v[92:93] op_sel:[1,0,0] op_sel_hi:[1,1,1]
    v_pk_fma_f32 v[94:95], v[18:19], v[30:31], v[94:95] op_sel:[1,0,0] op_sel_hi:[1,1,1]
    v_pk_mul_f32 v[76:77], v[22:23], v[76:77] op_sel:[1,0] op_sel_hi:[1,1]
    v_pk_mul_f32 v[78:79], v[22:23], v[78:79] op_sel:[1,0] op_sel_hi:[1,1]
    v_pk_mul_f32 v[92:93], v[22:23], v[92:93] op_sel:[1,0] op_sel_hi:[1,1]
    v_pk_mul_f32 v[94:95], v[22:23], v[94:95] op_sel:[1,0] op_sel_hi:[1,1]
    v_exp_f32 v32, v76
    v_exp_f32 v33, v77
    v_exp_f32 v34, v78
    v_exp_f32 v35, v79
    v_exp_f32 v36, v92
    v_exp_f32 v37, v93
    v_exp_f32 v38, v94
    v_exp_f32 v39, v95
    v_pk_fma_f32 v[32:33], v[32:33], v[12:13], v[12:13] op_sel_hi:[1,0,0]
    v_pk_fma_f32 v[34:35], v[34:35], v[12:13], v[12:13] op_sel_hi:[1,0,0]
    v_pk_fma_f32 v[36:37], v[36:37], v[12:13], v[12:13] op_sel_hi:[1,0,0]
    v_pk_fma_f32 v[38:39], v[38:39], v[12:13], v[12:13] op_sel_hi:[1,0,0]
    v_rcp_f32 v32, v32
    v_rcp_f32 v33, v33
    v_rcp_f32 v34, v34
    v_rcp_f32 v35, v35
    v_rcp_f32 v36, v36
    v_rcp_f32 v37, v37
    v_rcp_f32 v38, v38
    v_rcp_f32 v39, v39
    v_pk_mul_f32 v[76:77], v[76:77], v[32:33]
    v_pk_mul_f32 v[78:79], v[78:79], v[34:35]
    v_pk_mul_f32 v[92:93], v[92:93], v[36:37]
    v_pk_mul_f32 v[94:95], v[94:95], v[38:39]
    v_cvt_pk_bf16_f32 v140, v76, v77
    v_cvt_pk_bf16_f32 v141, v78, v79
    v_cvt_pk_bf16_f32 v142, v92, v93
    v_cvt_pk_bf16_f32 v143, v94, v95
    s_barrier
    v_pk_fma_f32 v[96:97], v[16:17], v[160:161], v[96:97] op_sel:[0,0,0] op_sel_hi:[0,1,1]
    v_pk_fma_f32 v[98:99], v[16:17], v[162:163], v[98:99] op_sel:[0,0,0] op_sel_hi:[0,1,1]
    v_pk_fma_f32 v[112:113], v[16:17], v[164:165], v[112:113] op_sel:[0,0,0] op_sel_hi:[0,1,1]
    v_pk_fma_f32 v[114:115], v[16:17], v[166:167], v[114:115] op_sel:[0,0,0] op_sel_hi:[0,1,1]
    v_pk_mul_f32 v[96:97], v[20:21], v[96:97] op_sel:[0,0] op_sel_hi:[0,1]
    v_pk_mul_f32 v[98:99], v[20:21], v[98:99] op_sel:[0,0] op_sel_hi:[0,1]
    v_pk_mul_f32 v[112:113], v[20:21], v[112:113] op_sel:[0,0] op_sel_hi:[0,1]
    v_pk_mul_f32 v[114:115], v[20:21], v[114:115] op_sel:[0,0] op_sel_hi:[0,1]
    v_exp_f32 v32, v96
    v_exp_f32 v33, v97
    v_exp_f32 v34, v98
    v_exp_f32 v35, v99
    v_exp_f32 v36, v112
    v_exp_f32 v37, v113
    v_exp_f32 v38, v114
    v_exp_f32 v39, v115
    v_pk_fma_f32 v[32:33], v[32:33], v[12:13], v[12:13] op_sel_hi:[1,0,0]
    v_pk_fma_f32 v[34:35], v[34:35], v[12:13], v[12:13] op_sel_hi:[1,0,0]
    v_pk_fma_f32 v[36:37], v[36:37], v[12:13], v[12:13] op_sel_hi:[1,0,0]
    v_pk_fma_f32 v[38:39], v[38:39], v[12:13], v[12:13] op_sel_hi:[1,0,0]
    v_rcp_f32 v32, v32
    v_rcp_f32 v33, v33
    v_rcp_f32 v34, v34
    v_rcp_f32 v35, v35
    v_rcp_f32 v36, v36
    v_rcp_f32 v37, v37
    v_rcp_f32 v38, v38
    v_rcp_f32 v39, v39
    v_pk_mul_f32 v[96:97], v[96:97], v[32:33]
    v_pk_mul_f32 v[98:99], v[98:99], v[34:35]
    v_pk_mul_f32 v[112:113], v[112:113], v[36:37]
    v_pk_mul_f32 v[114:115], v[114:115], v[38:39]
    v_cvt_pk_bf16_f32 v144, v96, v97
    v_cvt_pk_bf16_f32 v145, v98, v99
    v_cvt_pk_bf16_f32 v146, v112, v113
    v_cvt_pk_bf16_f32 v147, v114, v115
    v_pk_fma_f32 v[100:101], v[16:17], v[160:161], v[100:101] op_sel:[1,0,0] op_sel_hi:[1,1,1]
    v_pk_fma_f32 v[102:103], v[16:17], v[162:163], v[102:103] op_sel:[1,0,0] op_sel_hi:[1,1,1]
    v_pk_fma_f32 v[116:117], v[16:17], v[164:165], v[116:117] op_sel:[1,0,0] op_sel_hi:[1,1,1]
    v_pk_fma_f32 v[118:119], v[16:17], v[166:167], v[118:119] op_sel:[1,0,0] op_sel_hi:[1,1,1]
    v_pk_mul_f32 v[100:101], v[20:21], v[100:101] op_sel:[1,0] op_sel_hi:[1,1]
    v_pk_mul_f32 v[102:103], v[20:21], v[102:103] op_sel:[1,0] op_sel_hi:[1,1]
    v_pk_mul_f32 v[116:117], v[20:21], v[116:117] op_sel:[1,0] op_sel_hi:[1,1]
    v_pk_mul_f32 v[118:119], v[20:21], v[118:119] op_sel:[1,0] op_sel_hi:[1,1]
    v_exp_f32 v32, v100
    v_exp_f32 v33, v101
    v_exp_f32 v34, v102
    v_exp_f32 v35, v103
    v_exp_f32 v36, v116
    v_exp_f32 v37, v117
    v_exp_f32 v38, v118
    v_exp_f32 v39, v119
    v_pk_fma_f32 v[32:33], v[32:33], v[12:13], v[12:13] op_sel_hi:[1,0,0]
    v_pk_fma_f32 v[34:35], v[34:35], v[12:13], v[12:13] op_sel_hi:[1,0,0]
    v_pk_fma_f32 v[36:37], v[36:37], v[12:13], v[12:13] op_sel_hi:[1,0,0]
    v_pk_fma_f32 v[38:39], v[38:39], v[12:13], v[12:13] op_sel_hi:[1,0,0]
    v_rcp_f32 v32, v32
    v_rcp_f32 v33, v33
    v_rcp_f32 v34, v34
    v_rcp_f32 v35, v35
    v_rcp_f32 v36, v36
    v_rcp_f32 v37, v37
    v_rcp_f32 v38, v38
    v_rcp_f32 v39, v39
    v_pk_mul_f32 v[100:101], v[100:101], v[32:33]
    v_pk_mul_f32 v[102:103], v[102:103], v[34:35]
    v_pk_mul_f32 v[116:117], v[116:117], v[36:37]
    v_pk_mul_f32 v[118:119], v[118:119], v[38:39]
    v_cvt_pk_bf16_f32 v148, v100, v101
    v_cvt_pk_bf16_f32 v149, v102, v103
    v_cvt_pk_bf16_f32 v150, v116, v117
    v_cvt_pk_bf16_f32 v151, v118, v119
    v_pk_fma_f32 v[104:105], v[18:19], v[160:161], v[104:105] op_sel:[0,0,0] op_sel_hi:[0,1,1]
    v_pk_fma_f32 v[106:107], v[18:19], v[162:163], v[106:107] op_sel:[0,0,0] op_sel_hi:[0,1,1]
    v_pk_fma_f32 v[120:121], v[18:19], v[164:165], v[120:121] op_sel:[0,0,0] op_sel_hi:[0,1,1]
    v_pk_fma_f32 v[122:123], v[18:19], v[166:167], v[122:123] op_sel:[0,0,0] op_sel_hi:[0,1,1]
    v_pk_mul_f32 v[104:105], v[22:23], v[104:105] op_sel:[0,0] op_sel_hi:[0,1]
    v_pk_mul_f32 v[106:107], v[22:23], v[106:107] op_sel:[0,0] op_sel_hi:[0,1]
    v_pk_mul_f32 v[120:121], v[22:23], v[120:121] op_sel:[0,0] op_sel_hi:[0,1]
    v_pk_mul_f32 v[122:123], v[22:23], v[122:123] op_sel:[0,0] op_sel_hi:[0,1]
    v_exp_f32 v32, v104
    v_exp_f32 v33, v105
    v_exp_f32 v34, v106
    v_exp_f32 v35, v107
    v_exp_f32 v36, v120
    v_exp_f32 v37, v121
    v_exp_f32 v38, v122
    v_exp_f32 v39, v123
    v_pk_fma_f32 v[32:33], v[32:33], v[12:13], v[12:13] op_sel_hi:[1,0,0]
    v_pk_fma_f32 v[34:35], v[34:35], v[12:13], v[12:13] op_sel_hi:[1,0,0]
    v_pk_fma_f32 v[36:37], v[36:37], v[12:13], v[12:13] op_sel_hi:[1,0,0]
    v_pk_fma_f32 v[38:39], v[38:39], v[12:13], v[12:13] op_sel_hi:[1,0,0]
    v_rcp_f32 v32, v32
    v_rcp_f32 v33, v33
    v_rcp_f32 v34, v34
    v_rcp_f32 v35, v35
    v_rcp_f32 v36, v36
    v_rcp_f32 v37, v37
    v_rcp_f32 v38, v38
    v_rcp_f32 v39, v39
    v_pk_mul_f32 v[104:105], v[104:105], v[32:33]
    v_pk_mul_f32 v[106:107], v[106:107], v[34:35]
    v_pk_mul_f32 v[120:121], v[120:121], v[36:37]
    v_pk_mul_f32 v[122:123], v[122:123], v[38:39]
    v_cvt_pk_bf16_f32 v152, v104, v105
    v_cvt_pk_bf16_f32 v153, v106, v107
    v_cvt_pk_bf16_f32 v154, v120, v121
    v_cvt_pk_bf16_f32 v155, v122, v123
    v_pk_fma_f32 v[108:109], v[18:19], v[160:161], v[108:109] op_sel:[1,0,0] op_sel_hi:[1,1,1]
    v_pk_fma_f32 v[110:111], v[18:19], v[162:163], v[110:111] op_sel:[1,0,0] op_sel_hi:[1,1,1]
    v_pk_fma_f32 v[124:125], v[18:19], v[164:165], v[124:125] op_sel:[1,0,0] op_sel_hi:[1,1,1]
    v_pk_fma_f32 v[126:127], v[18:19], v[166:167], v[126:127] op_sel:[1,0,0] op_sel_hi:[1,1,1]
    v_pk_mul_f32 v[108:109], v[22:23], v[108:109] op_sel:[1,0] op_sel_hi:[1,1]
    v_pk_mul_f32 v[110:111], v[22:23], v[110:111] op_sel:[1,0] op_sel_hi:[1,1]
    v_pk_mul_f32 v[124:125], v[22:23], v[124:125] op_sel:[1,0] op_sel_hi:[1,1]
    v_pk_mul_f32 v[126:127], v[22:23], v[126:127] op_sel:[1,0] op_sel_hi:[1,1]
    v_exp_f32 v32, v108
    v_exp_f32 v33, v109
    v_exp_f32 v34, v110
    v_exp_f32 v35, v111
    v_exp_f32 v36, v124
    v_exp_f32 v37, v125
    v_exp_f32 v38, v126
    v_exp_f32 v39, v127
    v_pk_fma_f32 v[32:33], v[32:33], v[12:13], v[12:13] op_sel_hi:[1,0,0]
    v_pk_fma_f32 v[34:35], v[34:35], v[12:13], v[12:13] op_sel_hi:[1,0,0]
    v_pk_fma_f32 v[36:37], v[36:37], v[12:13], v[12:13] op_sel_hi:[1,0,0]
    v_pk_fma_f32 v[38:39], v[38:39], v[12:13], v[12:13] op_sel_hi:[1,0,0]
    v_rcp_f32 v32, v32
    v_rcp_f32 v33, v33
    v_rcp_f32 v34, v34
    v_rcp_f32 v35, v35
    v_rcp_f32 v36, v36
    v_rcp_f32 v37, v37
    v_rcp_f32 v38, v38
    v_rcp_f32 v39, v39
    v_pk_mul_f32 v[108:109], v[108:109], v[32:33]
    v_pk_mul_f32 v[110:111], v[110:111], v[34:35]
    v_pk_mul_f32 v[124:125], v[124:125], v[36:37]
    v_pk_mul_f32 v[126:127], v[126:127], v[38:39]
    v_cvt_pk_bf16_f32 v156, v108, v109
    v_cvt_pk_bf16_f32 v157, v110, v111
    v_cvt_pk_bf16_f32 v158, v124, v125
    v_cvt_pk_bf16_f32 v159, v126, v127
    s_branch L_f_adone_2
L_f_vpart_6:
    s_waitcnt lgkmcnt(0)
    s_bitcmp1_b32 s37, 0
    s_cbranch_scc1 L_f_cs_25
L_f_csb_26:
    s_bitcmp1_b32 s37, 1
    s_cbranch_scc1 L_f_cs_27
L_f_csb_28:
    s_setprio 1
    v_mfma_f32_16x16x32_bf16 v[64:67], v[32:35], v[48:51], 0
    ds_read_b64_tr_b16 v[144:145], v4 offset:8192
    ds_read_b64_tr_b16 v[146:147], v4 offset:9216
    v_mfma_f32_16x16x32_bf16 v[68:71], v[36:39], v[48:51], 0
    ds_read_b128 v[128:131], v3 offset:0
    ds_read_b128 v[132:135], v3 offset:2048
    v_mfma_f32_16x16x32_bf16 v[72:75], v[40:43], v[48:51], 0
    ds_read_b128 v[136:139], v3 offset:4096
    ds_read_b128 v[140:143], v3 offset:6144
    v_mfma_f32_16x16x32_bf16 v[76:79], v[44:47], v[48:51], 0
    ds_read_b64_tr_b16 v[148:149], v5 offset:8192
    ds_read_b64_tr_b16 v[150:151], v5 offset:9216
    v_mfma_f32_16x16x32_bf16 v[80:83], v[32:35], v[52:55], 0
    ds_read_b64_tr_b16 v[152:153], v6 offset:8192
    ds_read_b64_tr_b16 v[154:155], v6 offset:9216
    v_mfma_f32_16x16x32_bf16 v[84:87], v[36:39], v[52:55], 0
    ds_read_b64_tr_b16 v[156:157], v7 offset:8192
    ds_read_b64_tr_b16 v[158:159], v7 offset:9216
    v_mfma_f32_16x16x32_bf16 v[88:91], v[40:43], v[52:55], 0
    v_add_u32 v2, 49152, v2
    v_add_u32 v3, 49152, v3
    v_mfma_f32_16x16x32_bf16 v[92:95], v[44:47], v[52:55], 0
    v_add_u32 v4, 49152, v4
    v_add_u32 v5, 49152, v5
    s_setprio 0
    v_mfma_f32_16x16x32_bf16 v[96:99], v[32:35], v[56:59], 0
    v_add_u32 v6, 49152, v6
    v_add_u32 v7, 49152, v7
    v_mfma_f32_16x16x32_bf16 v[100:103], v[36:39], v[56:59], 0
    v_mfma_f32_16x16x32_bf16 v[104:107], v[40:43], v[56:59], 0
    v_mfma_f32_16x16x32_bf16 v[108:111], v[44:47], v[56:59], 0
    v_mfma_f32_16x16x32_bf16 v[112:115], v[32:35], v[60:63], 0
    v_mfma_f32_16x16x32_bf16 v[116:119], v[36:39], v[60:63], 0
    v_mfma_f32_16x16x32_bf16 v[120:123], v[40:43], v[60:63], 0
    v_mfma_f32_16x16x32_bf16 v[124:127], v[44:47], v[60:63], 0
    s_waitcnt lgkmcnt(0)
    s_barrier
    s_bitcmp1_b32 s37, 2
    s_cbranch_scc1 L_f_cs_29
L_f_csb_30:
    s_bitcmp1_b32 s37, 3
    s_cbranch_scc1 L_f_cs_31
L_f_csb_32:
    s_setprio 3
    v_mfma_f32_16x16x32_bf16 v[64:67], v[128:131], v[144:147], v[64:67]
    ds_read_b64_tr_b16 v[48:49], v4 offset:0
    ds_read_b64_tr_b16 v[50:51], v4 offset:1024
    v_mfma_f32_16x16x32_bf16 v[68:71], v[132:135], v[144:147], v[68:71]
    ds_read_b128 v[32:35], v2 offset:0
    ds_read_b128 v[36:39], v2 offset:2048
    v_mfma_f32_16x16x32_bf16 v[72:75], v[136:139], v[144:147], v[72:75]
    ds_read_b128 v[40:43], v2 offset:4096
    ds_read_b128 v[44:47], v2 offset:6144
    v_mfma_f32_16x16x32_bf16 v[76:79], v[140:143], v[144:147], v[76:79]
    ds_read_b64_tr_b16 v[52:53], v5 offset:0
    ds_read_b64_tr_b16 v[54:55], v5 offset:1024
    v_mfma_f32_16x16x32_bf16 v[80:83], v[128:131], v[148:151], v[80:83]
    ds_read_b64_tr_b16 v[56:57], v6 offset:0
    ds_read_b64_tr_b16 v[58:59], v6 offset:1024
    v_mfma_f32_16x16x32_bf16 v[84:87], v[132:135], v[148:151], v[84:87]
    ds_read_b64_tr_b16 v[60:61], v7 offset:0
    ds_read_b64_tr_b16 v[62:63], v7 offset:1024
    v_mfma_f32_16x16x32_bf16 v[88:91], v[136:139], v[148:151], v[88:91]
    v_mfma_f32_16x16x32_bf16 v[92:95], v[140:143], v[148:151], v[92:95]
    s_setprio 2
    v_mfma_f32_16x16x32_bf16 v[96:99], v[128:131], v[152:155], v[96:99]
    v_mfma_f32_16x16x32_bf16 v[100:103], v[132:135], v[152:155], v[100:103]
    v_mfma_f32_16x16x32_bf16 v[104:107], v[136:139], v[152:155], v[104:107]
    v_mfma_f32_16x16x32_bf16 v[108:111], v[140:143], v[152:155], v[108:111]
    v_mfma_f32_16x16x32_bf16 v[112:115], v[128:131], v[156:159], v[112:115]
    v_mfma_f32_16x16x32_bf16 v[116:119], v[132:135], v[156:159], v[116:119]
    v_mfma_f32_16x16x32_bf16 v[120:123], v[136:139], v[156:159], v[120:123]
    v_mfma_f32_16x16x32_bf16 v[124:127], v[140:143], v[156:159], v[124:127]
    s_waitcnt lgkmcnt(0)
    s_bitcmp1_b32 s37, 4
    s_cbranch_scc1 L_f_cs_33
L_f_csb_34:
    s_bitcmp1_b32 s37, 5
    s_cbranch_scc1 L_f_cs_35
L_f_csb_36:
    s_setprio 1
    v_mfma_f32_16x16x32_bf16 v[64:67], v[32:35], v[48:51], v[64:67]
    ds_read_b64_tr_b16 v[144:145], v4 offset:8192
    ds_read_b64_tr_b16 v[146:147], v4 offset:9216
    v_mfma_f32_16x16x32_bf16 v[68:71], v[36:39], v[48:51], v[68:71]
    ds_read_b128 v[128:131], v3 offset:0
    ds_read_b128 v[132:135], v3 offset:2048
    v_mfma_f32_16x16x32_bf16 v[72:75], v[40:43], v[48:51], v[72:75]
    ds_read_b128 v[136:139], v3 offset:4096
    ds_read_b128 v[140:143], v3 offset:6144
    v_mfma_f32_16x16x32_bf16 v[76:79], v[44:47], v[48:51], v[76:79]
    ds_read_b64_tr_b16 v[148:149], v5 offset:8192
    ds_read_b64_tr_b16 v[150:151], v5 offset:9216
    v_mfma_f32_16x16x32_bf16 v[80:83], v[32:35], v[52:55], v[80:83]
    ds_read_b64_tr_b16 v[152:153], v6 offset:8192
    ds_read_b64_tr_b16 v[154:155], v6 offset:9216
    v_mfma_f32_16x16x32_bf16 v[84:87], v[36:39], v[52:55], v[84:87]
    ds_read_b64_tr_b16 v[156:157], v7 offset:8192
    ds_read_b64_tr_b16 v[158:159], v7 offset:9216
    v_mfma_f32_16x16x32_bf16 v[88:91], v[40:43], v[52:55], v[88:91]
    v_add_u32 v2, 49152, v2
    v_add_u32 v3, 49152, v3
    v_mfma_f32_16x16x32_bf16 v[92:95], v[44:47], v[52:55], v[92:95]
    v_add_u32 v4, 49152, v4
    v_add_u32 v5, 49152, v5
    s_setprio 0
    v_mfma_f32_16x16x32_bf16 v[96:99], v[32:35], v[56:59], v[96:99]
    v_add_u32 v6, 49152, v6
    v_add_u32 v7, 49152, v7
    v_mfma_f32_16x16x32_bf16 v[100:103], v[36:39], v[56:59], v[100:103]
    v_mfma_f32_16x16x32_bf16 v[104:107], v[40:43], v[56:59], v[104:107]
    v_mfma_f32_16x16x32_bf16 v[108:111], v[44:47], v[56:59], v[108:111]
    v_mfma_f32_16x16x32_bf16 v[112:115], v[32:35], v[60:63], v[112:115]
    v_mfma_f32_16x16x32_bf16 v[116:119], v[36:39], v[60:63], v[116:119]
    v_mfma_f32_16x16x32_bf16 v[120:123], v[40:43], v[60:63], v[120:123]
    v_mfma_f32_16x16x32_bf16 v[124:127], v[44:47], v[60:63], v[124:127]
    s_waitcnt lgkmcnt(0)
    s_barrier
    s_setprio 3
    v_mfma_f32_16x16x32_bf16 v[64:67], v[128:131], v[144:147], v[64:67]
    ds_read_b64_tr_b16 v[48:49], v4 offset:0
    ds_read_b64_tr_b16 v[50:51], v4 offset:1024
    v_mfma_f32_16x16x32_bf16 v[68:71], v[132:135], v[144:147], v[68:71]
    ds_read_b128 v[32:35], v2 offset:0
    ds_read_b128 v[36:39], v2 offset:2048
    v_mfma_f32_16x16x32_bf16 v[72:75], v[136:139], v[144:147], v[72:75]
    ds_read_b128 v[40:43], v2 offset:4096
    ds_read_b128 v[44:47], v2 offset:6144
    v_mfma_f32_16x16x32_bf16 v[76:79], v[140:143], v[144:147], v[76:79]
    ds_read_b64_tr_b16 v[52:53], v5 offset:0
    ds_read_b64_tr_b16 v[54:55], v5 offset:1024
    v_mfma_f32_16x16x32_bf16 v[80:83], v[128:131], v[148:151], v[80:83]
    ds_read_b64_tr_b16 v[56:57], v6 offset:0
    ds_read_b64_tr_b16 v[58:59], v6 offset:1024
    v_mfma_f32_16x16x32_bf16 v[84:87], v[132:135], v[148:151], v[84:87]
    ds_read_b64_tr_b16 v[60:61], v7 offset:0
    ds_read_b64_tr_b16 v[62:63], v7 offset:1024
    v_mfma_f32_16x16x32_bf16 v[88:91], v[136:139], v[148:151], v[88:91]
    v_mfma_f32_16x16x32_bf16 v[92:95], v[140:143], v[148:151], v[92:95]
    s_setprio 2
    v_mfma_f32_16x16x32_bf16 v[96:99], v[128:131], v[152:155], v[96:99]
    v_mfma_f32_16x16x32_bf16 v[100:103], v[132:135], v[152:155], v[100:103]
    v_mfma_f32_16x16x32_bf16 v[104:107], v[136:139], v[152:155], v[104:107]
    v_mfma_f32_16x16x32_bf16 v[108:111], v[140:143], v[152:155], v[108:111]
    v_mfma_f32_16x16x32_bf16 v[112:115], v[128:131], v[156:159], v[112:115]
    v_mfma_f32_16x16x32_bf16 v[116:119], v[132:135], v[156:159], v[116:119]
    v_mfma_f32_16x16x32_bf16 v[120:123], v[136:139], v[156:159], v[120:123]
    v_mfma_f32_16x16x32_bf16 v[124:127], v[140:143], v[156:159], v[124:127]
    s_waitcnt lgkmcnt(0)
    s_setprio 1
    v_mfma_f32_16x16x32_bf16 v[64:67], v[32:35], v[48:51], v[64:67]
    ds_read_b64_tr_b16 v[144:145], v4 offset:8192
    ds_read_b64_tr_b16 v[146:147], v4 offset:9216
    ds_read_b128 v[128:131], v3 offset:0
    v_mfma_f32_16x16x32_bf16 v[68:71], v[36:39], v[48:51], v[68:71]
    ds_read_b128 v[132:135], v3 offset:2048
    ds_read_b128 v[136:139], v3 offset:4096
    ds_read_b128 v[140:143], v3 offset:6144
    v_mfma_f32_16x16x32_bf16 v[72:75], v[40:43], v[48:51], v[72:75]
    ds_read_b64_tr_b16 v[148:149], v5 offset:8192
    ds_read_b64_tr_b16 v[150:151], v5 offset:9216
    ds_read_b64_tr_b16 v[152:153], v6 offset:8192
    v_mfma_f32_16x16x32_bf16 v[76:79], v[44:47], v[48:51], v[76:79]
    ds_read_b64_tr_b16 v[154:155], v6 offset:9216
    ds_read_b64_tr_b16 v[156:157], v7 offset:8192
    ds_read_b64_tr_b16 v[158:159], v7 offset:9216
    v_mfma_f32_16x16x32_bf16 v[80:83], v[32:35], v[52:55], v[80:83]
    v_add_u32 v2, 4294868992, v2
    v_add_u32 v3, 4294868992, v3
    v_add_u32 v4, 4294868992, v4
    v_mfma_f32_16x16x32_bf16 v[84:87], v[36:39], v[52:55], v[84:87]
    v_add_u32 v5, 4294868992, v5
    v_add_u32 v6, 4294868992, v6
    v_add_u32 v7, 4294868992, v7
    v_mfma_f32_16x16x32_bf16 v[88:91], v[40:43], v[52:55], v[88:91]
    s_mul_i32 s40, s24, 2048
    s_lshl_b32 s41, s25, 15
    s_add_u32 s40, s40, s41
    v_mfma_f32_16x16x32_bf16 v[92:95], v[44:47], v[52:55], v[92:95]
    s_lshr_b32 s41, s12, 1
    s_lshl_b32 s41, s41, 9
    s_add_u32 s40, s40, s41
    s_setprio 0
    v_mfma_f32_16x16x32_bf16 v[96:99], v[32:35], v[56:59], v[96:99]
    s_add_u32 s40, s40, 28721152
    v_lshlrev_b32 v12, 3, v1
    v_mov_b32 v17, s13
    v_mfma_f32_16x16x32_bf16 v[100:103], v[36:39], v[56:59], v[100:103]
    s_mov_b32 exec_lo, 0xffff0000
    v_mov_b32 v16, v20
    s_mov_b32 exec_lo, 0
    v_mov_b32 v16, v24
    s_mov_b32 exec_hi, 0xffff0000
    v_mov_b32 v16, v28
    s_mov_b64 exec, -1
    buffer_store_dwordx2 v[16:17], v12, s[8:11], s40 offen sc1
    v_mfma_f32_16x16x32_bf16 v[104:107], v[40:43], v[56:59], v[104:107]
    v_mfma_f32_16x16x32_bf16 v[108:111], v[44:47], v[56:59], v[108:111]
    v_mfma_f32_16x16x32_bf16 v[112:115], v[32:35], v[60:63], v[112:115]
    v_mfma_f32_16x16x32_bf16 v[116:119], v[36:39], v[60:63], v[116:119]
    v_mfma_f32_16x16x32_bf16 v[120:123], v[40:43], v[60:63], v[120:123]
    v_mfma_f32_16x16x32_bf16 v[124:127], v[44:47], v[60:63], v[124:127]
    s_waitcnt lgkmcnt(0)
    s_barrier
    s_setprio 3
    v_mfma_f32_16x16x32_bf16 v[64:67], v[128:131], v[144:147], v[64:67]
    ds_read_b64_tr_b16 v[48:49], v4 offset:0
    ds_read_b64_tr_b16 v[50:51], v4 offset:1024
    v_mfma_f32_16x16x32_bf16 v[68:71], v[132:135], v[144:147], v[68:71]
    ds_read_b128 v[32:35], v2 offset:0
    ds_read_b128 v[36:39], v2 offset:2048
    v_mfma_f32_16x16x32_bf16 v[72:75], v[136:139], v[144:147], v[72:75]
    ds_read_b128 v[40:43], v2 offset:4096
    ds_read_b128 v[44:47], v2 offset:6144
    v_mfma_f32_16x16x32_bf16 v[76:79], v[140:143], v[144:147], v[76:79]
    ds_read_b64_tr_b16 v[52:53], v5 offset:0
    ds_read_b64_tr_b16 v[54:55], v5 offset:1024
    v_mfma_f32_16x16x32_bf16 v[80:83], v[128:131], v[148:151], v[80:83]
    ds_read_b64_tr_b16 v[56:57], v6 offset:0
    ds_read_b64_tr_b16 v[58:59], v6 offset:1024
    v_mfma_f32_16x16x32_bf16 v[84:87], v[132:135], v[148:151], v[84:87]
    ds_read_b64_tr_b16 v[60:61], v7 offset:0
    ds_read_b64_tr_b16 v[62:63], v7 offset:1024
    v_mfma_f32_16x16x32_bf16 v[88:91], v[136:139], v[148:151], v[88:91]
    v_mfma_f32_16x16x32_bf16 v[92:95], v[140:143], v[148:151], v[92:95]
    s_setprio 2
    v_mfma_f32_16x16x32_bf16 v[96:99], v[128:131], v[152:155], v[96:99]
    v_mfma_f32_16x16x32_bf16 v[100:103], v[132:135], v[152:155], v[100:103]
    v_mfma_f32_16x16x32_bf16 v[104:107], v[136:139], v[152:155], v[104:107]
    v_mfma_f32_16x16x32_bf16 v[108:111], v[140:143], v[152:155], v[108:111]
    v_mfma_f32_16x16x32_bf16 v[112:115], v[128:131], v[156:159], v[112:115]
    v_mfma_f32_16x16x32_bf16 v[116:119], v[132:135], v[156:159], v[116:119]
    v_mfma_f32_16x16x32_bf16 v[120:123], v[136:139], v[156:159], v[120:123]
    v_mfma_f32_16x16x32_bf16 v[124:127], v[140:143], v[156:159], v[124:127]
    s_waitcnt lgkmcnt(0)
    s_setprio 1
    v_mfma_f32_16x16x32_bf16 v[64:67], v[32:35], v[48:51], v[64:67]
    ds_read_b64_tr_b16 v[144:145], v4 offset:8192
    ds_read_b64_tr_b16 v[146:147], v4 offset:9216
    v_mfma_f32_16x16x32_bf16 v[68:71], v[36:39], v[48:51], v[68:71]
    ds_read_b128 v[128:131], v3 offset:0
    ds_read_b128 v[132:135], v3 offset:2048
    v_mfma_f32_16x16x32_bf16 v[72:75], v[40:43], v[48:51], v[72:75]
    ds_read_b128 v[136:139], v3 offset:4096
    ds_read_b128 v[140:143], v3 offset:6144
    v_mfma_f32_16x16x32_bf16 v[76:79], v[44:47], v[48:51], v[76:79]
    ds_read_b64_tr_b16 v[148:149], v5 offset:8192
    ds_read_b64_tr_b16 v[150:151], v5 offset:9216
    v_mfma_f32_16x16x32_bf16 v[80:83], v[32:35], v[52:55], v[80:83]
    ds_read_b64_tr_b16 v[152:153], v6 offset:8192
    ds_read_b64_tr_b16 v[154:155], v6 offset:9216
    v_mfma_f32_16x16x32_bf16 v[84:87], v[36:39], v[52:55], v[84:87]
    ds_read_b64_tr_b16 v[156:157], v7 offset:8192
    ds_read_b64_tr_b16 v[158:159], v7 offset:9216
    v_mfma_f32_16x16x32_bf16 v[88:91], v[40:43], v[52:55], v[88:91]
    v_add_u32 v2, 49152, v2
    v_add_u32 v3, 49152, v3
    v_mfma_f32_16x16x32_bf16 v[92:95], v[44:47], v[52:55], v[92:95]
    v_add_u32 v4, 49152, v4
    v_add_u32 v5, 49152, v5
    s_setprio 0
    v_mfma_f32_16x16x32_bf16 v[96:99], v[32:35], v[56:59], v[96:99]
    v_add_u32 v6, 49152, v6
    v_add_u32 v7, 49152, v7
    v_mfma_f32_16x16x32_bf16 v[100:103], v[36:39], v[56:59], v[100:103]
    v_mfma_f32_16x16x32_bf16 v[104:107], v[40:43], v[56:59], v[104:107]
    v_mfma_f32_16x16x32_bf16 v[108:111], v[44:47], v[56:59], v[108:111]
    v_mfma_f32_16x16x32_bf16 v[112:115], v[32:35], v[60:63], v[112:115]
    v_mfma_f32_16x16x32_bf16 v[116:119], v[36:39], v[60:63], v[116:119]
    v_mfma_f32_16x16x32_bf16 v[120:123], v[40:43], v[60:63], v[120:123]
    v_mfma_f32_16x16x32_bf16 v[124:127], v[44:47], v[60:63], v[124:127]
    s_waitcnt lgkmcnt(0)
    s_barrier
    s_setprio 3
    v_mfma_f32_16x16x32_bf16 v[64:67], v[128:131], v[144:147], v[64:67]
    ds_read_b64_tr_b16 v[48:49], v4 offset:0
    ds_read_b64_tr_b16 v[50:51], v4 offset:1024
    v_mfma_f32_16x16x32_bf16 v[68:71], v[132:135], v[144:147], v[68:71]
    ds_read_b128 v[32:35], v2 offset:0
    ds_read_b128 v[36:39], v2 offset:2048
    v_mfma_f32_16x16x32_bf16 v[72:75], v[136:139], v[144:147], v[72:75]
    ds_read_b128 v[40:43], v2 offset:4096
    ds_read_b128 v[44:47], v2 offset:6144
    v_mfma_f32_16x16x32_bf16 v[76:79], v[140:143], v[144:147], v[76:79]
    ds_read_b64_tr_b16 v[52:53], v5 offset:0
    ds_read_b64_tr_b16 v[54:55], v5 offset:1024
    v_mfma_f32_16x16x32_bf16 v[80:83], v[128:131], v[148:151], v[80:83]
    ds_read_b64_tr_b16 v[56:57], v6 offset:0
    ds_read_b64_tr_b16 v[58:59], v6 offset:1024
    v_mfma_f32_16x16x32_bf16 v[84:87], v[132:135], v[148:151], v[84:87]
    ds_read_b64_tr_b16 v[60:61], v7 offset:0
    ds_read_b64_tr_b16 v[62:63], v7 offset:1024
    v_mfma_f32_16x16x32_bf16 v[88:91], v[136:139], v[148:151], v[88:91]
    v_mfma_f32_16x16x32_bf16 v[92:95], v[140:143], v[148:151], v[92:95]
    s_setprio 2
    v_mfma_f32_16x16x32_bf16 v[96:99], v[128:131], v[152:155], v[96:99]
    v_mfma_f32_16x16x32_bf16 v[100:103], v[132:135], v[152:155], v[100:103]
    v_mfma_f32_16x16x32_bf16 v[104:107], v[136:139], v[152:155], v[104:107]
    v_mfma_f32_16x16x32_bf16 v[108:111], v[140:143], v[152:155], v[108:111]
    v_mfma_f32_16x16x32_bf16 v[112:115], v[128:131], v[156:159], v[112:115]
    v_mfma_f32_16x16x32_bf16 v[116:119], v[132:135], v[156:159], v[116:119]
    v_mfma_f32_16x16x32_bf16 v[120:123], v[136:139], v[156:159], v[120:123]
    v_mfma_f32_16x16x32_bf16 v[124:127], v[140:143], v[156:159], v[124:127]
    s_waitcnt lgkmcnt(0)
    s_setprio 1
    v_mfma_f32_16x16x32_bf16 v[64:67], v[32:35], v[48:51], v[64:67]
    ds_read_b64_tr_b16 v[144:145], v4 offset:8192
    ds_read_b64_tr_b16 v[146:147], v4 offset:9216
    v_mfma_f32_16x16x32_bf16 v[68:71], v[36:39], v[48:51], v[68:71]
    ds_read_b128 v[128:131], v3 offset:0
    ds_read_b128 v[132:135], v3 offset:2048
    v_mfma_f32_16x16x32_bf16 v[72:75], v[40:43], v[48:51], v[72:75]
    ds_read_b128 v[136:139], v3 offset:4096
    ds_read_b128 v[140:143], v3 offset:6144
    v_mfma_f32_16x16x32_bf16 v[76:79], v[44:47], v[48:51], v[76:79]
    ds_read_b64_tr_b16 v[148:149], v5 offset:8192
    ds_read_b64_tr_b16 v[150:151], v5 offset:9216
    v_mfma_f32_16x16x32_bf16 v[80:83], v[32:35], v[52:55], v[80:83]
    ds_read_b64_tr_b16 v[152:153], v6 offset:8192
    ds_read_b64_tr_b16 v[154:155], v6 offset:9216
    v_mfma_f32_16x16x32_bf16 v[84:87], v[36:39], v[52:55], v[84:87]
    ds_read_b64_tr_b16 v[156:157], v7 offset:8192
    ds_read_b64_tr_b16 v[158:159], v7 offset:9216
    v_mfma_f32_16x16x32_bf16 v[88:91], v[40:43], v[52:55], v[88:91]
    v_add_u32 v2, 49152, v2
    v_add_u32 v3, 49152, v3
    v_mfma_f32_16x16x32_bf16 v[92:95], v[44:47], v[52:55], v[92:95]
    v_add_u32 v4, 49152, v4
    v_add_u32 v5, 49152, v5
    s_setprio 0
    v_mfma_f32_16x16x32_bf16 v[96:99], v[32:35], v[56:59], v[96:99]
    v_add_u32 v6, 49152, v6
    v_add_u32 v7, 49152, v7
    v_mfma_f32_16x16x32_bf16 v[100:103], v[36:39], v[56:59], v[100:103]
    v_mfma_f32_16x16x32_bf16 v[104:107], v[40:43], v[56:59], v[104:107]
    v_mfma_f32_16x16x32_bf16 v[108:111], v[44:47], v[56:59], v[108:111]
    v_mfma_f32_16x16x32_bf16 v[112:115], v[32:35], v[60:63], v[112:115]
    v_mfma_f32_16x16x32_bf16 v[116:119], v[36:39], v[60:63], v[116:119]
    v_mfma_f32_16x16x32_bf16 v[120:123], v[40:43], v[60:63], v[120:123]
    v_mfma_f32_16x16x32_bf16 v[124:127], v[44:47], v[60:63], v[124:127]
    s_waitcnt lgkmcnt(0)
    s_barrier
    s_setprio 3
    v_mfma_f32_16x16x32_bf16 v[64:67], v[128:131], v[144:147], v[64:67]
    ds_read_b64_tr_b16 v[48:49], v4 offset:0
    ds_read_b64_tr_b16 v[50:51], v4 offset:1024
    v_mfma_f32_16x16x32_bf16 v[68:71], v[132:135], v[144:147], v[68:71]
    ds_read_b128 v[32:35], v2 offset:0
    ds_read_b128 v[36:39], v2 offset:2048
    v_mfma_f32_16x16x32_bf16 v[72:75], v[136:139], v[144:147], v[72:75]
    ds_read_b128 v[40:43], v2 offset:4096
    ds_read_b128 v[44:47], v2 offset:6144
    v_mfma_f32_16x16x32_bf16 v[76:79], v[140:143], v[144:147], v[76:79]
    ds_read_b64_tr_b16 v[52:53], v5 offset:0
    ds_read_b64_tr_b16 v[54:55], v5 offset:1024
    v_mfma_f32_16x16x32_bf16 v[80:83], v[128:131], v[148:151], v[80:83]
    ds_read_b64_tr_b16 v[56:57], v6 offset:0
    ds_read_b64_tr_b16 v[58:59], v6 offset:1024
    v_mfma_f32_16x16x32_bf16 v[84:87], v[132:135], v[148:151], v[84:87]
    ds_read_b64_tr_b16 v[60:61], v7 offset:0
    ds_read_b64_tr_b16 v[62:63], v7 offset:1024
    v_mfma_f32_16x16x32_bf16 v[88:91], v[136:139], v[148:151], v[88:91]
    v_mfma_f32_16x16x32_bf16 v[92:95], v[140:143], v[148:151], v[92:95]
    s_setprio 2
    v_mfma_f32_16x16x32_bf16 v[96:99], v[128:131], v[152:155], v[96:99]
    v_mfma_f32_16x16x32_bf16 v[100:103], v[132:135], v[152:155], v[100:103]
    v_mfma_f32_16x16x32_bf16 v[104:107], v[136:139], v[152:155], v[104:107]
    v_mfma_f32_16x16x32_bf16 v[108:111], v[140:143], v[152:155], v[108:111]
    v_mfma_f32_16x16x32_bf16 v[112:115], v[128:131], v[156:159], v[112:115]
    v_mfma_f32_16x16x32_bf16 v[116:119], v[132:135], v[156:159], v[116:119]
    v_mfma_f32_16x16x32_bf16 v[120:123], v[136:139], v[156:159], v[120:123]
    v_mfma_f32_16x16x32_bf16 v[124:127], v[140:143], v[156:159], v[124:127]
    s_waitcnt lgkmcnt(0)
    s_setprio 1
    v_mfma_f32_16x16x32_bf16 v[64:67], v[32:35], v[48:51], v[64:67]
    ds_read_b64_tr_b16 v[144:145], v4 offset:8192
    ds_read_b64_tr_b16 v[146:147], v4 offset:9216
    v_mfma_f32_16x16x32_bf16 v[68:71], v[36:39], v[48:51], v[68:71]
    ds_read_b128 v[128:131], v3 offset:0
    ds_read_b128 v[132:135], v3 offset:2048
    v_mfma_f32_16x16x32_bf16 v[72:75], v[40:43], v[48:51], v[72:75]
    ds_read_b128 v[136:139], v3 offset:4096
    ds_read_b128 v[140:143], v3 offset:6144
    v_mfma_f32_16x16x32_bf16 v[76:79], v[44:47], v[48:51], v[76:79]
    ds_read_b64_tr_b16 v[148:149], v5 offset:8192
    ds_read_b64_tr_b16 v[150:151], v5 offset:9216
    v_mfma_f32_16x16x32_bf16 v[80:83], v[32:35], v[52:55], v[80:83]
    ds_read_b64_tr_b16 v[152:153], v6 offset:8192
    ds_read_b64_tr_b16 v[154:155], v6 offset:9216
    v_mfma_f32_16x16x32_bf16 v[84:87], v[36:39], v[52:55], v[84:87]
    ds_read_b64_tr_b16 v[156:157], v7 offset:8192
    ds_read_b64_tr_b16 v[158:159], v7 offset:9216
    v_mfma_f32_16x16x32_bf16 v[88:91], v[40:43], v[52:55], v[88:91]
    v_add_u32 v2, 4294868992, v2
    v_add_u32 v3, 4294868992, v3
    v_mfma_f32_16x16x32_bf16 v[92:95], v[44:47], v[52:55], v[92:95]
    v_add_u32 v4, 4294868992, v4
    v_add_u32 v5, 4294868992, v5
    s_setprio 0
    v_mfma_f32_16x16x32_bf16 v[96:99], v[32:35], v[56:59], v[96:99]
    v_add_u32 v6, 4294868992, v6
    v_add_u32 v7, 4294868992, v7
    v_mfma_f32_16x16x32_bf16 v[100:103], v[36:39], v[56:59], v[100:103]
    v_mfma_f32_16x16x32_bf16 v[104:107], v[40:43], v[56:59], v[104:107]
    v_mfma_f32_16x16x32_bf16 v[108:111], v[44:47], v[56:59], v[108:111]
    v_mfma_f32_16x16x32_bf16 v[112:115], v[32:35], v[60:63], v[112:115]
    v_mfma_f32_16x16x32_bf16 v[116:119], v[36:39], v[60:63], v[116:119]
    v_mfma_f32_16x16x32_bf16 v[120:123], v[40:43], v[60:63], v[120:123]
    v_mfma_f32_16x16x32_bf16 v[124:127], v[44:47], v[60:63], v[124:127]
    s_waitcnt lgkmcnt(0)
    s_barrier
    s_setprio 3
    v_mfma_f32_16x16x32_bf16 v[64:67], v[128:131], v[144:147], v[64:67]
    ds_read_b64_tr_b16 v[48:49], v4 offset:0
    ds_read_b64_tr_b16 v[50:51], v4 offset:1024
    v_mfma_f32_16x16x32_bf16 v[68:71], v[132:135], v[144:147], v[68:71]
    ds_read_b128 v[32:35], v2 offset:0
    ds_read_b128 v[36:39], v2 offset:2048
    v_mfma_f32_16x16x32_bf16 v[72:75], v[136:139], v[144:147], v[72:75]
    ds_read_b128 v[40:43], v2 offset:4096
    ds_read_b128 v[44:47], v2 offset:6144
    v_mfma_f32_16x16x32_bf16 v[76:79], v[140:143], v[144:147], v[76:79]
    ds_read_b64_tr_b16 v[52:53], v5 offset:0
    ds_read_b64_tr_b16 v[54:55], v5 offset:1024
    v_mfma_f32_16x16x32_bf16 v[80:83], v[128:131], v[148:151], v[80:83]
    ds_read_b64_tr_b16 v[56:57], v6 offset:0
    ds_read_b64_tr_b16 v[58:59], v6 offset:1024
    v_mfma_f32_16x16x32_bf16 v[84:87], v[132:135], v[148:151], v[84:87]
    ds_read_b64_tr_b16 v[60:61], v7 offset:0
    ds_read_b64_tr_b16 v[62:63], v7 offset:1024
    v_mfma_f32_16x16x32_bf16 v[88:91], v[136:139], v[148:151], v[88:91]
    v_mfma_f32_16x16x32_bf16 v[92:95], v[140:143], v[148:151], v[92:95]
    s_setprio 2
    v_mfma_f32_16x16x32_bf16 v[96:99], v[128:131], v[152:155], v[96:99]
    v_mfma_f32_16x16x32_bf16 v[100:103], v[132:135], v[152:155], v[100:103]
    v_mfma_f32_16x16x32_bf16 v[104:107], v[136:139], v[152:155], v[104:107]
    v_mfma_f32_16x16x32_bf16 v[108:111], v[140:143], v[152:155], v[108:111]
    v_mfma_f32_16x16x32_bf16 v[112:115], v[128:131], v[156:159], v[112:115]
    v_mfma_f32_16x16x32_bf16 v[116:119], v[132:135], v[156:159], v[116:119]
    v_mfma_f32_16x16x32_bf16 v[120:123], v[136:139], v[156:159], v[120:123]
    v_mfma_f32_16x16x32_bf16 v[124:127], v[140:143], v[156:159], v[124:127]
    s_waitcnt lgkmcnt(0)
    s_setprio 1
    v_mfma_f32_16x16x32_bf16 v[64:67], v[32:35], v[48:51], v[64:67]
    ds_read_b64_tr_b16 v[144:145], v4 offset:8192
    ds_read_b64_tr_b16 v[146:147], v4 offset:9216
    v_mfma_f32_16x16x32_bf16 v[68:71], v[36:39], v[48:51], v[68:71]
    ds_read_b128 v[128:131], v3 offset:0
    ds_read_b128 v[132:135], v3 offset:2048
    v_mfma_f32_16x16x32_bf16 v[72:75], v[40:43], v[48:51], v[72:75]
    ds_read_b128 v[136:139], v3 offset:4096
    ds_read_b128 v[140:143], v3 offset:6144
    v_mfma_f32_16x16x32_bf16 v[76:79], v[44:47], v[48:51], v[76:79]
    ds_read_b64_tr_b16 v[148:149], v5 offset:8192
    ds_read_b64_tr_b16 v[150:151], v5 offset:9216
    v_mfma_f32_16x16x32_bf16 v[80:83], v[32:35], v[52:55], v[80:83]
    ds_read_b64_tr_b16 v[152:153], v6 offset:8192
    ds_read_b64_tr_b16 v[154:155], v6 offset:9216
    v_mfma_f32_16x16x32_bf16 v[84:87], v[36:39], v[52:55], v[84:87]
    ds_read_b64_tr_b16 v[156:157], v7 offset:8192
    ds_read_b64_tr_b16 v[158:159], v7 offset:9216
    v_mfma_f32_16x16x32_bf16 v[88:91], v[40:43], v[52:55], v[88:91]
    v_add_u32 v2, 49152, v2
    v_add_u32 v3, 49152, v3
    v_mfma_f32_16x16x32_bf16 v[92:95], v[44:47], v[52:55], v[92:95]
    v_add_u32 v4, 49152, v4
    v_add_u32 v5, 49152, v5
    s_setprio 0
    v_mfma_f32_16x16x32_bf16 v[96:99], v[32:35], v[56:59], v[96:99]
    v_add_u32 v6, 49152, v6
    v_add_u32 v7, 49152, v7
    v_mfma_f32_16x16x32_bf16 v[100:103], v[36:39], v[56:59], v[100:103]
    v_mfma_f32_16x16x32_bf16 v[104:107], v[40:43], v[56:59], v[104:107]
    v_mfma_f32_16x16x32_bf16 v[108:111], v[44:47], v[56:59], v[108:111]
    v_mfma_f32_16x16x32_bf16 v[112:115], v[32:35], v[60:63], v[112:115]
    v_mfma_f32_16x16x32_bf16 v[116:119], v[36:39], v[60:63], v[116:119]
    v_mfma_f32_16x16x32_bf16 v[120:123], v[40:43], v[60:63], v[120:123]
    v_mfma_f32_16x16x32_bf16 v[124:127], v[44:47], v[60:63], v[124:127]
    s_waitcnt lgkmcnt(0)
    s_barrier
    s_setprio 3
    v_mfma_f32_16x16x32_bf16 v[64:67], v[128:131], v[144:147], v[64:67]
    ds_read_b64_tr_b16 v[48:49], v4 offset:0
    ds_read_b64_tr_b16 v[50:51], v4 offset:1024
    v_mfma_f32_16x16x32_bf16 v[68:71], v[132:135], v[144:147], v[68:71]
    ds_read_b128 v[32:35], v2 offset:0
    ds_read_b128 v[36:39], v2 offset:2048
    v_mfma_f32_16x16x32_bf16 v[72:75], v[136:139], v[144:147], v[72:75]
    ds_read_b128 v[40:43], v2 offset:4096
    ds_read_b128 v[44:47], v2 offset:6144
    v_mfma_f32_16x16x32_bf16 v[76:79], v[140:143], v[144:147], v[76:79]
    ds_read_b64_tr_b16 v[52:53], v5 offset:0
    ds_read_b64_tr_b16 v[54:55], v5 offset:1024
    v_mfma_f32_16x16x32_bf16 v[80:83], v[128:131], v[148:151], v[80:83]
    ds_read_b64_tr_b16 v[56:57], v6 offset:0
    ds_read_b64_tr_b16 v[58:59], v6 offset:1024
    v_mfma_f32_16x16x32_bf16 v[84:87], v[132:135], v[148:151], v[84:87]
    ds_read_b64_tr_b16 v[60:61], v7 offset:0
    ds_read_b64_tr_b16 v[62:63], v7 offset:1024
    v_mfma_f32_16x16x32_bf16 v[88:91], v[136:139], v[148:151], v[88:91]
    v_mfma_f32_16x16x32_bf16 v[92:95], v[140:143], v[148:151], v[92:95]
    s_setprio 2
    v_mfma_f32_16x16x32_bf16 v[96:99], v[128:131], v[152:155], v[96:99]
    v_mfma_f32_16x16x32_bf16 v[100:103], v[132:135], v[152:155], v[100:103]
    v_mfma_f32_16x16x32_bf16 v[104:107], v[136:139], v[152:155], v[104:107]
    v_mfma_f32_16x16x32_bf16 v[108:111], v[140:143], v[152:155], v[108:111]
    v_mfma_f32_16x16x32_bf16 v[112:115], v[128:131], v[156:159], v[112:115]
    v_mfma_f32_16x16x32_bf16 v[116:119], v[132:135], v[156:159], v[116:119]
    v_mfma_f32_16x16x32_bf16 v[120:123], v[136:139], v[156:159], v[120:123]
    v_mfma_f32_16x16x32_bf16 v[124:127], v[140:143], v[156:159], v[124:127]
    s_waitcnt lgkmcnt(0)
    s_setprio 1
    v_mfma_f32_16x16x32_bf16 v[64:67], v[32:35], v[48:51], v[64:67]
    ds_read_b64_tr_b16 v[144:145], v4 offset:8192
    ds_read_b64_tr_b16 v[146:147], v4 offset:9216
    v_mfma_f32_16x16x32_bf16 v[68:71], v[36:39], v[48:51], v[68:71]
    ds_read_b128 v[128:131], v3 offset:0
    ds_read_b128 v[132:135], v3 offset:2048
    v_mfma_f32_16x16x32_bf16 v[72:75], v[40:43], v[48:51], v[72:75]
    ds_read_b128 v[136:139], v3 offset:4096
    ds_read_b128 v[140:143], v3 offset:6144
    v_mfma_f32_16x16x32_bf16 v[76:79], v[44:47], v[48:51], v[76:79]
    ds_read_b64_tr_b16 v[148:149], v5 offset:8192
    ds_read_b64_tr_b16 v[150:151], v5 offset:9216
    v_mfma_f32_16x16x32_bf16 v[80:83], v[32:35], v[52:55], v[80:83]
    ds_read_b64_tr_b16 v[152:153], v6 offset:8192
    ds_read_b64_tr_b16 v[154:155], v6 offset:9216
    v_mfma_f32_16x16x32_bf16 v[84:87], v[36:39], v[52:55], v[84:87]
    ds_read_b64_tr_b16 v[156:157], v7 offset:8192
    ds_read_b64_tr_b16 v[158:159], v7 offset:9216
    v_mfma_f32_16x16x32_bf16 v[88:91], v[40:43], v[52:55], v[88:91]
    v_add_u32 v2, 49152, v2
    v_add_u32 v3, 49152, v3
    v_mfma_f32_16x16x32_bf16 v[92:95], v[44:47], v[52:55], v[92:95]
    v_add_u32 v4, 49152, v4
    v_add_u32 v5, 49152, v5
    s_setprio 0
    v_mfma_f32_16x16x32_bf16 v[96:99], v[32:35], v[56:59], v[96:99]
    v_add_u32 v6, 49152, v6
    v_add_u32 v7, 49152, v7
    v_mfma_f32_16x16x32_bf16 v[100:103], v[36:39], v[56:59], v[100:103]
    v_mfma_f32_16x16x32_bf16 v[104:107], v[40:43], v[56:59], v[104:107]
    v_mfma_f32_16x16x32_bf16 v[108:111], v[44:47], v[56:59], v[108:111]
    v_mfma_f32_16x16x32_bf16 v[112:115], v[32:35], v[60:63], v[112:115]
    v_mfma_f32_16x16x32_bf16 v[116:119], v[36:39], v[60:63], v[116:119]
    v_mfma_f32_16x16x32_bf16 v[120:123], v[40:43], v[60:63], v[120:123]
    v_mfma_f32_16x16x32_bf16 v[124:127], v[44:47], v[60:63], v[124:127]
    s_waitcnt lgkmcnt(0)
    s_barrier
    s_setprio 3
    v_mfma_f32_16x16x32_bf16 v[64:67], v[128:131], v[144:147], v[64:67]
    ds_read_b64_tr_b16 v[48:49], v4 offset:0
    ds_read_b64_tr_b16 v[50:51], v4 offset:1024
    v_mfma_f32_16x16x32_bf16 v[68:71], v[132:135], v[144:147], v[68:71]
    ds_read_b128 v[32:35], v2 offset:0
    ds_read_b128 v[36:39], v2 offset:2048
    v_mfma_f32_16x16x32_bf16 v[72:75], v[136:139], v[144:147], v[72:75]
    ds_read_b128 v[40:43], v2 offset:4096
    ds_read_b128 v[44:47], v2 offset:6144
    v_mfma_f32_16x16x32_bf16 v[76:79], v[140:143], v[144:147], v[76:79]
    ds_read_b64_tr_b16 v[52:53], v5 offset:0
    ds_read_b64_tr_b16 v[54:55], v5 offset:1024
    v_mfma_f32_16x16x32_bf16 v[80:83], v[128:131], v[148:151], v[80:83]
    ds_read_b64_tr_b16 v[56:57], v6 offset:0
    ds_read_b64_tr_b16 v[58:59], v6 offset:1024
    v_mfma_f32_16x16x32_bf16 v[84:87], v[132:135], v[148:151], v[84:87]
    ds_read_b64_tr_b16 v[60:61], v7 offset:0
    ds_read_b64_tr_b16 v[62:63], v7 offset:1024
    v_mfma_f32_16x16x32_bf16 v[88:91], v[136:139], v[148:151], v[88:91]
    v_mfma_f32_16x16x32_bf16 v[92:95], v[140:143], v[148:151], v[92:95]
    s_setprio 2
    v_mfma_f32_16x16x32_bf16 v[96:99], v[128:131], v[152:155], v[96:99]
    v_mfma_f32_16x16x32_bf16 v[100:103], v[132:135], v[152:155], v[100:103]
    v_mfma_f32_16x16x32_bf16 v[104:107], v[136:139], v[152:155], v[104:107]
    v_mfma_f32_16x16x32_bf16 v[108:111], v[140:143], v[152:155], v[108:111]
    v_mfma_f32_16x16x32_bf16 v[112:115], v[128:131], v[156:159], v[112:115]
    v_mfma_f32_16x16x32_bf16 v[116:119], v[132:135], v[156:159], v[116:119]
    v_mfma_f32_16x16x32_bf16 v[120:123], v[136:139], v[156:159], v[120:123]
    v_mfma_f32_16x16x32_bf16 v[124:127], v[140:143], v[156:159], v[124:127]
    s_waitcnt lgkmcnt(0)
    s_barrier
    s_setprio 0
    s_cmp_lt_u32 s12, 4
    s_cbranch_scc1 f_loFalse
    s_barrier
f_loFalse:
    v_mfma_f32_16x16x32_bf16 v[64:67], v[32:35], v[48:51], v[64:67]
    ds_read_b64_tr_b16 v[144:145], v4 offset:8192
    ds_read_b64_tr_b16 v[146:147], v4 offset:9216
    v_mfma_f32_16x16x32_bf16 v[68:71], v[36:39], v[48:51], v[68:71]
    ds_read_b128 v[128:131], v3 offset:0
    ds_read_b128 v[132:135], v3 offset:2048
    v_mfma_f32_16x16x32_bf16 v[72:75], v[40:43], v[48:51], v[72:75]
    ds_read_b128 v[136:139], v3 offset:4096
    ds_read_b128 v[140:143], v3 offset:6144
    v_mfma_f32_16x16x32_bf16 v[76:79], v[44:47], v[48:51], v[76:79]
    ds_read_b64_tr_b16 v[148:149], v5 offset:8192
    ds_read_b64_tr_b16 v[150:151], v5 offset:9216
    v_mfma_f32_16x16x32_bf16 v[80:83], v[32:35], v[52:55], v[80:83]
    ds_read_b64_tr_b16 v[152:153], v6 offset:8192
    ds_read_b64_tr_b16 v[154:155], v6 offset:9216
    v_mfma_f32_16x16x32_bf16 v[84:87], v[36:39], v[52:55], v[84:87]
    ds_read_b64_tr_b16 v[156:157], v7 offset:8192
    ds_read_b64_tr_b16 v[158:159], v7 offset:9216
    v_mfma_f32_16x16x32_bf16 v[88:91], v[40:43], v[52:55], v[88:91]
    v_add_u32 v2, 4294868992, v2
    v_add_u32 v3, 4294868992, v3
    v_mfma_f32_16x16x32_bf16 v[92:95], v[44:47], v[52:55], v[92:95]
    v_add_u32 v4, 4294868992, v4
    v_add_u32 v5, 4294868992, v5
    v_mfma_f32_16x16x32_bf16 v[96:99], v[32:35], v[56:59], v[96:99]
    v_add_u32 v6, 4294868992, v6
    v_add_u32 v7, 4294868992, v7
    v_mfma_f32_16x16x32_bf16 v[100:103], v[36:39], v[56:59], v[100:103]
    v_mfma_f32_16x16x32_bf16 v[104:107], v[40:43], v[56:59], v[104:107]
    v_mfma_f32_16x16x32_bf16 v[108:111], v[44:47], v[56:59], v[108:111]
    v_mfma_f32_16x16x32_bf16 v[112:115], v[32:35], v[60:63], v[112:115]
    v_mfma_f32_16x16x32_bf16 v[116:119], v[36:39], v[60:63], v[116:119]
    v_mfma_f32_16x16x32_bf16 v[120:123], v[40:43], v[60:63], v[120:123]
    v_mfma_f32_16x16x32_bf16 v[124:127], v[44:47], v[60:63], v[124:127]
    s_waitcnt lgkmcnt(0)
    v_mfma_f32_16x16x32_bf16 v[64:67], v[128:131], v[144:147], v[64:67]
    ds_read_b64_tr_b16 v[48:49], v4 offset:0
    ds_read_b64_tr_b16 v[50:51], v4 offset:1024
    v_mfma_f32_16x16x32_bf16 v[68:71], v[132:135], v[144:147], v[68:71]
    ds_read_b128 v[32:35], v2 offset:0
    ds_read_b128 v[36:39], v2 offset:2048
    v_mfma_f32_16x16x32_bf16 v[72:75], v[136:139], v[144:147], v[72:75]
    ds_read_b128 v[40:43], v2 offset:4096
    ds_read_b128 v[44:47], v2 offset:6144
    v_mfma_f32_16x16x32_bf16 v[76:79], v[140:143], v[144:147], v[76:79]
    ds_read_b64_tr_b16 v[52:53], v5 offset:0
    ds_read_b64_tr_b16 v[54:55], v5 offset:1024
    v_mfma_f32_16x16x32_bf16 v[80:83], v[128:131], v[148:151], v[80:83]
    ds_read_b64_tr_b16 v[56:57], v6 offset:0
    ds_read_b64_tr_b16 v[58:59], v6 offset:1024
    v_mfma_f32_16x16x32_bf16 v[84:87], v[132:135], v[148:151], v[84:87]
    ds_read_b64_tr_b16 v[60:61], v7 offset:0
    ds_read_b64_tr_b16 v[62:63], v7 offset:1024
    v_mfma_f32_16x16x32_bf16 v[88:91], v[136:139], v[148:151], v[88:91]
    v_mfma_f32_16x16x32_bf16 v[92:95], v[140:143], v[148:151], v[92:95]
    v_mfma_f32_16x16x32_bf16 v[96:99], v[128:131], v[152:155], v[96:99]
    v_mfma_f32_16x16x32_bf16 v[100:103], v[132:135], v[152:155], v[100:103]
    v_mfma_f32_16x16x32_bf16 v[104:107], v[136:139], v[152:155], v[104:107]
    v_mfma_f32_16x16x32_bf16 v[108:111], v[140:143], v[152:155], v[108:111]
    v_mfma_f32_16x16x32_bf16 v[112:115], v[128:131], v[156:159], v[112:115]
    v_mfma_f32_16x16x32_bf16 v[116:119], v[132:135], v[156:159], v[116:119]
    v_mfma_f32_16x16x32_bf16 v[120:123], v[136:139], v[156:159], v[120:123]
    v_mfma_f32_16x16x32_bf16 v[124:127], v[140:143], v[156:159], v[124:127]
    s_waitcnt lgkmcnt(0)
    v_mfma_f32_16x16x32_bf16 v[64:67], v[32:35], v[48:51], v[64:67]
    ds_read_b64_tr_b16 v[144:145], v4 offset:8192
    ds_read_b64_tr_b16 v[146:147], v4 offset:9216
    v_mfma_f32_16x16x32_bf16 v[68:71], v[36:39], v[48:51], v[68:71]
    ds_read_b128 v[128:131], v3 offset:0
    ds_read_b128 v[132:135], v3 offset:2048
    v_mfma_f32_16x16x32_bf16 v[72:75], v[40:43], v[48:51], v[72:75]
    ds_read_b128 v[136:139], v3 offset:4096
    ds_read_b128 v[140:143], v3 offset:6144
    v_mfma_f32_16x16x32_bf16 v[76:79], v[44:47], v[48:51], v[76:79]
    ds_read_b64_tr_b16 v[148:149], v5 offset:8192
    ds_read_b64_tr_b16 v[150:151], v5 offset:9216
    v_mfma_f32_16x16x32_bf16 v[80:83], v[32:35], v[52:55], v[80:83]
    ds_read_b64_tr_b16 v[152:153], v6 offset:8192
    ds_read_b64_tr_b16 v[154:155], v6 offset:9216
    v_mfma_f32_16x16x32_bf16 v[84:87], v[36:39], v[52:55], v[84:87]
    ds_read_b64_tr_b16 v[156:157], v7 offset:8192
    ds_read_b64_tr_b16 v[158:159], v7 offset:9216
    v_mfma_f32_16x16x32_bf16 v[88:91], v[40:43], v[52:55], v[88:91]
    v_mfma_f32_16x16x32_bf16 v[92:95], v[44:47], v[52:55], v[92:95]
    v_mfma_f32_16x16x32_bf16 v[96:99], v[32:35], v[56:59], v[96:99]
    v_mfma_f32_16x16x32_bf16 v[100:103], v[36:39], v[56:59], v[100:103]
    v_mfma_f32_16x16x32_bf16 v[104:107], v[40:43], v[56:59], v[104:107]
    v_mfma_f32_16x16x32_bf16 v[108:111], v[44:47], v[56:59], v[108:111]
    v_mfma_f32_16x16x32_bf16 v[112:115], v[32:35], v[60:63], v[112:115]
    v_mfma_f32_16x16x32_bf16 v[116:119], v[36:39], v[60:63], v[116:119]
    v_mfma_f32_16x16x32_bf16 v[120:123], v[40:43], v[60:63], v[120:123]
    v_mfma_f32_16x16x32_bf16 v[124:127], v[44:47], v[60:63], v[124:127]
    s_waitcnt lgkmcnt(0)
    v_mfma_f32_16x16x32_bf16 v[64:67], v[128:131], v[144:147], v[64:67]
    v_mfma_f32_16x16x32_bf16 v[68:71], v[132:135], v[144:147], v[68:71]
    v_mfma_f32_16x16x32_bf16 v[72:75], v[136:139], v[144:147], v[72:75]
    v_mfma_f32_16x16x32_bf16 v[76:79], v[140:143], v[144:147], v[76:79]
    v_mfma_f32_16x16x32_bf16 v[80:83], v[128:131], v[148:151], v[80:83]
    v_mfma_f32_16x16x32_bf16 v[84:87], v[132:135], v[148:151], v[84:87]
    v_mfma_f32_16x16x32_bf16 v[88:91], v[136:139], v[148:151], v[88:91]
    v_mfma_f32_16x16x32_bf16 v[92:95], v[140:143], v[148:151], v[92:95]
    v_mfma_f32_16x16x32_bf16 v[96:99], v[128:131], v[152:155], v[96:99]
    v_mfma_f32_16x16x32_bf16 v[100:103], v[132:135], v[152:155], v[100:103]
    v_mfma_f32_16x16x32_bf16 v[104:107], v[136:139], v[152:155], v[104:107]
    v_mfma_f32_16x16x32_bf16 v[108:111], v[140:143], v[152:155], v[108:111]
    v_mfma_f32_16x16x32_bf16 v[112:115], v[128:131], v[156:159], v[112:115]
    v_mfma_f32_16x16x32_bf16 v[116:119], v[132:135], v[156:159], v[116:119]
    v_mfma_f32_16x16x32_bf16 v[120:123], v[136:139], v[156:159], v[120:123]
    v_mfma_f32_16x16x32_bf16 v[124:127], v[140:143], v[156:159], v[124:127]
    v_lshrrev_b32 v12, 4, v1
    v_mul_u32_u24 v15, 10240, v12
    v_and_b32 v14, 15, v1
    v_lshl_add_u32 v15, v14, 4, v15
    v_lshlrev_b32 v12, 4, v12
    s_lshl_b32 s40, s27, 8
    s_add_u32 s40, s40, 148480
    v_add_u32 v12, s40, v12
    v_lshlrev_b32 v14, 2, v14
    s_lshl_b32 s40, s28, 8
    s_add_u32 s40, s40, 147456
    v_add_u32 v14, s40, v14
    ds_read2_b32 v[16:17], v14 offset0:0 offset1:16
    ds_read2_b32 v[18:19], v14 offset0:32 offset1:48
    ds_read_b128 v[32:35], v12 offset:0
    ds_read_b128 v[48:51], v12 offset:512
    ds_read_b128 v[36:39], v12 offset:64
    ds_read_b128 v[52:55], v12 offset:576
    ds_read_b128 v[40:43], v12 offset:128
    ds_read_b128 v[56:59], v12 offset:640
    ds_read_b128 v[44:47], v12 offset:192
    ds_read_b128 v[60:63], v12 offset:704
    s_lshl_b32 s42, s24, 1
    s_add_u32 s42, s42, s27
    s_mul_i32 s42, s42, 81920
    s_sub_u32 s40, s25, 10
    s_lshl_b32 s40, s40, 11
    s_add_u32 s42, s42, s40
    s_lshl_b32 s40, s28, 10
    s_add_u32 s42, s42, s40
    s_add_u32 s33, s42, 5242880
    s_add_u32 s34, s33, 40960
    s_waitcnt lgkmcnt(0)
    v_pk_fma_f32 v[64:65], v[32:33], v[16:17], v[64:65] op_sel:[0,0,0] op_sel_hi:[1,0,1]
    v_pk_fma_f32 v[66:67], v[34:35], v[16:17], v[66:67] op_sel:[0,0,0] op_sel_hi:[1,0,1]
    v_pk_fma_f32 v[68:69], v[36:37], v[16:17], v[68:69] op_sel:[0,0,0] op_sel_hi:[1,0,1]
    v_pk_fma_f32 v[70:71], v[38:39], v[16:17], v[70:71] op_sel:[0,0,0] op_sel_hi:[1,0,1]
    v_pk_mul_f32 v[64:65], v[48:49], v[64:65]
    v_pk_mul_f32 v[66:67], v[50:51], v[66:67]
    v_pk_mul_f32 v[68:69], v[52:53], v[68:69]
    v_pk_mul_f32 v[70:71], v[54:55], v[70:71]
    v_cvt_pk_bf16_f32 v64, v64, v65
    v_cvt_pk_bf16_f32 v65, v66, v67
    v_cvt_pk_bf16_f32 v66, v68, v69
    v_cvt_pk_bf16_f32 v67, v70, v71
    buffer_store_dwordx4 v[64:67], v15, s[8:11], s33 offen offset:0 sc1
    v_pk_fma_f32 v[80:81], v[32:33], v[16:17], v[80:81] op_sel:[0,1,0] op_sel_hi:[1,1,1]
    v_pk_fma_f32 v[82:83], v[34:35], v[16:17], v[82:83] op_sel:[0,1,0] op_sel_hi:[1,1,1]
    v_pk_fma_f32 v[84:85], v[36:37], v[16:17], v[84:85] op_sel:[0,1,0] op_sel_hi:[1,1,1]
    v_pk_fma_f32 v[86:87], v[38:39], v[16:17], v[86:87] op_sel:[0,1,0] op_sel_hi:[1,1,1]
    v_pk_mul_f32 v[80:81], v[48:49], v[80:81]
    v_pk_mul_f32 v[82:83], v[50:51], v[82:83]
    v_pk_mul_f32 v[84:85], v[52:53], v[84:85]
    v_pk_mul_f32 v[86:87], v[54:55], v[86:87]
    v_cvt_pk_bf16_f32 v80, v80, v81
    v_cvt_pk_bf16_f32 v81, v82, v83
    v_cvt_pk_bf16_f32 v82, v84, v85
    v_cvt_pk_bf16_f32 v83, v86, v87
    buffer_store_dwordx4 v[80:83], v15, s[8:11], s33 offen offset:256 sc1
    v_pk_fma_f32 v[96:97], v[32:33], v[18:19], v[96:97] op_sel:[0,0,0] op_sel_hi:[1,0,1]
    v_pk_fma_f32 v[98:99], v[34:35], v[18:19], v[98:99] op_sel:[0,0,0] op_sel_hi:[1,0,1]
    v_pk_fma_f32 v[100:101], v[36:37], v[18:19], v[100:101] op_sel:[0,0,0] op_sel_hi:[1,0,1]
    v_pk_fma_f32 v[102:103], v[38:39], v[18:19], v[102:103] op_sel:[0,0,0] op_sel_hi:[1,0,1]
    v_pk_mul_f32 v[96:97], v[48:49], v[96:97]
    v_pk_mul_f32 v[98:99], v[50:51], v[98:99]
    v_pk_mul_f32 v[100:101], v[52:53], v[100:101]
    v_pk_mul_f32 v[102:103], v[54:55], v[102:103]
    v_cvt_pk_bf16_f32 v96, v96, v97
    v_cvt_pk_bf16_f32 v97, v98, v99
    v_cvt_pk_bf16_f32 v98, v100, v101
    v_cvt_pk_bf16_f32 v99, v102, v103
    buffer_store_dwordx4 v[96:99], v15, s[8:11], s33 offen offset:512 sc1
    v_pk_fma_f32 v[112:113], v[32:33], v[18:19], v[112:113] op_sel:[0,1,0] op_sel_hi:[1,1,1]
    v_pk_fma_f32 v[114:115], v[34:35], v[18:19], v[114:115] op_sel:[0,1,0] op_sel_hi:[1,1,1]
    v_pk_fma_f32 v[116:117], v[36:37], v[18:19], v[116:117] op_sel:[0,1,0] op_sel_hi:[1,1,1]
    v_pk_fma_f32 v[118:119], v[38:39], v[18:19], v[118:119] op_sel:[0,1,0] op_sel_hi:[1,1,1]
    v_pk_mul_f32 v[112:113], v[48:49], v[112:113]
    v_pk_mul_f32 v[114:115], v[50:51], v[114:115]
    v_pk_mul_f32 v[116:117], v[52:53], v[116:117]
    v_pk_mul_f32 v[118:119], v[54:55], v[118:119]
    v_cvt_pk_bf16_f32 v112, v112, v113
    v_cvt_pk_bf16_f32 v113, v114, v115
    v_cvt_pk_bf16_f32 v114, v116, v117
    v_cvt_pk_bf16_f32 v115, v118, v119
    buffer_store_dwordx4 v[112:115], v15, s[8:11], s33 offen offset:768 sc1
    v_pk_fma_f32 v[72:73], v[40:41], v[16:17], v[72:73] op_sel:[0,0,0] op_sel_hi:[1,0,1]
    v_pk_fma_f32 v[74:75], v[42:43], v[16:17], v[74:75] op_sel:[0,0,0] op_sel_hi:[1,0,1]
    v_pk_fma_f32 v[76:77], v[44:45], v[16:17], v[76:77] op_sel:[0,0,0] op_sel_hi:[1,0,1]
    v_pk_fma_f32 v[78:79], v[46:47], v[16:17], v[78:79] op_sel:[0,0,0] op_sel_hi:[1,0,1]
    v_pk_mul_f32 v[72:73], v[56:57], v[72:73]
    v_pk_mul_f32 v[74:75], v[58:59], v[74:75]
    v_pk_mul_f32 v[76:77], v[60:61], v[76:77]
    v_pk_mul_f32 v[78:79], v[62:63], v[78:79]
    v_cvt_pk_bf16_f32 v72, v72, v73
    v_cvt_pk_bf16_f32 v73, v74, v75
    v_cvt_pk_bf16_f32 v74, v76, v77
    v_cvt_pk_bf16_f32 v75, v78, v79
    buffer_store_dwordx4 v[72:75], v15, s[8:11], s34 offen offset:0 sc1
    v_pk_fma_f32 v[88:89], v[40:41], v[16:17], v[88:89] op_sel:[0,1,0] op_sel_hi:[1,1,1]
    v_pk_fma_f32 v[90:91], v[42:43], v[16:17], v[90:91] op_sel:[0,1,0] op_sel_hi:[1,1,1]
    v_pk_fma_f32 v[92:93], v[44:45], v[16:17], v[92:93] op_sel:[0,1,0] op_sel_hi:[1,1,1]
    v_pk_fma_f32 v[94:95], v[46:47], v[16:17], v[94:95] op_sel:[0,1,0] op_sel_hi:[1,1,1]
    v_pk_mul_f32 v[88:89], v[56:57], v[88:89]
    v_pk_mul_f32 v[90:91], v[58:59], v[90:91]
    v_pk_mul_f32 v[92:93], v[60:61], v[92:93]
    v_pk_mul_f32 v[94:95], v[62:63], v[94:95]
    v_cvt_pk_bf16_f32 v88, v88, v89
    v_cvt_pk_bf16_f32 v89, v90, v91
    v_cvt_pk_bf16_f32 v90, v92, v93
    v_cvt_pk_bf16_f32 v91, v94, v95
    buffer_store_dwordx4 v[88:91], v15, s[8:11], s34 offen offset:256 sc1
    v_pk_fma_f32 v[104:105], v[40:41], v[18:19], v[104:105] op_sel:[0,0,0] op_sel_hi:[1,0,1]
    v_pk_fma_f32 v[106:107], v[42:43], v[18:19], v[106:107] op_sel:[0,0,0] op_sel_hi:[1,0,1]
    v_pk_fma_f32 v[108:109], v[44:45], v[18:19], v[108:109] op_sel:[0,0,0] op_sel_hi:[1,0,1]
    v_pk_fma_f32 v[110:111], v[46:47], v[18:19], v[110:111] op_sel:[0,0,0] op_sel_hi:[1,0,1]
    v_pk_mul_f32 v[104:105], v[56:57], v[104:105]
    v_pk_mul_f32 v[106:107], v[58:59], v[106:107]
    v_pk_mul_f32 v[108:109], v[60:61], v[108:109]
    v_pk_mul_f32 v[110:111], v[62:63], v[110:111]
    v_cvt_pk_bf16_f32 v104, v104, v105
    v_cvt_pk_bf16_f32 v105, v106, v107
    v_cvt_pk_bf16_f32 v106, v108, v109
    v_cvt_pk_bf16_f32 v107, v110, v111
    buffer_store_dwordx4 v[104:107], v15, s[8:11], s34 offen offset:512 sc1
    v_pk_fma_f32 v[120:121], v[40:41], v[18:19], v[120:121] op_sel:[0,1,0] op_sel_hi:[1,1,1]
    v_pk_fma_f32 v[122:123], v[42:43], v[18:19], v[122:123] op_sel:[0,1,0] op_sel_hi:[1,1,1]
    v_pk_fma_f32 v[124:125], v[44:45], v[18:19], v[124:125] op_sel:[0,1,0] op_sel_hi:[1,1,1]
    v_pk_fma_f32 v[126:127], v[46:47], v[18:19], v[126:127] op_sel:[0,1,0] op_sel_hi:[1,1,1]
    v_pk_mul_f32 v[120:121], v[56:57], v[120:121]
    v_pk_mul_f32 v[122:123], v[58:59], v[122:123]
    v_pk_mul_f32 v[124:125], v[60:61], v[124:125]
    v_pk_mul_f32 v[126:127], v[62:63], v[126:127]
    v_cvt_pk_bf16_f32 v120, v120, v121
    v_cvt_pk_bf16_f32 v121, v122, v123
    v_cvt_pk_bf16_f32 v122, v124, v125
    v_cvt_pk_bf16_f32 v123, v126, v127
    buffer_store_dwordx4 v[120:123], v15, s[8:11], s34 offen offset:768 sc1
    s_lshl_b32 s40, s25, 4
    s_add_u32 s40, s40, s24
    s_lshl_b32 s40, s40, 5
    s_add_u32 s40, s40, s12
    s_lshl_b32 s40, s40, 2
    s_add_u32 s40, s40, 28491776
    s_barrier
    v_mov_b32 v12, s13
    v_mov_b32 v13, 0
    s_waitcnt vmcnt(0)
    s_mov_b64 exec, 1
    buffer_store_dword v12, v13, s[8:11], s40 offen sc1
    s_mov_b64 exec, -1
    s_setprio 0
    s_barrier
    s_branch L_f_adone_2
L_f_idle_8:
    s_barrier
    s_barrier
    s_barrier
    s_barrier
    s_barrier
    s_barrier
    s_barrier
    s_barrier
    s_barrier
    s_barrier
    s_barrier
    s_branch L_f_adone_2
L_f_retile_5:
    s_waitcnt lgkmcnt(0)
    s_barrier
    s_mov_b32 s23, 0x00020000
    s_lshl_b32 s4, s12, 4
    s_add_u32 s4, s4, s3
    s_mul_i32 s28, s12, 20480
    v_add_u32 v2, 0, v1
    v_mul_u32_u24 v3, 1639, v2
    v_lshrrev_b32 v22, 16, v3
    v_mul_u32_u24 v4, 40, v22
    v_sub_u32 v4, v2, v4
    v_lshlrev_b32 v4, 4, v4
    v_mul_u32_u24 v5, 1280, v22
    v_add_u32 v12, v4, v5
    v_add_u32 v2, 64, v1
    v_mul_u32_u24 v3, 1639, v2
    v_lshrrev_b32 v23, 16, v3
    v_mul_u32_u24 v4, 40, v23
    v_sub_u32 v4, v2, v4
    v_lshlrev_b32 v4, 4, v4
    v_mul_u32_u24 v5, 1280, v23
    v_add_u32 v13, v4, v5
    v_add_u32 v2, 128, v1
    v_mul_u32_u24 v3, 1639, v2
    v_lshrrev_b32 v24, 16, v3
    v_mul_u32_u24 v4, 40, v24
    v_sub_u32 v4, v2, v4
    v_lshlrev_b32 v4, 4, v4
    v_mul_u32_u24 v5, 1280, v24
    v_add_u32 v14, v4, v5
    v_add_u32 v2, 192, v1
    v_mul_u32_u24 v3, 1639, v2
    v_lshrrev_b32 v25, 16, v3
    v_mul_u32_u24 v4, 40, v25
    v_sub_u32 v4, v2, v4
    v_lshlrev_b32 v4, 4, v4
    v_mul_u32_u24 v5, 1280, v25
    v_add_u32 v15, v4, v5
    v_add_u32 v2, 256, v1
    v_mul_u32_u24 v3, 1639, v2
    v_lshrrev_b32 v26, 16, v3
    v_mul_u32_u24 v4, 40, v26
    v_sub_u32 v4, v2, v4
    v_lshlrev_b32 v4, 4, v4
    v_mul_u32_u24 v5, 1280, v26
    v_add_u32 v16, v4, v5
    v_add_u32 v2, 320, v1
    v_mul_u32_u24 v3, 1639, v2
    v_lshrrev_b32 v27, 16, v3
    v_mul_u32_u24 v4, 40, v27
    v_sub_u32 v4, v2, v4
    v_lshlrev_b32 v4, 4, v4
    v_mul_u32_u24 v5, 1280, v27
    v_add_u32 v17, v4, v5
    v_add_u32 v2, 384, v1
    v_mul_u32_u24 v3, 1639, v2
    v_lshrrev_b32 v28, 16, v3
    v_mul_u32_u24 v4, 40, v28
    v_sub_u32 v4, v2, v4
    v_lshlrev_b32 v4, 4, v4
    v_mul_u32_u24 v5, 1280, v28
    v_add_u32 v18, v4, v5
    v_add_u32 v2, 448, v1
    v_mul_u32_u24 v3, 1639, v2
    v_lshrrev_b32 v29, 16, v3
    v_mul_u32_u24 v4, 40, v29
    v_sub_u32 v4, v2, v4
    v_lshlrev_b32 v4, 4, v4
    v_mul_u32_u24 v5, 1280, v29
    v_add_u32 v19, v4, v5
    v_add_u32 v2, 512, v1
    v_mul_u32_u24 v3, 1639, v2
    v_lshrrev_b32 v30, 16, v3
    v_mul_u32_u24 v4, 40, v30
    v_sub_u32 v4, v2, v4
    v_lshlrev_b32 v4, 4, v4
    v_mul_u32_u24 v5, 1280, v30
    v_add_u32 v20, v4, v5
    v_add_u32 v2, 576, v1
    v_mul_u32_u24 v3, 1639, v2
    v_lshrrev_b32 v31, 16, v3
    v_mul_u32_u24 v4, 40, v31
    v_sub_u32 v4, v2, v4
    v_lshlrev_b32 v4, 4, v4
    v_mul_u32_u24 v5, 1280, v31
    v_add_u32 v21, v4, v5
    v_lshrrev_b32 v2, 5, v1
    v_lshlrev_b32 v2, 2, v2
    v_bfe_u32 v3, v1, 2, 2
    v_add_u32 v2, v2, v3
    v_mul_u32_u24 v2, 640, v2
    v_bfe_u32 v3, v1, 4, 1
    v_lshlrev_b32 v3, 5, v3
    v_add_u32 v2, v2, v3
    v_and_b32 v3, 3, v1
    v_lshlrev_b32 v3, 3, v3
    v_add_u32 v2, v2, v3
    v_add_u32 v6, s28, v2
    v_lshlrev_b32 v7, 4, v1
    s_waitcnt lgkmcnt(0)
    s_add_u32 s24, s4, 0
    s_lshr_b32 s40, s24, 1
    s_and_b32 s41, s24, 1
    s_lshr_b32 s42, s40, 1
    s_lshl_b32 s42, s42, 5
    s_and_b32 s43, s40, 1
    s_lshl_b32 s43, s43, 3
    s_add_u32 s42, s42, s43
    s_sub_u32 s43, s40, 108
    s_mul_i32 s43, s43, 20
    s_cmp_ge_u32 s40, 108
    s_cselect_b32 s42, s43, s42
    s_cselect_b32 s29, 0, 10240
    s_cselect_b32 s20, s52, s58
    s_cselect_b32 s21, s53, s59
    s_mov_b32 s43, 2211840
    s_cselect_b32 s22, 819200, s43
    s_sub_u32 s43, s40, 140
    s_mul_i32 s43, s43, 80
    s_add_u32 s43, s43, 16
    s_cmp_ge_u32 s40, 140
    s_cselect_b32 s42, s43, s42
    s_cselect_b32 s27, 20480, 0
    s_mul_i32 s25, s42, 1280
    s_mul_i32 s41, s41, 640
    s_add_u32 s25, s25, s41
    v_lshrrev_b32 v8, 2, v22
    v_mad_u32_u24 v8, v8, s27, v12
    v_lshrrev_b32 v9, 3, v22
    s_add_u32 m0, s28, 0
    v_mad_u32_u24 v8, v9, s29, v8
    buffer_load_dwordx4 v8, s[20:23], s25 offen lds
    v_lshrrev_b32 v8, 2, v23
    v_mad_u32_u24 v8, v8, s27, v13
    v_lshrrev_b32 v9, 3, v23
    s_add_u32 m0, s28, 1024
    v_mad_u32_u24 v8, v9, s29, v8
    buffer_load_dwordx4 v8, s[20:23], s25 offen lds
    v_lshrrev_b32 v8, 2, v24
    v_mad_u32_u24 v8, v8, s27, v14
    v_lshrrev_b32 v9, 3, v24
    s_add_u32 m0, s28, 2048
    v_mad_u32_u24 v8, v9, s29, v8
    buffer_load_dwordx4 v8, s[20:23], s25 offen lds
    v_lshrrev_b32 v8, 2, v25
    v_mad_u32_u24 v8, v8, s27, v15
    v_lshrrev_b32 v9, 3, v25
    s_add_u32 m0, s28, 3072
    v_mad_u32_u24 v8, v9, s29, v8
    buffer_load_dwordx4 v8, s[20:23], s25 offen lds
    v_lshrrev_b32 v8, 2, v26
    v_mad_u32_u24 v8, v8, s27, v16
    v_lshrrev_b32 v9, 3, v26
    s_add_u32 m0, s28, 4096
    v_mad_u32_u24 v8, v9, s29, v8
    buffer_load_dwordx4 v8, s[20:23], s25 offen lds
    v_lshrrev_b32 v8, 2, v27
    v_mad_u32_u24 v8, v8, s27, v17
    v_lshrrev_b32 v9, 3, v27
    s_add_u32 m0, s28, 5120
    v_mad_u32_u24 v8, v9, s29, v8
    buffer_load_dwordx4 v8, s[20:23], s25 offen lds
    v_lshrrev_b32 v8, 2, v28
    v_mad_u32_u24 v8, v8, s27, v18
    v_lshrrev_b32 v9, 3, v28
    s_add_u32 m0, s28, 6144
    v_mad_u32_u24 v8, v9, s29, v8
    buffer_load_dwordx4 v8, s[20:23], s25 offen lds
    v_lshrrev_b32 v8, 2, v29
    v_mad_u32_u24 v8, v8, s27, v19
    v_lshrrev_b32 v9, 3, v29
    s_add_u32 m0, s28, 7168
    v_mad_u32_u24 v8, v9, s29, v8
    buffer_load_dwordx4 v8, s[20:23], s25 offen lds
    v_lshrrev_b32 v8, 2, v30
    v_mad_u32_u24 v8, v8, s27, v20
    v_lshrrev_b32 v9, 3, v30
    s_add_u32 m0, s28, 8192
    v_mad_u32_u24 v8, v9, s29, v8
    buffer_load_dwordx4 v8, s[20:23], s25 offen lds
    v_lshrrev_b32 v8, 2, v31
    v_mad_u32_u24 v8, v8, s27, v21
    v_lshrrev_b32 v9, 3, v31
    s_add_u32 m0, s28, 9216
    v_mad_u32_u24 v8, v9, s29, v8
    buffer_load_dwordx4 v8, s[20:23], s25 offen lds
    s_add_u32 s24, s4, 128
    s_lshr_b32 s40, s24, 1
    s_and_b32 s41, s24, 1
    s_lshr_b32 s42, s40, 1
    s_lshl_b32 s42, s42, 5
    s_and_b32 s43, s40, 1
    s_lshl_b32 s43, s43, 3
    s_add_u32 s42, s42, s43
    s_sub_u32 s43, s40, 108
    s_mul_i32 s43, s43, 20
    s_cmp_ge_u32 s40, 108
    s_cselect_b32 s42, s43, s42
    s_cselect_b32 s29, 0, 10240
    s_cselect_b32 s20, s52, s58
    s_cselect_b32 s21, s53, s59
    s_mov_b32 s43, 2211840
    s_cselect_b32 s22, 819200, s43
    s_sub_u32 s43, s40, 140
    s_mul_i32 s43, s43, 80
    s_add_u32 s43, s43, 16
    s_cmp_ge_u32 s40, 140
    s_cselect_b32 s42, s43, s42
    s_cselect_b32 s27, 20480, 0
    s_mul_i32 s25, s42, 1280
    s_mul_i32 s41, s41, 640
    s_add_u32 s25, s25, s41
    v_lshrrev_b32 v8, 2, v22
    v_mad_u32_u24 v8, v8, s27, v12
    v_lshrrev_b32 v9, 3, v22
    s_add_u32 m0, s28, 10240
    v_mad_u32_u24 v8, v9, s29, v8
    buffer_load_dwordx4 v8, s[20:23], s25 offen lds
    v_lshrrev_b32 v8, 2, v23
    v_mad_u32_u24 v8, v8, s27, v13
    v_lshrrev_b32 v9, 3, v23
    s_add_u32 m0, s28, 11264
    v_mad_u32_u24 v8, v9, s29, v8
    buffer_load_dwordx4 v8, s[20:23], s25 offen lds
    v_lshrrev_b32 v8, 2, v24
    v_mad_u32_u24 v8, v8, s27, v14
    v_lshrrev_b32 v9, 3, v24
    s_add_u32 m0, s28, 12288
    v_mad_u32_u24 v8, v9, s29, v8
    buffer_load_dwordx4 v8, s[20:23], s25 offen lds
    v_lshrrev_b32 v8, 2, v25
    v_mad_u32_u24 v8, v8, s27, v15
    v_lshrrev_b32 v9, 3, v25
    s_add_u32 m0, s28, 13312
    v_mad_u32_u24 v8, v9, s29, v8
    buffer_load_dwordx4 v8, s[20:23], s25 offen lds
    v_lshrrev_b32 v8, 2, v26
    v_mad_u32_u24 v8, v8, s27, v16
    v_lshrrev_b32 v9, 3, v26
    s_add_u32 m0, s28, 14336
    v_mad_u32_u24 v8, v9, s29, v8
    buffer_load_dwordx4 v8, s[20:23], s25 offen lds
    v_lshrrev_b32 v8, 2, v27
    v_mad_u32_u24 v8, v8, s27, v17
    v_lshrrev_b32 v9, 3, v27
    s_add_u32 m0, s28, 15360
    v_mad_u32_u24 v8, v9, s29, v8
    buffer_load_dwordx4 v8, s[20:23], s25 offen lds
    v_lshrrev_b32 v8, 2, v28
    v_mad_u32_u24 v8, v8, s27, v18
    v_lshrrev_b32 v9, 3, v28
    s_add_u32 m0, s28, 16384
    v_mad_u32_u24 v8, v9, s29, v8
    buffer_load_dwordx4 v8, s[20:23], s25 offen lds
    v_lshrrev_b32 v8, 2, v29
    v_mad_u32_u24 v8, v8, s27, v19
    v_lshrrev_b32 v9, 3, v29
    s_add_u32 m0, s28, 17408
    v_mad_u32_u24 v8, v9, s29, v8
    buffer_load_dwordx4 v8, s[20:23], s25 offen lds
    v_lshrrev_b32 v8, 2, v30
    v_mad_u32_u24 v8, v8, s27, v20
    v_lshrrev_b32 v9, 3, v30
    s_add_u32 m0, s28, 18432
    v_mad_u32_u24 v8, v9, s29, v8
    buffer_load_dwordx4 v8, s[20:23], s25 offen lds
    v_lshrrev_b32 v8, 2, v31
    v_mad_u32_u24 v8, v8, s27, v21
    v_lshrrev_b32 v9, 3, v31
    s_add_u32 m0, s28, 19456
    v_mad_u32_u24 v8, v9, s29, v8
    buffer_load_dwordx4 v8, s[20:23], s25 offen lds
    s_waitcnt vmcnt(10)
    ds_read_b64_tr_b16 v[32:33], v6 offset:0
    ds_read_b64_tr_b16 v[34:35], v6 offset:5120
    ds_read_b64_tr_b16 v[36:37], v6 offset:64
    ds_read_b64_tr_b16 v[38:39], v6 offset:5184
    ds_read_b64_tr_b16 v[40:41], v6 offset:128
    ds_read_b64_tr_b16 v[42:43], v6 offset:5248
    ds_read_b64_tr_b16 v[44:45], v6 offset:192
    ds_read_b64_tr_b16 v[46:47], v6 offset:5312
    ds_read_b64_tr_b16 v[48:49], v6 offset:256
    ds_read_b64_tr_b16 v[50:51], v6 offset:5376
    ds_read_b64_tr_b16 v[52:53], v6 offset:320
    ds_read_b64_tr_b16 v[54:55], v6 offset:5440
    ds_read_b64_tr_b16 v[56:57], v6 offset:384
    ds_read_b64_tr_b16 v[58:59], v6 offset:5504
    ds_read_b64_tr_b16 v[60:61], v6 offset:448
    ds_read_b64_tr_b16 v[62:63], v6 offset:5568
    ds_read_b64_tr_b16 v[64:65], v6 offset:512
    ds_read_b64_tr_b16 v[66:67], v6 offset:5632
    ds_read_b64_tr_b16 v[68:69], v6 offset:576
    ds_read_b64_tr_b16 v[70:71], v6 offset:5696
    s_waitcnt lgkmcnt(0)
    s_cmp_ge_u32 s4, 40
    s_cbranch_scc1 L_f_two_37
    s_add_u32 s24, s4, 256
    s_lshr_b32 s40, s24, 1
    s_and_b32 s41, s24, 1
    s_lshr_b32 s42, s40, 1
    s_lshl_b32 s42, s42, 5
    s_and_b32 s43, s40, 1
    s_lshl_b32 s43, s43, 3
    s_add_u32 s42, s42, s43
    s_sub_u32 s43, s40, 108
    s_mul_i32 s43, s43, 20
    s_cmp_ge_u32 s40, 108
    s_cselect_b32 s42, s43, s42
    s_cselect_b32 s29, 0, 10240
    s_cselect_b32 s20, s52, s58
    s_cselect_b32 s21, s53, s59
    s_mov_b32 s43, 2211840
    s_cselect_b32 s22, 819200, s43
    s_sub_u32 s43, s40, 140
    s_mul_i32 s43, s43, 80
    s_add_u32 s43, s43, 16
    s_cmp_ge_u32 s40, 140
    s_cselect_b32 s42, s43, s42
    s_cselect_b32 s27, 20480, 0
    s_mul_i32 s25, s42, 1280
    s_mul_i32 s41, s41, 640
    s_add_u32 s25, s25, s41
    v_lshrrev_b32 v8, 2, v22
    v_mad_u32_u24 v8, v8, s27, v12
    v_lshrrev_b32 v9, 3, v22
    s_add_u32 m0, s28, 0
    v_mad_u32_u24 v8, v9, s29, v8
    buffer_load_dwordx4 v8, s[20:23], s25 offen lds
    v_lshrrev_b32 v8, 2, v23
    v_mad_u32_u24 v8, v8, s27, v13
    v_lshrrev_b32 v9, 3, v23
    s_add_u32 m0, s28, 1024
    v_mad_u32_u24 v8, v9, s29, v8
    buffer_load_dwordx4 v8, s[20:23], s25 offen lds
    v_lshrrev_b32 v8, 2, v24
    v_mad_u32_u24 v8, v8, s27, v14
    v_lshrrev_b32 v9, 3, v24
    s_add_u32 m0, s28, 2048
    v_mad_u32_u24 v8, v9, s29, v8
    buffer_load_dwordx4 v8, s[20:23], s25 offen lds
    v_lshrrev_b32 v8, 2, v25
    v_mad_u32_u24 v8, v8, s27, v15
    v_lshrrev_b32 v9, 3, v25
    s_add_u32 m0, s28, 3072
    v_mad_u32_u24 v8, v9, s29, v8
    buffer_load_dwordx4 v8, s[20:23], s25 offen lds
    v_lshrrev_b32 v8, 2, v26
    v_mad_u32_u24 v8, v8, s27, v16
    v_lshrrev_b32 v9, 3, v26
    s_add_u32 m0, s28, 4096
    v_mad_u32_u24 v8, v9, s29, v8
    buffer_load_dwordx4 v8, s[20:23], s25 offen lds
    v_lshrrev_b32 v8, 2, v27
    v_mad_u32_u24 v8, v8, s27, v17
    v_lshrrev_b32 v9, 3, v27
    s_add_u32 m0, s28, 5120
    v_mad_u32_u24 v8, v9, s29, v8
    buffer_load_dwordx4 v8, s[20:23], s25 offen lds
    v_lshrrev_b32 v8, 2, v28
    v_mad_u32_u24 v8, v8, s27, v18
    v_lshrrev_b32 v9, 3, v28
    s_add_u32 m0, s28, 6144
    v_mad_u32_u24 v8, v9, s29, v8
    buffer_load_dwordx4 v8, s[20:23], s25 offen lds
    v_lshrrev_b32 v8, 2, v29
    v_mad_u32_u24 v8, v8, s27, v19
    v_lshrrev_b32 v9, 3, v29
    s_add_u32 m0, s28, 7168
    v_mad_u32_u24 v8, v9, s29, v8
    buffer_load_dwordx4 v8, s[20:23], s25 offen lds
    v_lshrrev_b32 v8, 2, v30
    v_mad_u32_u24 v8, v8, s27, v20
    v_lshrrev_b32 v9, 3, v30
    s_add_u32 m0, s28, 8192
    v_mad_u32_u24 v8, v9, s29, v8
    buffer_load_dwordx4 v8, s[20:23], s25 offen lds
    v_lshrrev_b32 v8, 2, v31
    v_mad_u32_u24 v8, v8, s27, v21
    v_lshrrev_b32 v9, 3, v31
    s_add_u32 m0, s28, 9216
    v_mad_u32_u24 v8, v9, s29, v8
    buffer_load_dwordx4 v8, s[20:23], s25 offen lds
    s_waitcnt vmcnt(10)
    ds_read_b64_tr_b16 v[72:73], v6 offset:10240
    ds_read_b64_tr_b16 v[74:75], v6 offset:15360
    ds_read_b64_tr_b16 v[76:77], v6 offset:10304
    ds_read_b64_tr_b16 v[78:79], v6 offset:15424
    ds_read_b64_tr_b16 v[80:81], v6 offset:10368
    ds_read_b64_tr_b16 v[82:83], v6 offset:15488
    ds_read_b64_tr_b16 v[84:85], v6 offset:10432
    ds_read_b64_tr_b16 v[86:87], v6 offset:15552
    ds_read_b64_tr_b16 v[88:89], v6 offset:10496
    ds_read_b64_tr_b16 v[90:91], v6 offset:15616
    ds_read_b64_tr_b16 v[92:93], v6 offset:10560
    ds_read_b64_tr_b16 v[94:95], v6 offset:15680
    ds_read_b64_tr_b16 v[96:97], v6 offset:10624
    ds_read_b64_tr_b16 v[98:99], v6 offset:15744
    ds_read_b64_tr_b16 v[100:101], v6 offset:10688
    ds_read_b64_tr_b16 v[102:103], v6 offset:15808
    ds_read_b64_tr_b16 v[104:105], v6 offset:10752
    ds_read_b64_tr_b16 v[106:107], v6 offset:15872
    ds_read_b64_tr_b16 v[108:109], v6 offset:10816
    ds_read_b64_tr_b16 v[110:111], v6 offset:15936
    s_waitcnt lgkmcnt(0)
    s_waitcnt vmcnt(0)
    ds_read_b64_tr_b16 v[112:113], v6 offset:0
    ds_read_b64_tr_b16 v[114:115], v6 offset:5120
    ds_read_b64_tr_b16 v[116:117], v6 offset:64
    ds_read_b64_tr_b16 v[118:119], v6 offset:5184
    ds_read_b64_tr_b16 v[120:121], v6 offset:128
    ds_read_b64_tr_b16 v[122:123], v6 offset:5248
    ds_read_b64_tr_b16 v[124:125], v6 offset:192
    ds_read_b64_tr_b16 v[126:127], v6 offset:5312
    ds_read_b64_tr_b16 v[128:129], v6 offset:256
    ds_read_b64_tr_b16 v[130:131], v6 offset:5376
    ds_read_b64_tr_b16 v[132:133], v6 offset:320
    ds_read_b64_tr_b16 v[134:135], v6 offset:5440
    ds_read_b64_tr_b16 v[136:137], v6 offset:384
    ds_read_b64_tr_b16 v[138:139], v6 offset:5504
    ds_read_b64_tr_b16 v[140:141], v6 offset:448
    ds_read_b64_tr_b16 v[142:143], v6 offset:5568
    ds_read_b64_tr_b16 v[144:145], v6 offset:512
    ds_read_b64_tr_b16 v[146:147], v6 offset:5632
    ds_read_b64_tr_b16 v[148:149], v6 offset:576
    ds_read_b64_tr_b16 v[150:151], v6 offset:5696
    s_waitcnt lgkmcnt(0)
    s_barrier
    s_add_u32 s24, s4, 256
    s_lshr_b32 s40, s24, 1
    s_and_b32 s41, s24, 1
    s_mul_i32 s26, s24, 10240
    s_add_u32 s26, s26, 22806528
    buffer_store_dwordx4 v[112:115], v7, s[8:11], s26 offen offset:0 sc1
    buffer_store_dwordx4 v[116:119], v7, s[8:11], s26 offen offset:1024 sc1
    buffer_store_dwordx4 v[120:123], v7, s[8:11], s26 offen offset:2048 sc1
    buffer_store_dwordx4 v[124:127], v7, s[8:11], s26 offen offset:3072 sc1
    s_add_u32 s26, s26, 4096
    buffer_store_dwordx4 v[128:131], v7, s[8:11], s26 offen offset:0 sc1
    buffer_store_dwordx4 v[132:135], v7, s[8:11], s26 offen offset:1024 sc1
    buffer_store_dwordx4 v[136:139], v7, s[8:11], s26 offen offset:2048 sc1
    buffer_store_dwordx4 v[140:143], v7, s[8:11], s26 offen offset:3072 sc1
    s_add_u32 s26, s26, 4096
    buffer_store_dwordx4 v[144:147], v7, s[8:11], s26 offen offset:0 sc1
    buffer_store_dwordx4 v[148:151], v7, s[8:11], s26 offen offset:1024 sc1
    s_branch L_f_stores_38
L_f_two_37:
    s_waitcnt vmcnt(0)
    ds_read_b64_tr_b16 v[72:73], v6 offset:10240
    ds_read_b64_tr_b16 v[74:75], v6 offset:15360
    ds_read_b64_tr_b16 v[76:77], v6 offset:10304
    ds_read_b64_tr_b16 v[78:79], v6 offset:15424
    ds_read_b64_tr_b16 v[80:81], v6 offset:10368
    ds_read_b64_tr_b16 v[82:83], v6 offset:15488
    ds_read_b64_tr_b16 v[84:85], v6 offset:10432
    ds_read_b64_tr_b16 v[86:87], v6 offset:15552
    ds_read_b64_tr_b16 v[88:89], v6 offset:10496
    ds_read_b64_tr_b16 v[90:91], v6 offset:15616
    ds_read_b64_tr_b16 v[92:93], v6 offset:10560
    ds_read_b64_tr_b16 v[94:95], v6 offset:15680
    ds_read_b64_tr_b16 v[96:97], v6 offset:10624
    ds_read_b64_tr_b16 v[98:99], v6 offset:15744
    ds_read_b64_tr_b16 v[100:101], v6 offset:10688
    ds_read_b64_tr_b16 v[102:103], v6 offset:15808
    ds_read_b64_tr_b16 v[104:105], v6 offset:10752
    ds_read_b64_tr_b16 v[106:107], v6 offset:15872
    ds_read_b64_tr_b16 v[108:109], v6 offset:10816
    ds_read_b64_tr_b16 v[110:111], v6 offset:15936
    s_waitcnt lgkmcnt(0)
    s_barrier
L_f_stores_38:
    s_add_u32 s24, s4, 0
    s_lshr_b32 s40, s24, 1
    s_and_b32 s41, s24, 1
    s_mul_i32 s26, s24, 10240
    s_add_u32 s26, s26, 22806528
    buffer_store_dwordx4 v[32:35], v7, s[8:11], s26 offen offset:0 sc1
    buffer_store_dwordx4 v[36:39], v7, s[8:11], s26 offen offset:1024 sc1
    buffer_store_dwordx4 v[40:43], v7, s[8:11], s26 offen offset:2048 sc1
    buffer_store_dwordx4 v[44:47], v7, s[8:11], s26 offen offset:3072 sc1
    s_add_u32 s26, s26, 4096
    buffer_store_dwordx4 v[48:51], v7, s[8:11], s26 offen offset:0 sc1
    buffer_store_dwordx4 v[52:55], v7, s[8:11], s26 offen offset:1024 sc1
    buffer_store_dwordx4 v[56:59], v7, s[8:11], s26 offen offset:2048 sc1
    buffer_store_dwordx4 v[60:63], v7, s[8:11], s26 offen offset:3072 sc1
    s_add_u32 s26, s26, 4096
    buffer_store_dwordx4 v[64:67], v7, s[8:11], s26 offen offset:0 sc1
    buffer_store_dwordx4 v[68:71], v7, s[8:11], s26 offen offset:1024 sc1
    s_add_u32 s24, s4, 128
    s_lshr_b32 s40, s24, 1
    s_and_b32 s41, s24, 1
    s_mul_i32 s26, s24, 10240
    s_add_u32 s26, s26, 22806528
    buffer_store_dwordx4 v[72:75], v7, s[8:11], s26 offen offset:0 sc1
    buffer_store_dwordx4 v[76:79], v7, s[8:11], s26 offen offset:1024 sc1
    buffer_store_dwordx4 v[80:83], v7, s[8:11], s26 offen offset:2048 sc1
    buffer_store_dwordx4 v[84:87], v7, s[8:11], s26 offen offset:3072 sc1
    s_add_u32 s26, s26, 4096
    buffer_store_dwordx4 v[88:91], v7, s[8:11], s26 offen offset:0 sc1
    buffer_store_dwordx4 v[92:95], v7, s[8:11], s26 offen offset:1024 sc1
    buffer_store_dwordx4 v[96:99], v7, s[8:11], s26 offen offset:2048 sc1
    buffer_store_dwordx4 v[100:103], v7, s[8:11], s26 offen offset:3072 sc1
    s_add_u32 s26, s26, 4096
    buffer_store_dwordx4 v[104:107], v7, s[8:11], s26 offen offset:0 sc1
    buffer_store_dwordx4 v[108:111], v7, s[8:11], s26 offen offset:1024 sc1
    s_lshl_b32 s40, s3, 5
    s_add_u32 s40, s40, s12
    s_lshl_b32 s40, s40, 2
    s_add_u32 s60, s40, 28524544
    v_mov_b32 v2, 163832
    v_mov_b32 v3, s13
    ds_write_b32 v2, v3
    s_waitcnt lgkmcnt(0)
    s_barrier
    s_branch L_f_adone_2
L_f_loader_4:
    s_setprio 3
    s_and_b32 s3, s2, 7
    s_lshr_b32 s4, s2, 3
    s_cmp_ge_u32 s4, 30
    s_cbranch_scc0 L_f_gemm_39
    s_lshl_b32 s3, s3, 1
    s_add_u32 s3, s3, s4
    s_sub_u32 s3, s3, 30
    s_branch L_f_retile_loader_9
L_f_gemm_39:
    s_mul_i32 s3, s3, 30
    s_add_u32 s3, s3, s4
    s_cmp_ge_u32 s3, 120
    s_cselect_b32 s4, 120, 0
    s_cselect_b32 s5, 8, 0
    s_sub_u32 s3, s3, s4
    s_lshr_b32 s25, s3, 3
    s_and_b32 s3, s3, 7
    s_add_u32 s24, s3, s5
    s_mul_i32 s4, s25, 5
    s_add_u32 s3, s24, s4
    s_and_b32 s3, s3, 15
    s_mul_i32 s4, s3, 5
    s_lshr_b32 s4, s4, 1
    s_lshr_b32 s30, s4, 2
    s_and_b32 s4, s4, 3
    s_and_b32 s3, s3, 1
    s_lshl_b32 s3, s3, 2
    s_or_b32 s3, s3, 3
    s_lshl_b32 s37, s3, s4
    s_sub_u32 s36, s12, 8
    s_lshr_b32 s29, s36, 1
    s_cmp_eq_u32 s29, 0
    s_mov_b32 s40, 2211840
    s_cselect_b32 s22, 2457600, s40
    s_mov_b32 s23, 0x00020000
    s_mov_b32 s40, 3456
    s_cselect_b32 s26, 3840, s40
    s_lshl_b32 s35, s26, 2
    s_sub_u32 s35, s35, 1024
    s_lshl_b32 s31, s36, 12
    s_lshl_b32 s32, s36, 13
    s_add_u32 s32, s32, 16384
    s_and_b32 s40, s36, 1
    s_lshl_b32 s40, s40, 5
    v_lshrrev_b32 v12, 4, v1
    v_add_u32 v13, s40, v12
    v_mul_lo_u32 v13, v13, s26
    v_and_b32 v14, 15, v1
    v_lshlrev_b32 v12, 2, v12
    v_xor_b32 v14, v14, v12
    v_lshlrev_b32 v14, 4, v14
    s_lshl_b32 s41, s25, 8
    v_add3_u32 v10, v13, v14, s41
    v_xor_b32 v14, 32, v14
    v_add3_u32 v11, v13, v14, s41
    s_cmp_eq_u32 s25, 14
    s_cselect_b32 s40, s29, 0
    s_cmp_eq_u32 s40, 1
    s_cselect_b32 s22, 0, s22
    s_lshl_b32 s40, s24, 7
    s_lshl_b32 s41, s36, 5
    s_add_u32 s40, s40, s41
    v_lshrrev_b32 v12, 3, v1
    v_add_u32 v12, s40, v12
    v_mul_u32_u24 v12, 1280, v12
    v_and_b32 v13, 7, v1
    v_lshrrev_b32 v14, 4, v1
    v_xor_b32 v13, v13, v14
    v_lshlrev_b32 v13, 4, v13
    v_add_u32 v8, v12, v13
    v_xor_b32 v13, 64, v13
    v_add_u32 v9, v12, v13
    v_add_u32 v9, 9216, v9
    s_cmp_eq_u32 s29, 0
    s_waitcnt lgkmcnt(0)
    s_cselect_b32 s20, s50, s56
    s_cselect_b32 s21, s51, s57
    s_mov_b32 s16, s48
    s_mov_b32 s17, s49
    s_mov_b32 s18, 2621440
    s_mov_b32 s19, 0x00020000
    s_add_u32 m0, s31, 0
    s_lshl_b32 s33, s30, 7
    buffer_load_dwordx4 v8, s[16:19], s33 offen lds
    buffer_load_dwordx4 v9, s[16:19], s33 offen offset:1024 lds
    s_add_u32 s33, s33, 18432
    buffer_load_dwordx4 v8, s[16:19], s33 offen offset:2048 lds
    buffer_load_dwordx4 v9, s[16:19], s33 offen offset:3072 lds
    s_lshl_b32 s34, s30, 6
    s_mul_i32 s34, s34, s26
    s_add_u32 m0, s32, 0
    s_nop 0
    buffer_load_dwordx4 v10, s[20:23], s34 offen offset:0 lds
    s_add_u32 s34, s34, s35
    buffer_load_dwordx4 v10, s[20:23], s34 offen offset:1024 lds
    s_add_u32 s34, s34, s35
    buffer_load_dwordx4 v11, s[20:23], s34 offen offset:2048 lds
    s_add_u32 s34, s34, s35
    buffer_load_dwordx4 v11, s[20:23], s34 offen offset:3072 lds
    s_add_u32 m0, s32, 4096
    s_add_u32 s34, s34, 4096
    s_add_u32 s34, s34, s35
    buffer_load_dwordx4 v10, s[20:23], s34 offen offset:0 lds
    s_add_u32 s34, s34, s35
    buffer_load_dwordx4 v10, s[20:23], s34 offen offset:1024 lds
    s_add_u32 s34, s34, s35
    buffer_load_dwordx4 v11, s[20:23], s34 offen offset:2048 lds
    s_add_u32 s34, s34, s35
    buffer_load_dwordx4 v11, s[20:23], s34 offen offset:3072 lds
    s_add_u32 s30, s30, 1
    s_cmp_eq_u32 s30, 10
    s_cselect_b32 s30, 0, s30
    s_waitcnt vmcnt(0)
    s_barrier
    s_add_u32 m0, s31, 49152
    s_lshl_b32 s33, s30, 7
    buffer_load_dwordx4 v8, s[16:19], s33 offen lds
    buffer_load_dwordx4 v9, s[16:19], s33 offen offset:1024 lds
    s_add_u32 s33, s33, 18432
    buffer_load_dwordx4 v8, s[16:19], s33 offen offset:2048 lds
    buffer_load_dwordx4 v9, s[16:19], s33 offen offset:3072 lds
    s_lshl_b32 s34, s30, 6
    s_mul_i32 s34, s34, s26
    s_add_u32 m0, s32, 49152
    s_nop 0
    buffer_load_dwordx4 v10, s[20:23], s34 offen offset:0 lds
    s_add_u32 s34, s34, s35
    buffer_load_dwordx4 v10, s[20:23], s34 offen offset:1024 lds
    s_add_u32 s34, s34, s35
    buffer_load_dwordx4 v11, s[20:23], s34 offen offset:2048 lds
    s_add_u32 s34, s34, s35
    buffer_load_dwordx4 v11, s[20:23], s34 offen offset:3072 lds
    s_add_u32 m0, s32, 53248
    s_add_u32 s34, s34, 4096
    s_add_u32 s34, s34, s35
    buffer_load_dwordx4 v10, s[20:23], s34 offen offset:0 lds
    s_add_u32 s34, s34, s35
    buffer_load_dwordx4 v10, s[20:23], s34 offen offset:1024 lds
    s_add_u32 s34, s34, s35
    buffer_load_dwordx4 v11, s[20:23], s34 offen offset:2048 lds
    s_add_u32 s34, s34, s35
    buffer_load_dwordx4 v11, s[20:23], s34 offen offset:3072 lds
    s_add_u32 s30, s30, 1
    s_cmp_eq_u32 s30, 10
    s_cselect_b32 s30, 0, s30
    s_add_u32 m0, s31, 98304
    s_lshl_b32 s33, s30, 7
    buffer_load_dwordx4 v8, s[16:19], s33 offen lds
    buffer_load_dwordx4 v9, s[16:19], s33 offen offset:1024 lds
    s_add_u32 s33, s33, 18432
    buffer_load_dwordx4 v8, s[16:19], s33 offen offset:2048 lds
    buffer_load_dwordx4 v9, s[16:19], s33 offen offset:3072 lds
    s_lshl_b32 s34, s30, 6
    s_mul_i32 s34, s34, s26
    s_add_u32 m0, s32, 98304
    s_nop 0
    buffer_load_dwordx4 v10, s[20:23], s34 offen offset:0 lds
    s_add_u32 s34, s34, s35
    buffer_load_dwordx4 v10, s[20:23], s34 offen offset:1024 lds
    s_add_u32 s34, s34, s35
    buffer_load_dwordx4 v11, s[20:23], s34 offen offset:2048 lds
    s_add_u32 s34, s34, s35
    buffer_load_dwordx4 v11, s[20:23], s34 offen offset:3072 lds
    s_add_u32 m0, s32, 102400
    s_add_u32 s34, s34, 4096
    s_add_u32 s34, s34, s35
    buffer_load_dwordx4 v10, s[20:23], s34 offen offset:0 lds
    s_add_u32 s34, s34, s35
    buffer_load_dwordx4 v10, s[20:23], s34 offen offset:1024 lds
    s_add_u32 s34, s34, s35
    buffer_load_dwordx4 v11, s[20:23], s34 offen offset:2048 lds
    s_add_u32 s34, s34, s35
    buffer_load_dwordx4 v11, s[20:23], s34 offen offset:3072 lds
    s_add_u32 s30, s30, 1
    s_cmp_eq_u32 s30, 10
    s_cselect_b32 s30, 0, s30
    s_waitcnt vmcnt(12)
    s_barrier
    s_add_u32 m0, s31, 0
    s_lshl_b32 s33, s30, 7
    buffer_load_dwordx4 v8, s[16:19], s33 offen lds
    buffer_load_dwordx4 v9, s[16:19], s33 offen offset:1024 lds
    s_add_u32 s33, s33, 18432
    buffer_load_dwordx4 v8, s[16:19], s33 offen offset:2048 lds
    buffer_load_dwordx4 v9, s[16:19], s33 offen offset:3072 lds
    s_lshl_b32 s34, s30, 6
    s_mul_i32 s34, s34, s26
    s_add_u32 m0, s32, 0
    s_nop 0
    buffer_load_dwordx4 v10, s[20:23], s34 offen offset:0 lds
    s_add_u32 s34, s34, s35
    buffer_load_dwordx4 v10, s[20:23], s34 offen offset:1024 lds
    s_add_u32 s34, s34, s35
    buffer_load_dwordx4 v11, s[20:23], s34 offen offset:2048 lds
    s_add_u32 s34, s34, s35
    buffer_load_dwordx4 v11, s[20:23], s34 offen offset:3072 lds
    s_add_u32 m0, s32, 4096
    s_add_u32 s34, s34, 4096
    s_add_u32 s34, s34, s35
    buffer_load_dwordx4 v10, s[20:23], s34 offen offset:0 lds
    s_add_u32 s34, s34, s35
    buffer_load_dwordx4 v10, s[20:23], s34 offen offset:1024 lds
    s_add_u32 s34, s34, s35
    buffer_load_dwordx4 v11, s[20:23], s34 offen offset:2048 lds
    s_add_u32 s34, s34, s35
    buffer_load_dwordx4 v11, s[20:23], s34 offen offset:3072 lds
    s_add_u32 s30, s30, 1
    s_cmp_eq_u32 s30, 10
    s_cselect_b32 s30, 0, s30
    s_waitcnt vmcnt(12)
    s_barrier
    s_add_u32 m0, s31, 49152
    s_lshl_b32 s33, s30, 7
    buffer_load_dwordx4 v8, s[16:19], s33 offen lds
    buffer_load_dwordx4 v9, s[16:19], s33 offen offset:1024 lds
    s_add_u32 s33, s33, 18432
    buffer_load_dwordx4 v8, s[16:19], s33 offen offset:2048 lds
    buffer_load_dwordx4 v9, s[16:19], s33 offen offset:3072 lds
    s_lshl_b32 s34, s30, 6
    s_mul_i32 s34, s34, s26
    s_add_u32 m0, s32, 49152
    s_nop 0
    buffer_load_dwordx4 v10, s[20:23], s34 offen offset:0 lds
    s_add_u32 s34, s34, s35
    buffer_load_dwordx4 v10, s[20:23], s34 offen offset:1024 lds
    s_add_u32 s34, s34, s35
    buffer_load_dwordx4 v11, s[20:23], s34 offen offset:2048 lds
    s_add_u32 s34, s34, s35
    buffer_load_dwordx4 v11, s[20:23], s34 offen offset:3072 lds
    s_add_u32 m0, s32, 53248
    s_add_u32 s34, s34, 4096
    s_add_u32 s34, s34, s35
    buffer_load_dwordx4 v10, s[20:23], s34 offen offset:0 lds
    s_add_u32 s34, s34, s35
    buffer_load_dwordx4 v10, s[20:23], s34 offen offset:1024 lds
    s_add_u32 s34, s34, s35
    buffer_load_dwordx4 v11, s[20:23], s34 offen offset:2048 lds
    s_add_u32 s34, s34, s35
    buffer_load_dwordx4 v11, s[20:23], s34 offen offset:3072 lds
    s_add_u32 s30, s30, 1
    s_cmp_eq_u32 s30, 10
    s_cselect_b32 s30, 0, s30
    s_waitcnt vmcnt(12)
    s_barrier
    s_add_u32 m0, s31, 98304
    s_lshl_b32 s33, s30, 7
    buffer_load_dwordx4 v8, s[16:19], s33 offen lds
    buffer_load_dwordx4 v9, s[16:19], s33 offen offset:1024 lds
    s_add_u32 s33, s33, 18432
    buffer_load_dwordx4 v8, s[16:19], s33 offen offset:2048 lds
    buffer_load_dwordx4 v9, s[16:19], s33 offen offset:3072 lds
    s_lshl_b32 s34, s30, 6
    s_mul_i32 s34, s34, s26
    s_add_u32 m0, s32, 98304
    s_nop 0
    buffer_load_dwordx4 v10, s[20:23], s34 offen offset:0 lds
    s_add_u32 s34, s34, s35
    buffer_load_dwordx4 v10, s[20:23], s34 offen offset:1024 lds
    s_add_u32 s34, s34, s35
    buffer_load_dwordx4 v11, s[20:23], s34 offen offset:2048 lds
    s_add_u32 s34, s34, s35
    buffer_load_dwordx4 v11, s[20:23], s34 offen offset:3072 lds
    s_add_u32 m0, s32, 102400
    s_add_u32 s34, s34, 4096
    s_add_u32 s34, s34, s35
    buffer_load_dwordx4 v10, s[20:23], s34 offen offset:0 lds
    s_add_u32 s34, s34, s35
    buffer_load_dwordx4 v10, s[20:23], s34 offen offset:1024 lds
    s_add_u32 s34, s34, s35
    buffer_load_dwordx4 v11, s[20:23], s34 offen offset:2048 lds
    s_add_u32 s34, s34, s35
    buffer_load_dwordx4 v11, s[20:23], s34 offen offset:3072 lds
    s_add_u32 s30, s30, 1
    s_cmp_eq_u32 s30, 10
    s_cselect_b32 s30, 0, s30
    s_waitcnt vmcnt(12)
    s_barrier
    s_add_u32 m0, s31, 0
    s_lshl_b32 s33, s30, 7
    buffer_load_dwordx4 v8, s[16:19], s33 offen lds
    buffer_load_dwordx4 v9, s[16:19], s33 offen offset:1024 lds
    s_add_u32 s33, s33, 18432
    buffer_load_dwordx4 v8, s[16:19], s33 offen offset:2048 lds
    buffer_load_dwordx4 v9, s[16:19], s33 offen offset:3072 lds
    s_lshl_b32 s34, s30, 6
    s_mul_i32 s34, s34, s26
    s_add_u32 m0, s32, 0
    s_nop 0
    buffer_load_dwordx4 v10, s[20:23], s34 offen offset:0 lds
    s_add_u32 s34, s34, s35
    buffer_load_dwordx4 v10, s[20:23], s34 offen offset:1024 lds
    s_add_u32 s34, s34, s35
    buffer_load_dwordx4 v11, s[20:23], s34 offen offset:2048 lds
    s_add_u32 s34, s34, s35
    buffer_load_dwordx4 v11, s[20:23], s34 offen offset:3072 lds
    s_add_u32 m0, s32, 4096
    s_add_u32 s34, s34, 4096
    s_add_u32 s34, s34, s35
    buffer_load_dwordx4 v10, s[20:23], s34 offen offset:0 lds
    s_add_u32 s34, s34, s35
    buffer_load_dwordx4 v10, s[20:23], s34 offen offset:1024 lds
    s_add_u32 s34, s34, s35
    buffer_load_dwordx4 v11, s[20:23], s34 offen offset:2048 lds
    s_add_u32 s34, s34, s35
    buffer_load_dwordx4 v11, s[20:23], s34 offen offset:3072 lds
    s_add_u32 s30, s30, 1
    s_cmp_eq_u32 s30, 10
    s_cselect_b32 s30, 0, s30
    v_mov_b32 v20, 163832
    ds_read_b32 v20, v20
    s_lshl_b32 s38, s25, 15
    s_lshl_b32 s40, s36, 9
    s_add_u32 s38, s38, s40
    s_add_u32 s38, s38, 28721152
    s_lshl_b32 s39, s24, 2
    s_add_u32 s39, s39, s36
    s_lshl_b32 s39, s39, 9
    s_add_u32 s39, s39, 28459008
    s_lshl_b32 s42, s25, 1
    s_add_u32 s42, s42, s36
    s_cmp_ge_u32 s42, 29
    s_cselect_b32 s42, s29, 0
    s_sub_u32 s42, s42, 1
    v_and_b32 v22, 31, v1
    v_lshlrev_b32 v21, 4, v22
    s_waitcnt lgkmcnt(0)
    v_readfirstlane_b32 s13, v20
    v_lshrrev_b32 v20, 5, v1
    v_lshl_add_u32 v20, v20, 11, v21
    buffer_load_dwordx4 v[16:19], v21, s[8:11], s39 offen sc1
    s_mov_b32 s43, s38
    buffer_load_dwordx4 v[32:35], v20, s[8:11], s43 offen sc1
    s_add_u32 s43, s43, 4096
    buffer_load_dwordx4 v[36:39], v20, s[8:11], s43 offen sc1
    s_add_u32 s43, s43, 4096
    s_waitcnt vmcnt(15)
    s_barrier
    s_add_u32 m0, s31, 49152
    s_lshl_b32 s33, s30, 7
    buffer_load_dwordx4 v8, s[16:19], s33 offen lds
    buffer_load_dwordx4 v9, s[16:19], s33 offen offset:1024 lds
    s_add_u32 s33, s33, 18432
    buffer_load_dwordx4 v8, s[16:19], s33 offen offset:2048 lds
    buffer_load_dwordx4 v9, s[16:19], s33 offen offset:3072 lds
    s_lshl_b32 s34, s30, 6
    s_mul_i32 s34, s34, s26
    s_add_u32 m0, s32, 49152
    s_nop 0
    buffer_load_dwordx4 v10, s[20:23], s34 offen offset:0 lds
    s_add_u32 s34, s34, s35
    buffer_load_dwordx4 v10, s[20:23], s34 offen offset:1024 lds
    s_add_u32 s34, s34, s35
    buffer_load_dwordx4 v11, s[20:23], s34 offen offset:2048 lds
    s_add_u32 s34, s34, s35
    buffer_load_dwordx4 v11, s[20:23], s34 offen offset:3072 lds
    s_add_u32 m0, s32, 53248
    s_add_u32 s34, s34, 4096
    s_add_u32 s34, s34, s35
    buffer_load_dwordx4 v10, s[20:23], s34 offen offset:0 lds
    s_add_u32 s34, s34, s35
    buffer_load_dwordx4 v10, s[20:23], s34 offen offset:1024 lds
    s_add_u32 s34, s34, s35
    buffer_load_dwordx4 v11, s[20:23], s34 offen offset:2048 lds
    s_add_u32 s34, s34, s35
    buffer_load_dwordx4 v11, s[20:23], s34 offen offset:3072 lds
    s_add_u32 s30, s30, 1
    s_cmp_eq_u32 s30, 10
    s_cselect_b32 s30, 0, s30
    buffer_load_dwordx4 v[40:43], v20, s[8:11], s43 offen sc1
    s_add_u32 s43, s43, 4096
    buffer_load_dwordx4 v[44:47], v20, s[8:11], s43 offen sc1
    s_add_u32 s43, s43, 4096
    buffer_load_dwordx4 v[48:51], v20, s[8:11], s43 offen sc1
    s_add_u32 s43, s43, 4096
    s_waitcnt vmcnt(15)
    s_barrier
    s_add_u32 m0, s31, 98304
    s_lshl_b32 s33, s30, 7
    buffer_load_dwordx4 v8, s[16:19], s33 offen lds
    buffer_load_dwordx4 v9, s[16:19], s33 offen offset:1024 lds
    s_add_u32 s33, s33, 18432
    buffer_load_dwordx4 v8, s[16:19], s33 offen offset:2048 lds
    buffer_load_dwordx4 v9, s[16:19], s33 offen offset:3072 lds
    s_lshl_b32 s34, s30, 6
    s_mul_i32 s34, s34, s26
    s_add_u32 m0, s32, 98304
    s_nop 0
    buffer_load_dwordx4 v10, s[20:23], s34 offen offset:0 lds
    s_add_u32 s34, s34, s35
    buffer_load_dwordx4 v10, s[20:23], s34 offen offset:1024 lds
    s_add_u32 s34, s34, s35
    buffer_load_dwordx4 v11, s[20:23], s34 offen offset:2048 lds
    s_add_u32 s34, s34, s35
    buffer_load_dwordx4 v11, s[20:23], s34 offen offset:3072 lds
    s_add_u32 m0, s32, 102400
    s_add_u32 s34, s34, 4096
    s_add_u32 s34, s34, s35
    buffer_load_dwordx4 v10, s[20:23], s34 offen offset:0 lds
    s_add_u32 s34, s34, s35
    buffer_load_dwordx4 v10, s[20:23], s34 offen offset:1024 lds
    s_add_u32 s34, s34, s35
    buffer_load_dwordx4 v11, s[20:23], s34 offen offset:2048 lds
    s_add_u32 s34, s34, s35
    buffer_load_dwordx4 v11, s[20:23], s34 offen offset:3072 lds
    s_add_u32 s30, s30, 1
    s_cmp_eq_u32 s30, 10
    s_cselect_b32 s30, 0, s30
    buffer_load_dwordx4 v[52:55], v20, s[8:11], s43 offen sc1
    s_add_u32 s43, s43, 4096
    buffer_load_dwordx4 v[56:59], v20, s[8:11], s43 offen sc1
    s_add_u32 s43, s43, 4096
    buffer_load_dwordx4 v[60:63], v20, s[8:11], s43 offen sc1
    s_add_u32 s43, s43, 4096
    s_waitcnt vmcnt(15)
    s_barrier
    s_add_u32 m0, s31, 0
    s_lshl_b32 s33, s30, 7
    buffer_load_dwordx4 v8, s[16:19], s33 offen lds
    buffer_load_dwordx4 v9, s[16:19], s33 offen offset:1024 lds
    s_add_u32 s33, s33, 18432
    buffer_load_dwordx4 v8, s[16:19], s33 offen offset:2048 lds
    buffer_load_dwordx4 v9, s[16:19], s33 offen offset:3072 lds
    s_lshl_b32 s34, s30, 6
    s_mul_i32 s34, s34, s26
    s_add_u32 m0, s32, 0
    s_nop 0
    buffer_load_dwordx4 v10, s[20:23], s34 offen offset:0 lds
    s_add_u32 s34, s34, s35
    buffer_load_dwordx4 v10, s[20:23], s34 offen offset:1024 lds
    s_add_u32 s34, s34, s35
    buffer_load_dwordx4 v11, s[20:23], s34 offen offset:2048 lds
    s_add_u32 s34, s34, s35
    buffer_load_dwordx4 v11, s[20:23], s34 offen offset:3072 lds
    s_add_u32 m0, s32, 4096
    s_add_u32 s34, s34, 4096
    s_add_u32 s34, s34, s35
    buffer_load_dwordx4 v10, s[20:23], s34 offen offset:0 lds
    s_add_u32 s34, s34, s35
    buffer_load_dwordx4 v10, s[20:23], s34 offen offset:1024 lds
    s_add_u32 s34, s34, s35
    buffer_load_dwordx4 v11, s[20:23], s34 offen offset:2048 lds
    s_add_u32 s34, s34, s35
    buffer_load_dwordx4 v11, s[20:23], s34 offen offset:3072 lds
    s_add_u32 s30, s30, 1
    s_cmp_eq_u32 s30, 10
    s_cselect_b32 s30, 0, s30
    s_waitcnt vmcnt(12)
    s_barrier
    s_waitcnt vmcnt(12)
    v_xor_b32 v18, s13, v18
    v_xor_b32 v19, s13, v19
    v_or_b32 v18, v18, v19
    v_cmp_ne_u32 vcc, 0, v18
    s_nop 0
    s_cbranch_vccnz L_f_spin_41
L_f_back_40:
    v_xor_b32 v33, s13, v33
    v_xor_b32 v35, s13, v35
    v_xor_b32 v37, s13, v37
    v_xor_b32 v39, s13, v39
    v_xor_b32 v41, s13, v41
    v_xor_b32 v43, s13, v43
    v_xor_b32 v45, s13, v45
    v_xor_b32 v47, s13, v47
    v_xor_b32 v49, s13, v49
    v_xor_b32 v51, s13, v51
    v_xor_b32 v53, s13, v53
    v_xor_b32 v55, s13, v55
    v_xor_b32 v57, s13, v57
    v_xor_b32 v59, s13, v59
    v_xor_b32 v61, s13, v61
    v_xor_b32 v63, s13, v63
    v_or3_b32 v33, v33, v35, v37
    v_or3_b32 v33, v33, v39, v41
    v_or3_b32 v33, v33, v43, v45
    v_or3_b32 v33, v33, v47, v49
    v_or3_b32 v33, v33, v51, v53
    v_or3_b32 v33, v33, v55, v57
    v_or3_b32 v33, v33, v59, v61
    v_or_b32 v33, v33, v63
    v_and_b32 v33, s42, v33
    v_cmp_ne_u32 vcc, 0, v33
    s_nop 0
    s_cbranch_vccnz L_f_spin_43
L_f_back_42:
    v_add_f32 v32, v32, v36
    v_add_f32 v34, v34, v38
    v_add_f32 v40, v40, v44
    v_add_f32 v42, v42, v46
    v_add_f32 v48, v48, v52
    v_add_f32 v50, v50, v54
    v_add_f32 v56, v56, v60
    v_add_f32 v58, v58, v62
    v_add_f32 v32, v32, v40
    v_add_f32 v34, v34, v42
    v_add_f32 v48, v48, v56
    v_add_f32 v50, v50, v58
    v_add_f32 v32, v32, v48
    v_add_f32 v34, v34, v50
    v_mov_b32 v36, v32
    v_mov_b32 v37, v34
    s_lshl_b32 s40, s36, 7
    s_add_u32 s40, s40, 148480
    v_permlane32_swap_b32 v32, v36
    v_permlane32_swap_b32 v34, v37
    v_lshlrev_b32 v22, 2, v22
    v_add_u32 v23, s40, v22
    ds_write_b32 v23, v16
    ds_write_b32 v23, v17 offset:512
    s_lshl_b32 s40, s36, 8
    s_add_u32 s40, s40, 147456
    v_add_f32 v32, v32, v36
    v_add_f32 v33, v34, v37
    v_lshlrev_b32 v22, 1, v22
    v_add_u32 v22, s40, v22
    ds_write_b64 v22, v[32:33]
    s_waitcnt lgkmcnt(0)
    s_waitcnt vmcnt(0)
    s_barrier
    s_branch L_f_adone_2
L_f_spin_41:
    s_mov_b32 s41, 1048576
L_f_spinl_44:
    buffer_load_dwordx4 v[16:19], v21, s[8:11], s39 offen sc1
    s_waitcnt vmcnt(0)
    v_xor_b32 v18, s13, v18
    v_xor_b32 v19, s13, v19
    v_or_b32 v18, v18, v19
    v_cmp_ne_u32 vcc, 0, v18
    s_sub_u32 s41, s41, 1
    s_cselect_b64 vcc, 0, vcc
    s_cbranch_vccnz L_f_spinl_44
    s_branch L_f_back_40
L_f_spin_43:
    s_mov_b32 s41, 1048576
L_f_spinl_45:
    s_mov_b32 s40, s38
    buffer_load_dwordx4 v[32:35], v20, s[8:11], s40 offen sc1
    s_add_u32 s40, s40, 4096
    buffer_load_dwordx4 v[36:39], v20, s[8:11], s40 offen sc1
    s_add_u32 s40, s40, 4096
    buffer_load_dwordx4 v[40:43], v20, s[8:11], s40 offen sc1
    s_add_u32 s40, s40, 4096
    buffer_load_dwordx4 v[44:47], v20, s[8:11], s40 offen sc1
    s_add_u32 s40, s40, 4096
    buffer_load_dwordx4 v[48:51], v20, s[8:11], s40 offen sc1
    s_add_u32 s40, s40, 4096
    buffer_load_dwordx4 v[52:55], v20, s[8:11], s40 offen sc1
    s_add_u32 s40, s40, 4096
    buffer_load_dwordx4 v[56:59], v20, s[8:11], s40 offen sc1
    s_add_u32 s40, s40, 4096
    buffer_load_dwordx4 v[60:63], v20, s[8:11], s40 offen sc1
    s_waitcnt vmcnt(0)
    v_xor_b32 v33, s13, v33
    v_xor_b32 v35, s13, v35
    v_xor_b32 v37, s13, v37
    v_xor_b32 v39, s13, v39
    v_xor_b32 v41, s13, v41
    v_xor_b32 v43, s13, v43
    v_xor_b32 v45, s13, v45
    v_xor_b32 v47, s13, v47
    v_xor_b32 v49, s13, v49
    v_xor_b32 v51, s13, v51
    v_xor_b32 v53, s13, v53
    v_xor_b32 v55, s13, v55
    v_xor_b32 v57, s13, v57
    v_xor_b32 v59, s13, v59
    v_xor_b32 v61, s13, v61
    v_xor_b32 v63, s13, v63
    v_or3_b32 v33, v33, v35, v37
    v_or3_b32 v33, v33, v39, v41
    v_or3_b32 v33, v33, v43, v45
    v_or3_b32 v33, v33, v47, v49
    v_or3_b32 v33, v33, v51, v53
    v_or3_b32 v33, v33, v55, v57
    v_or3_b32 v33, v33, v59, v61
    v_or_b32 v33, v33, v63
    v_and_b32 v33, s42, v33
    v_cmp_ne_u32 vcc, 0, v33
    s_sub_u32 s41, s41, 1
    s_cselect_b64 vcc, 0, vcc
    s_cbranch_vccnz L_f_spinl_45
    s_branch L_f_back_42
L_f_cs_13:
    v_mfma_f32_16x16x32_bf16 v[16:19], v[160:163], v[48:51], v[16:19]
    v_mfma_f32_16x16x32_bf16 v[20:23], v[160:163], v[52:55], v[20:23]
    v_mfma_f32_16x16x32_bf16 v[24:27], v[160:163], v[56:59], v[24:27]
    v_mfma_f32_16x16x32_bf16 v[28:31], v[160:163], v[60:63], v[28:31]
    s_branch L_f_csb_14
L_f_cs_15:
    v_mfma_f32_16x16x32_bf16 v[16:19], v[164:167], v[48:51], v[16:19]
    v_mfma_f32_16x16x32_bf16 v[20:23], v[164:167], v[52:55], v[20:23]
    v_mfma_f32_16x16x32_bf16 v[24:27], v[164:167], v[56:59], v[24:27]
    v_mfma_f32_16x16x32_bf16 v[28:31], v[164:167], v[60:63], v[28:31]
    s_branch L_f_csb_16
L_f_cs_17:
    v_mfma_f32_16x16x32_bf16 v[16:19], v[160:163], v[144:147], v[16:19]
    v_mfma_f32_16x16x32_bf16 v[20:23], v[160:163], v[148:151], v[20:23]
    v_mfma_f32_16x16x32_bf16 v[24:27], v[160:163], v[152:155], v[24:27]
    v_mfma_f32_16x16x32_bf16 v[28:31], v[160:163], v[156:159], v[28:31]
    s_branch L_f_csb_18
L_f_cs_19:
    v_mfma_f32_16x16x32_bf16 v[16:19], v[164:167], v[144:147], v[16:19]
    v_mfma_f32_16x16x32_bf16 v[20:23], v[164:167], v[148:151], v[20:23]
    v_mfma_f32_16x16x32_bf16 v[24:27], v[164:167], v[152:155], v[24:27]
    v_mfma_f32_16x16x32_bf16 v[28:31], v[164:167], v[156:159], v[28:31]
    s_branch L_f_csb_20
L_f_cs_21:
    v_mfma_f32_16x16x32_bf16 v[16:19], v[160:163], v[48:51], v[16:19]
    v_mfma_f32_16x16x32_bf16 v[20:23], v[160:163], v[52:55], v[20:23]
    v_mfma_f32_16x16x32_bf16 v[24:27], v[160:163], v[56:59], v[24:27]
    v_mfma_f32_16x16x32_bf16 v[28:31], v[160:163], v[60:63], v[28:31]
    s_branch L_f_csb_22
L_f_cs_23:
    v_mfma_f32_16x16x32_bf16 v[16:19], v[164:167], v[48:51], v[16:19]
    v_mfma_f32_16x16x32_bf16 v[20:23], v[164:167], v[52:55], v[20:23]
    v_mfma_f32_16x16x32_bf16 v[24:27], v[164:167], v[56:59], v[24:27]
    v_mfma_f32_16x16x32_bf16 v[28:31], v[164:167], v[60:63], v[28:31]
    s_branch L_f_csb_24
L_f_cs_25:
    v_mfma_f32_16x16x32_bf16 v[16:19], v[160:163], v[48:51], v[16:19]
    v_mfma_f32_16x16x32_bf16 v[20:23], v[160:163], v[52:55], v[20:23]
    v_mfma_f32_16x16x32_bf16 v[24:27], v[160:163], v[56:59], v[24:27]
    v_mfma_f32_16x16x32_bf16 v[28:31], v[160:163], v[60:63], v[28:31]
    s_branch L_f_csb_26
L_f_cs_27:
    v_mfma_f32_16x16x32_bf16 v[16:19], v[164:167], v[48:51], v[16:19]
    v_mfma_f32_16x16x32_bf16 v[20:23], v[164:167], v[52:55], v[20:23]
    v_mfma_f32_16x16x32_bf16 v[24:27], v[164:167], v[56:59], v[24:27]
    v_mfma_f32_16x16x32_bf16 v[28:31], v[164:167], v[60:63], v[28:31]
    s_branch L_f_csb_28
L_f_cs_29:
    v_mfma_f32_16x16x32_bf16 v[16:19], v[160:163], v[144:147], v[16:19]
    v_mfma_f32_16x16x32_bf16 v[20:23], v[160:163], v[148:151], v[20:23]
    v_mfma_f32_16x16x32_bf16 v[24:27], v[160:163], v[152:155], v[24:27]
    v_mfma_f32_16x16x32_bf16 v[28:31], v[160:163], v[156:159], v[28:31]
    s_branch L_f_csb_30
L_f_cs_31:
    v_mfma_f32_16x16x32_bf16 v[16:19], v[164:167], v[144:147], v[16:19]
    v_mfma_f32_16x16x32_bf16 v[20:23], v[164:167], v[148:151], v[20:23]
    v_mfma_f32_16x16x32_bf16 v[24:27], v[164:167], v[152:155], v[24:27]
    v_mfma_f32_16x16x32_bf16 v[28:31], v[164:167], v[156:159], v[28:31]
    s_branch L_f_csb_32
L_f_cs_33:
    v_mfma_f32_16x16x32_bf16 v[16:19], v[160:163], v[48:51], v[16:19]
    v_mfma_f32_16x16x32_bf16 v[20:23], v[160:163], v[52:55], v[20:23]
    v_mfma_f32_16x16x32_bf16 v[24:27], v[160:163], v[56:59], v[24:27]
    v_mfma_f32_16x16x32_bf16 v[28:31], v[160:163], v[60:63], v[28:31]
    s_branch L_f_csb_34
L_f_cs_35:
    v_mfma_f32_16x16x32_bf16 v[16:19], v[164:167], v[48:51], v[16:19]
    v_mfma_f32_16x16x32_bf16 v[20:23], v[164:167], v[52:55], v[20:23]
    v_mfma_f32_16x16x32_bf16 v[24:27], v[164:167], v[56:59], v[24:27]
    v_mfma_f32_16x16x32_bf16 v[28:31], v[164:167], v[60:63], v[28:31]
    s_branch L_f_csb_36
L_f_retile_loader_9:
    s_getpc_b64 s[40:41]
L_pc:
    s_sub_u32 s40, s40, L_pc-parallel_sum__softmax_full_mha__dense_activation_silu__prompt_kernel
    s_subb_u32 s41, s41, 0
    s_sub_u32 s42, s12, 8
    s_lshl_b32 s42, s42, 6
    v_add_u32 v2, s42, v1
    v_lshlrev_b32 v2, 7, v2
    v_min_u32 v3, L_code_end-parallel_sum__softmax_full_mha__dense_activation_silu__prompt_kernel-4, v2
    global_load_dword v4, v3, s[40:41]
    v_add_u32 v2, 0x8000, v2
    v_min_u32 v3, L_code_end-parallel_sum__softmax_full_mha__dense_activation_silu__prompt_kernel-4, v2
    global_load_dword v5, v3, s[40:41]
    s_barrier
    s_waitcnt vmcnt(0) lgkmcnt(0)
    s_branch L_f_adone_2
L_f_adone_2:
    s_cmp_ge_u32 s12, 8
    s_cbranch_scc1 L_f_ffn_46
    s_and_b32 s3, s2, 7
    s_lshr_b32 s6, s2, 3
    s_lshr_b32 s7, s6, 3
    s_lshl_b32 s14, s3, 2
    s_add_u32 s14, s14, s7
    s_and_b32 s46, s6, 7
    s_and_b32 s15, s12, 3
    s_lshl_b32 s15, s15, 1
    s_bfe_u32 s7, s12, 0x10002
    s_add_u32 s15, s15, s7
    s_lshl_b32 s7, s46, 3
    s_add_u32 s15, s15, s7
    s_and_b32 s42, s6, 3
    s_lshr_b32 s6, s6, 2
    s_lshl_b32 s3, s3, 3
    s_add_u32 s41, s3, s6
    s_and_b32 s45, s12, 3
    s_mul_i32 s30, s14, 20
    s_add_u32 s31, s30, 19
    s_lshr_b32 s30, s30, 6
    s_lshr_b32 s31, s31, 6
    s_sub_u32 s31, s31, s30
    v_lshrrev_b32 v3, 5, v1
    v_mul_u32_u24 v2, s31, v3
    v_add_u32 v2, s30, v2
    v_and_b32 v4, 1, v2
    v_lshrrev_b32 v2, 1, v2
    v_lshlrev_b32 v2, 11, v2
    v_lshl_add_u32 v2, v4, 3, v2
    s_mov_b32 s24, -1
    s_mov_b32 s25, 0
    s_mov_b32 s26, 0
    s_mov_b32 s27, -1
    s_mov_b32 s28, 0xfffff
    s_mov_b32 s29, 0xfffff
    v_lshrrev_b32 v3, 5, v1
    v_and_b32 v90, 7, v1
    v_bfe_u32 v2, v1, 3, 1
    v_lshl_add_u32 v90, v2, 4, v90
    v_bfe_u32 v2, v1, 4, 1
    v_lshl_add_u32 v90, v2, 3, v90
    v_lshlrev_b32 v90, 3, v90
    v_and_b32 v2, 31, v1
    v_lshl_add_u32 v80, v3, 9, v90
    v_add_u32 v81, 1024, v90
    s_mov_b64 exec, s[26:27]
    v_mov_b32 v81, 1616
    s_mov_b64 exec, -1
    v_min_u32 v2, 21, v2
    v_lshlrev_b32 v2, 4, v2
    v_mul_u32_u24 v92, 352, v3
    v_add3_u32 v82, v2, v92, 64
    v_add_u32 v82, 1216, v82
    v_lshrrev_b32 v2, 2, v0
    v_mul_u32_u24 v2, 2688, v2
    v_and_b32 v92, 3, v0
    v_mul_u32_u24 v92, 352, v92
    v_add_u32 v2, v2, v92
    v_mov_b32 v90, 0x3f803f80
    v_mov_b32 v91, 0x3f803f80
    v_mov_b32 v92, 0
    v_mov_b32 v93, 0
    v_cmp_gt_u32 vcc, 96, v0
    s_nop 0
    s_and_saveexec_b64 s[6:7], vcc
    ds_write_b64 v2, v[90:91] offset:1600
    ds_write_b64 v2, v[90:91] offset:1608
    ds_write_b64 v2, v[92:93] offset:1616
    ds_write_b64 v2, v[92:93] offset:1624
    s_mov_b64 exec, -1
    s_lshr_b32 s30, s12, 2
    s_mul_i32 s30, s30, 10752
    v_add_u32 v80, s30, v80
    v_add_u32 v81, s30, v81
    v_add_u32 v82, s30, v82
    v_mov_b32 v64, 0
    v_mov_b32 v65, 0
    v_mov_b32 v66, 0
    v_mov_b32 v67, 0
    v_mov_b32 v68, 0
    v_mov_b32 v69, 0
    v_mov_b32 v70, 0
    v_mov_b32 v71, 0
    v_mov_b32 v72, 0
    v_mov_b32 v73, 0
    v_mov_b32 v74, 0
    v_mov_b32 v75, 0
    v_mov_b32 v76, 0
    v_mov_b32 v77, 0
    v_mov_b32 v78, 0
    v_mov_b32 v79, 0
    v_mov_b32 v96, 0
    v_mov_b32 v97, 0
    v_mov_b32 v98, 0
    v_mov_b32 v99, 0
    v_mov_b32 v100, 0
    v_mov_b32 v101, 0
    v_mov_b32 v102, 0
    v_mov_b32 v103, 0
    v_mov_b32 v104, 0
    v_mov_b32 v105, 0
    v_mov_b32 v106, 0
    v_mov_b32 v107, 0
    v_mov_b32 v108, 0
    v_mov_b32 v109, 0
    v_mov_b32 v110, 0
    v_mov_b32 v111, 0
    v_mov_b32 v28, 0
    v_mov_b32 v29, 0
    v_mov_b32 v30, 0
    v_mov_b32 v31, 0
    v_mov_b32 v20, 0
    v_mov_b32 v21, 0
    v_mov_b32 v22, 0
    v_mov_b32 v23, 0
    s_and_b32 s30, s15, 7
    s_mul_i32 s31, s30, 1280
    s_xor_b32 s30, s30, 1
    s_mul_i32 s30, s30, 1280
    v_and_b32 v2, 31, v1
    v_lshlrev_b32 v2, 3, v2
    v_lshl_add_u32 v3, v3, 9, v2
    v_add_u32 v90, s31, v3
    v_add_u32 v91, s30, v3
    v_add_u32 v92, s31, v2
    v_add_u32 v93, s30, v2
    s_mov_b64 exec, s[26:27]
    v_mov_b32 v92, 4294878800
    v_mov_b32 v93, 4294878800
    s_mov_b64 exec, -1
    v_add_u32 v90, 89088, v90
    v_add_u32 v91, 89088, v91
    v_add_u32 v92, 89088, v92
    v_add_u32 v93, 89088, v93
    s_waitcnt lgkmcnt(0)
    s_barrier
    ds_read_b64 v[8:9], v92 offset:1024
    ds_read_b64 v[4:5], v90
    ds_read_b64 v[6:7], v90 offset:256
    ds_read_b64 v[88:89], v93 offset:1024
    ds_read_b64 v[84:85], v91
    ds_read_b64 v[86:87], v91 offset:256
    ds_read_b64 v[14:15], v81 offset:0
    ds_read_b64 v[10:11], v80 offset:0
    ds_read_b64 v[12:13], v80 offset:256
    s_waitcnt lgkmcnt(0)
    v_mfma_f32_32x32x8_bf16 v[32:47], v[14:15], v[8:9], 0
    v_mfma_f32_32x32x16_bf16 v[32:47], v[10:13], v[4:7], v[32:47]
    ds_read_b128 v[16:19], v82 offset:0
    s_nop 7
    s_setprio 2
    s_nop 1
    v_exp_f32 v32, v32
    v_exp_f32 v33, v33
    v_mfma_f32_32x32x16_bf16 v[96:111], v[20:23], v[28:31], v[96:111]
    ds_read_b128 v[20:23], v82 offset:704
    v_exp_f32 v34, v34
    v_exp_f32 v35, v35
    v_cvt_pk_bf16_f32 v24, v32, v33
    v_cvt_pk_bf16_f32 v25, v34, v35
    v_exp_f32 v36, v36
    v_exp_f32 v37, v37
    v_mfma_f32_32x32x8_bf16 v[48:63], v[14:15], v[88:89], 0
    ds_read_b64 v[14:15], v81 offset:2688
    v_exp_f32 v38, v38
    v_exp_f32 v39, v39
    v_cvt_pk_bf16_f32 v26, v36, v37
    v_cvt_pk_bf16_f32 v27, v38, v39
    v_exp_f32 v40, v40
    v_exp_f32 v41, v41
    v_mfma_f32_32x32x16_bf16 v[48:63], v[10:13], v[84:87], v[48:63]
    ds_read_b64 v[10:11], v80 offset:2688
    ds_read_b64 v[12:13], v80 offset:2944
    v_exp_f32 v42, v42
    v_exp_f32 v43, v43
    v_cvt_pk_bf16_f32 v28, v40, v41
    v_cvt_pk_bf16_f32 v29, v42, v43
    v_exp_f32 v44, v44
    v_exp_f32 v45, v45
    s_waitcnt lgkmcnt(4)
    v_mfma_f32_32x32x16_bf16 v[64:79], v[16:19], v[24:27], v[64:79]
    v_exp_f32 v46, v46
    v_exp_f32 v47, v47
    v_cvt_pk_bf16_f32 v30, v44, v45
    v_cvt_pk_bf16_f32 v31, v46, v47
    v_exp_f32 v48, v48
    v_exp_f32 v49, v49
    s_waitcnt lgkmcnt(0)
    v_mfma_f32_32x32x16_bf16 v[64:79], v[20:23], v[28:31], v[64:79]
    v_exp_f32 v50, v50
    v_exp_f32 v51, v51
    v_cvt_pk_bf16_f32 v24, v48, v49
    v_cvt_pk_bf16_f32 v25, v50, v51
    v_exp_f32 v52, v52
    v_exp_f32 v53, v53
    v_mfma_f32_32x32x8_bf16 v[32:47], v[14:15], v[8:9], 0
    v_exp_f32 v54, v54
    v_exp_f32 v55, v55
    v_cvt_pk_bf16_f32 v26, v52, v53
    v_cvt_pk_bf16_f32 v27, v54, v55
    v_exp_f32 v56, v56
    v_exp_f32 v57, v57
    v_mfma_f32_32x32x16_bf16 v[32:47], v[10:13], v[4:7], v[32:47]
    v_exp_f32 v58, v58
    v_exp_f32 v59, v59
    v_cvt_pk_bf16_f32 v28, v56, v57
    v_cvt_pk_bf16_f32 v29, v58, v59
    v_exp_f32 v60, v60
    v_exp_f32 v61, v61
    v_mfma_f32_32x32x16_bf16 v[96:111], v[16:19], v[24:27], v[96:111]
    ds_read_b128 v[16:19], v82 offset:2688
    v_exp_f32 v62, v62
    v_exp_f32 v63, v63
    v_cvt_pk_bf16_f32 v30, v60, v61
    v_cvt_pk_bf16_f32 v31, v62, v63
    s_setprio 1
    v_exp_f32 v32, v32
    v_exp_f32 v33, v33
    v_mfma_f32_32x32x16_bf16 v[96:111], v[20:23], v[28:31], v[96:111]
    ds_read_b128 v[20:23], v82 offset:3392
    v_exp_f32 v34, v34
    v_exp_f32 v35, v35
    v_cvt_pk_bf16_f32 v24, v32, v33
    v_cvt_pk_bf16_f32 v25, v34, v35
    v_exp_f32 v36, v36
    v_exp_f32 v37, v37
    v_mfma_f32_32x32x8_bf16 v[48:63], v[14:15], v[88:89], 0
    ds_read_b64 v[14:15], v81 offset:5376
    v_exp_f32 v38, v38
    v_exp_f32 v39, v39
    v_cvt_pk_bf16_f32 v26, v36, v37
    v_cvt_pk_bf16_f32 v27, v38, v39
    v_exp_f32 v40, v40
    v_exp_f32 v41, v41
    v_mfma_f32_32x32x16_bf16 v[48:63], v[10:13], v[84:87], v[48:63]
    ds_read_b64 v[10:11], v80 offset:5376
    ds_read_b64 v[12:13], v80 offset:5632
    v_exp_f32 v42, v42
    v_exp_f32 v43, v43
    v_cvt_pk_bf16_f32 v28, v40, v41
    v_cvt_pk_bf16_f32 v29, v42, v43
    v_exp_f32 v44, v44
    v_exp_f32 v45, v45
    s_waitcnt lgkmcnt(4)
    v_mfma_f32_32x32x16_bf16 v[64:79], v[16:19], v[24:27], v[64:79]
    v_exp_f32 v46, v46
    v_exp_f32 v47, v47
    v_cvt_pk_bf16_f32 v30, v44, v45
    v_cvt_pk_bf16_f32 v31, v46, v47
    s_cmp_eq_u32 s61, 0
    s_cbranch_scc1 L_f_noh_50
    v_lshrrev_b32 v2, 4, v1
    v_lshlrev_b32 v2, 9, v2
    v_and_b32 v3, 15, v1
    v_lshl_add_u32 v2, v3, 4, v2
    s_add_u32 s30, s61, 110592
    buffer_store_dwordx4 v[128:131], v2, s[8:11], s61 offen offset:0 sc1
    buffer_store_dwordx4 v[132:135], v2, s[8:11], s61 offen offset:256 sc1
    buffer_store_dwordx4 v[136:139], v2, s[8:11], s30 offen offset:0 sc1
    buffer_store_dwordx4 v[140:143], v2, s[8:11], s30 offen offset:256 sc1
    buffer_store_dwordx4 v[144:147], v2, s[8:11], s61 offen offset:2048 sc1
    buffer_store_dwordx4 v[148:151], v2, s[8:11], s61 offen offset:2304 sc1
    buffer_store_dwordx4 v[152:155], v2, s[8:11], s30 offen offset:2048 sc1
    buffer_store_dwordx4 v[156:159], v2, s[8:11], s30 offen offset:2304 sc1
L_f_noh_50:
    v_exp_f32 v48, v48
    v_exp_f32 v49, v49
    s_waitcnt lgkmcnt(0)
    v_mfma_f32_32x32x16_bf16 v[64:79], v[20:23], v[28:31], v[64:79]
    v_exp_f32 v50, v50
    v_exp_f32 v51, v51
    v_cvt_pk_bf16_f32 v24, v48, v49
    v_cvt_pk_bf16_f32 v25, v50, v51
    v_exp_f32 v52, v52
    v_exp_f32 v53, v53
    v_mfma_f32_32x32x8_bf16 v[32:47], v[14:15], v[8:9], 0
    v_exp_f32 v54, v54
    v_exp_f32 v55, v55
    v_cvt_pk_bf16_f32 v26, v52, v53
    v_cvt_pk_bf16_f32 v27, v54, v55
    v_exp_f32 v56, v56
    v_exp_f32 v57, v57
    v_mfma_f32_32x32x16_bf16 v[32:47], v[10:13], v[4:7], v[32:47]
    v_exp_f32 v58, v58
    v_exp_f32 v59, v59
    v_cvt_pk_bf16_f32 v28, v56, v57
    v_cvt_pk_bf16_f32 v29, v58, v59
    v_exp_f32 v60, v60
    v_exp_f32 v61, v61
    v_mfma_f32_32x32x16_bf16 v[96:111], v[16:19], v[24:27], v[96:111]
    ds_read_b128 v[16:19], v82 offset:5376
    v_exp_f32 v62, v62
    v_exp_f32 v63, v63
    v_cvt_pk_bf16_f32 v30, v60, v61
    v_cvt_pk_bf16_f32 v31, v62, v63
    s_setprio 0
    v_exp_f32 v32, v32
    v_exp_f32 v33, v33
    v_mfma_f32_32x32x16_bf16 v[96:111], v[20:23], v[28:31], v[96:111]
    ds_read_b128 v[20:23], v82 offset:6080
    v_exp_f32 v34, v34
    v_exp_f32 v35, v35
    v_cvt_pk_bf16_f32 v24, v32, v33
    v_cvt_pk_bf16_f32 v25, v34, v35
    v_exp_f32 v36, v36
    v_exp_f32 v37, v37
    v_mfma_f32_32x32x8_bf16 v[48:63], v[14:15], v[88:89], 0
    ds_read_b64 v[14:15], v81 offset:8064
    v_exp_f32 v38, v38
    v_exp_f32 v39, v39
    v_cvt_pk_bf16_f32 v26, v36, v37
    v_cvt_pk_bf16_f32 v27, v38, v39
    v_exp_f32 v40, v40
    v_exp_f32 v41, v41
    v_mfma_f32_32x32x16_bf16 v[48:63], v[10:13], v[84:87], v[48:63]
    ds_read_b64 v[10:11], v80 offset:8064
    ds_read_b64 v[12:13], v80 offset:8320
    v_exp_f32 v42, v42
    v_exp_f32 v43, v43
    v_cvt_pk_bf16_f32 v28, v40, v41
    v_cvt_pk_bf16_f32 v29, v42, v43
    v_exp_f32 v44, v44
    v_exp_f32 v45, v45
    s_waitcnt lgkmcnt(4)
    v_mfma_f32_32x32x16_bf16 v[64:79], v[16:19], v[24:27], v[64:79]
    v_exp_f32 v46, v46
    v_exp_f32 v47, v47
    v_cvt_pk_bf16_f32 v30, v44, v45
    v_cvt_pk_bf16_f32 v31, v46, v47
    v_exp_f32 v48, v48
    v_exp_f32 v49, v49
    s_waitcnt lgkmcnt(0)
    v_mfma_f32_32x32x16_bf16 v[64:79], v[20:23], v[28:31], v[64:79]
    v_exp_f32 v50, v50
    v_exp_f32 v51, v51
    v_cvt_pk_bf16_f32 v24, v48, v49
    v_cvt_pk_bf16_f32 v25, v50, v51
    v_exp_f32 v52, v52
    v_exp_f32 v53, v53
    v_mfma_f32_32x32x8_bf16 v[32:47], v[14:15], v[8:9], 0
    v_exp_f32 v54, v54
    v_exp_f32 v55, v55
    v_cvt_pk_bf16_f32 v26, v52, v53
    v_cvt_pk_bf16_f32 v27, v54, v55
    v_exp_f32 v56, v56
    v_exp_f32 v57, v57
    v_mfma_f32_32x32x16_bf16 v[32:47], v[10:13], v[4:7], v[32:47]
    v_exp_f32 v58, v58
    v_exp_f32 v59, v59
    v_cvt_pk_bf16_f32 v28, v56, v57
    v_cvt_pk_bf16_f32 v29, v58, v59
    v_exp_f32 v60, v60
    v_exp_f32 v61, v61
    v_mfma_f32_32x32x16_bf16 v[96:111], v[16:19], v[24:27], v[96:111]
    ds_read_b128 v[16:19], v82 offset:8064
    v_exp_f32 v62, v62
    v_exp_f32 v63, v63
    v_cvt_pk_bf16_f32 v30, v60, v61
    v_cvt_pk_bf16_f32 v31, v62, v63
    s_setprio 3
    v_exp_f32 v32, v32
    v_exp_f32 v33, v33
    v_mfma_f32_32x32x16_bf16 v[96:111], v[20:23], v[28:31], v[96:111]
    ds_read_b128 v[20:23], v82 offset:8768
    v_exp_f32 v34, v34
    v_exp_f32 v35, v35
    v_cvt_pk_bf16_f32 v24, v32, v33
    v_cvt_pk_bf16_f32 v25, v34, v35
    s_barrier
    v_exp_f32 v36, v36
    v_exp_f32 v37, v37
    v_mfma_f32_32x32x8_bf16 v[48:63], v[14:15], v[88:89], 0
    ds_read_b64 v[14:15], v81 offset:21504
    v_exp_f32 v38, v38
    v_exp_f32 v39, v39
    v_cvt_pk_bf16_f32 v26, v36, v37
    v_cvt_pk_bf16_f32 v27, v38, v39
    v_exp_f32 v40, v40
    v_exp_f32 v41, v41
    v_mfma_f32_32x32x16_bf16 v[48:63], v[10:13], v[84:87], v[48:63]
    ds_read_b64 v[10:11], v80 offset:21504
    ds_read_b64 v[12:13], v80 offset:21760
    v_exp_f32 v42, v42
    v_exp_f32 v43, v43
    v_cvt_pk_bf16_f32 v28, v40, v41
    v_cvt_pk_bf16_f32 v29, v42, v43
    v_exp_f32 v44, v44
    v_exp_f32 v45, v45
    s_waitcnt lgkmcnt(4)
    v_mfma_f32_32x32x16_bf16 v[64:79], v[16:19], v[24:27], v[64:79]
    v_exp_f32 v46, v46
    v_exp_f32 v47, v47
    v_cvt_pk_bf16_f32 v30, v44, v45
    v_cvt_pk_bf16_f32 v31, v46, v47
    v_exp_f32 v48, v48
    v_exp_f32 v49, v49
    s_waitcnt lgkmcnt(0)
    v_mfma_f32_32x32x16_bf16 v[64:79], v[20:23], v[28:31], v[64:79]
    v_exp_f32 v50, v50
    v_exp_f32 v51, v51
    v_cvt_pk_bf16_f32 v24, v48, v49
    v_cvt_pk_bf16_f32 v25, v50, v51
    v_exp_f32 v52, v52
    v_exp_f32 v53, v53
    v_mfma_f32_32x32x8_bf16 v[32:47], v[14:15], v[8:9], 0
    v_exp_f32 v54, v54
    v_exp_f32 v55, v55
    v_cvt_pk_bf16_f32 v26, v52, v53
    v_cvt_pk_bf16_f32 v27, v54, v55
    v_exp_f32 v56, v56
    v_exp_f32 v57, v57
    v_mfma_f32_32x32x16_bf16 v[32:47], v[10:13], v[4:7], v[32:47]
    v_exp_f32 v58, v58
    v_exp_f32 v59, v59
    v_cvt_pk_bf16_f32 v28, v56, v57
    v_cvt_pk_bf16_f32 v29, v58, v59
    v_exp_f32 v60, v60
    v_exp_f32 v61, v61
    v_mfma_f32_32x32x16_bf16 v[96:111], v[16:19], v[24:27], v[96:111]
    ds_read_b128 v[16:19], v82 offset:21504
    v_exp_f32 v62, v62
    v_exp_f32 v63, v63
    v_cvt_pk_bf16_f32 v30, v60, v61
    v_cvt_pk_bf16_f32 v31, v62, v63
    s_setprio 2
    v_exp_f32 v32, v32
    v_exp_f32 v33, v33
    v_mfma_f32_32x32x16_bf16 v[96:111], v[20:23], v[28:31], v[96:111]
    ds_read_b128 v[20:23], v82 offset:22208
    v_exp_f32 v34, v34
    v_exp_f32 v35, v35
    v_cvt_pk_bf16_f32 v24, v32, v33
    v_cvt_pk_bf16_f32 v25, v34, v35
    v_exp_f32 v36, v36
    v_exp_f32 v37, v37
    v_mfma_f32_32x32x8_bf16 v[48:63], v[14:15], v[88:89], 0
    ds_read_b64 v[14:15], v81 offset:24192
    v_exp_f32 v38, v38
    v_exp_f32 v39, v39
    v_cvt_pk_bf16_f32 v26, v36, v37
    v_cvt_pk_bf16_f32 v27, v38, v39
    v_exp_f32 v40, v40
    v_exp_f32 v41, v41
    v_mfma_f32_32x32x16_bf16 v[48:63], v[10:13], v[84:87], v[48:63]
    ds_read_b64 v[10:11], v80 offset:24192
    ds_read_b64 v[12:13], v80 offset:24448
    v_exp_f32 v42, v42
    v_exp_f32 v43, v43
    v_cvt_pk_bf16_f32 v28, v40, v41
    v_cvt_pk_bf16_f32 v29, v42, v43
    v_exp_f32 v44, v44
    v_exp_f32 v45, v45
    s_waitcnt lgkmcnt(4)
    v_mfma_f32_32x32x16_bf16 v[64:79], v[16:19], v[24:27], v[64:79]
    v_exp_f32 v46, v46
    v_exp_f32 v47, v47
    v_cvt_pk_bf16_f32 v30, v44, v45
    v_cvt_pk_bf16_f32 v31, v46, v47
    v_mov_b32 v90, s13
    v_mov_b32 v91, 0
    s_waitcnt vmcnt(0)
    s_mov_b64 exec, 1
    buffer_store_dword v90, v91, s[8:11], s60 offen sc1
    s_mov_b64 exec, -1
    v_exp_f32 v48, v48
    v_exp_f32 v49, v49
    s_waitcnt lgkmcnt(0)
    v_mfma_f32_32x32x16_bf16 v[64:79], v[20:23], v[28:31], v[64:79]
    v_exp_f32 v50, v50
    v_exp_f32 v51, v51
    v_cvt_pk_bf16_f32 v24, v48, v49
    v_cvt_pk_bf16_f32 v25, v50, v51
    v_exp_f32 v52, v52
    v_exp_f32 v53, v53
    v_mfma_f32_32x32x8_bf16 v[32:47], v[14:15], v[8:9], 0
    v_exp_f32 v54, v54
    v_exp_f32 v55, v55
    v_cvt_pk_bf16_f32 v26, v52, v53
    v_cvt_pk_bf16_f32 v27, v54, v55
    v_exp_f32 v56, v56
    v_exp_f32 v57, v57
    v_mfma_f32_32x32x16_bf16 v[32:47], v[10:13], v[4:7], v[32:47]
    v_exp_f32 v58, v58
    v_exp_f32 v59, v59
    v_cvt_pk_bf16_f32 v28, v56, v57
    v_cvt_pk_bf16_f32 v29, v58, v59
    v_exp_f32 v60, v60
    v_exp_f32 v61, v61
    v_mfma_f32_32x32x16_bf16 v[96:111], v[16:19], v[24:27], v[96:111]
    ds_read_b128 v[16:19], v82 offset:24192
    v_exp_f32 v62, v62
    v_exp_f32 v63, v63
    v_cvt_pk_bf16_f32 v30, v60, v61
    v_cvt_pk_bf16_f32 v31, v62, v63
    s_setprio 1
    v_exp_f32 v32, v32
    v_exp_f32 v33, v33
    v_mfma_f32_32x32x16_bf16 v[96:111], v[20:23], v[28:31], v[96:111]
    ds_read_b128 v[20:23], v82 offset:24896
    v_exp_f32 v34, v34
    v_exp_f32 v35, v35
    v_cvt_pk_bf16_f32 v24, v32, v33
    v_cvt_pk_bf16_f32 v25, v34, v35
    v_exp_f32 v36, v36
    v_exp_f32 v37, v37
    v_mfma_f32_32x32x8_bf16 v[48:63], v[14:15], v[88:89], 0
    ds_read_b64 v[14:15], v81 offset:26880
    v_exp_f32 v38, v38
    v_exp_f32 v39, v39
    v_cvt_pk_bf16_f32 v26, v36, v37
    v_cvt_pk_bf16_f32 v27, v38, v39
    v_exp_f32 v40, v40
    v_exp_f32 v41, v41
    v_mfma_f32_32x32x16_bf16 v[48:63], v[10:13], v[84:87], v[48:63]
    ds_read_b64 v[10:11], v80 offset:26880
    ds_read_b64 v[12:13], v80 offset:27136
    v_exp_f32 v42, v42
    v_exp_f32 v43, v43
    v_cvt_pk_bf16_f32 v28, v40, v41
    v_cvt_pk_bf16_f32 v29, v42, v43
    v_exp_f32 v44, v44
    v_exp_f32 v45, v45
    s_waitcnt lgkmcnt(4)
    v_mfma_f32_32x32x16_bf16 v[64:79], v[16:19], v[24:27], v[64:79]
    v_exp_f32 v46, v46
    v_exp_f32 v47, v47
    v_cvt_pk_bf16_f32 v30, v44, v45
    v_cvt_pk_bf16_f32 v31, v46, v47
    v_exp_f32 v48, v48
    v_exp_f32 v49, v49
    s_waitcnt lgkmcnt(0)
    v_mfma_f32_32x32x16_bf16 v[64:79], v[20:23], v[28:31], v[64:79]
    v_exp_f32 v50, v50
    v_exp_f32 v51, v51
    v_cvt_pk_bf16_f32 v24, v48, v49
    v_cvt_pk_bf16_f32 v25, v50, v51
    v_exp_f32 v52, v52
    v_exp_f32 v53, v53
    v_mfma_f32_32x32x8_bf16 v[32:47], v[14:15], v[8:9], 0
    v_exp_f32 v54, v54
    v_exp_f32 v55, v55
    v_cvt_pk_bf16_f32 v26, v52, v53
    v_cvt_pk_bf16_f32 v27, v54, v55
    v_exp_f32 v56, v56
    v_exp_f32 v57, v57
    v_mfma_f32_32x32x16_bf16 v[32:47], v[10:13], v[4:7], v[32:47]
    v_exp_f32 v58, v58
    v_exp_f32 v59, v59
    v_cvt_pk_bf16_f32 v28, v56, v57
    v_cvt_pk_bf16_f32 v29, v58, v59
    v_exp_f32 v60, v60
    v_exp_f32 v61, v61
    v_mfma_f32_32x32x16_bf16 v[96:111], v[16:19], v[24:27], v[96:111]
    ds_read_b128 v[16:19], v82 offset:26880
    v_exp_f32 v62, v62
    v_exp_f32 v63, v63
    v_cvt_pk_bf16_f32 v30, v60, v61
    v_cvt_pk_bf16_f32 v31, v62, v63
    s_setprio 0
    v_exp_f32 v32, v32
    v_exp_f32 v33, v33
    v_mfma_f32_32x32x16_bf16 v[96:111], v[20:23], v[28:31], v[96:111]
    ds_read_b128 v[20:23], v82 offset:27584
    v_exp_f32 v34, v34
    v_exp_f32 v35, v35
    v_cvt_pk_bf16_f32 v24, v32, v33
    v_cvt_pk_bf16_f32 v25, v34, v35
    v_exp_f32 v36, v36
    v_exp_f32 v37, v37
    v_mfma_f32_32x32x8_bf16 v[48:63], v[14:15], v[88:89], 0
    ds_read_b64 v[14:15], v81 offset:29568
    v_exp_f32 v38, v38
    v_exp_f32 v39, v39
    v_cvt_pk_bf16_f32 v26, v36, v37
    v_cvt_pk_bf16_f32 v27, v38, v39
    v_exp_f32 v40, v40
    v_exp_f32 v41, v41
    v_mfma_f32_32x32x16_bf16 v[48:63], v[10:13], v[84:87], v[48:63]
    ds_read_b64 v[10:11], v80 offset:29568
    ds_read_b64 v[12:13], v80 offset:29824
    v_exp_f32 v42, v42
    v_exp_f32 v43, v43
    v_cvt_pk_bf16_f32 v28, v40, v41
    v_cvt_pk_bf16_f32 v29, v42, v43
    v_exp_f32 v44, v44
    v_exp_f32 v45, v45
    s_waitcnt lgkmcnt(4)
    v_mfma_f32_32x32x16_bf16 v[64:79], v[16:19], v[24:27], v[64:79]
    v_exp_f32 v46, v46
    v_exp_f32 v47, v47
    v_cvt_pk_bf16_f32 v30, v44, v45
    v_cvt_pk_bf16_f32 v31, v46, v47
    v_exp_f32 v48, v48
    v_exp_f32 v49, v49
    s_waitcnt lgkmcnt(0)
    v_mfma_f32_32x32x16_bf16 v[64:79], v[20:23], v[28:31], v[64:79]
    v_exp_f32 v50, v50
    v_exp_f32 v51, v51
    v_cvt_pk_bf16_f32 v24, v48, v49
    v_cvt_pk_bf16_f32 v25, v50, v51
    v_exp_f32 v52, v52
    v_exp_f32 v53, v53
    v_mfma_f32_32x32x8_bf16 v[32:47], v[14:15], v[8:9], 0
    v_exp_f32 v54, v54
    v_exp_f32 v55, v55
    v_cvt_pk_bf16_f32 v26, v52, v53
    v_cvt_pk_bf16_f32 v27, v54, v55
    v_exp_f32 v56, v56
    v_exp_f32 v57, v57
    v_mfma_f32_32x32x16_bf16 v[32:47], v[10:13], v[4:7], v[32:47]
    v_exp_f32 v58, v58
    v_exp_f32 v59, v59
    v_cvt_pk_bf16_f32 v28, v56, v57
    v_cvt_pk_bf16_f32 v29, v58, v59
    v_exp_f32 v60, v60
    v_exp_f32 v61, v61
    v_mfma_f32_32x32x16_bf16 v[96:111], v[16:19], v[24:27], v[96:111]
    ds_read_b128 v[16:19], v82 offset:29568
    v_exp_f32 v62, v62
    v_exp_f32 v63, v63
    v_cvt_pk_bf16_f32 v30, v60, v61
    v_cvt_pk_bf16_f32 v31, v62, v63
    s_setprio 3
    v_exp_f32 v32, v32
    v_exp_f32 v33, v33
    v_mfma_f32_32x32x16_bf16 v[96:111], v[20:23], v[28:31], v[96:111]
    ds_read_b128 v[20:23], v82 offset:30272
    v_exp_f32 v34, v34
    v_exp_f32 v35, v35
    v_cvt_pk_bf16_f32 v24, v32, v33
    v_cvt_pk_bf16_f32 v25, v34, v35
    s_barrier
    v_exp_f32 v36, v36
    v_exp_f32 v37, v37
    v_mfma_f32_32x32x8_bf16 v[48:63], v[14:15], v[88:89], 0
    ds_read_b64 v[14:15], v81 offset:43008
    v_exp_f32 v38, v38
    v_exp_f32 v39, v39
    v_cvt_pk_bf16_f32 v26, v36, v37
    v_cvt_pk_bf16_f32 v27, v38, v39
    v_exp_f32 v40, v40
    v_exp_f32 v41, v41
    v_mfma_f32_32x32x16_bf16 v[48:63], v[10:13], v[84:87], v[48:63]
    ds_read_b64 v[10:11], v80 offset:43008
    ds_read_b64 v[12:13], v80 offset:43264
    v_exp_f32 v42, v42
    v_exp_f32 v43, v43
    v_cvt_pk_bf16_f32 v28, v40, v41
    v_cvt_pk_bf16_f32 v29, v42, v43
    v_exp_f32 v44, v44
    v_exp_f32 v45, v45
    s_waitcnt lgkmcnt(4)
    v_mfma_f32_32x32x16_bf16 v[64:79], v[16:19], v[24:27], v[64:79]
    v_exp_f32 v46, v46
    v_exp_f32 v47, v47
    v_cvt_pk_bf16_f32 v30, v44, v45
    v_cvt_pk_bf16_f32 v31, v46, v47
    v_exp_f32 v48, v48
    v_exp_f32 v49, v49
    s_waitcnt lgkmcnt(0)
    v_mfma_f32_32x32x16_bf16 v[64:79], v[20:23], v[28:31], v[64:79]
    v_exp_f32 v50, v50
    v_exp_f32 v51, v51
    v_cvt_pk_bf16_f32 v24, v48, v49
    v_cvt_pk_bf16_f32 v25, v50, v51
    v_exp_f32 v52, v52
    v_exp_f32 v53, v53
    v_mfma_f32_32x32x8_bf16 v[32:47], v[14:15], v[8:9], 0
    v_exp_f32 v54, v54
    v_exp_f32 v55, v55
    v_cvt_pk_bf16_f32 v26, v52, v53
    v_cvt_pk_bf16_f32 v27, v54, v55
    v_exp_f32 v56, v56
    v_exp_f32 v57, v57
    v_mfma_f32_32x32x16_bf16 v[32:47], v[10:13], v[4:7], v[32:47]
    v_exp_f32 v58, v58
    v_exp_f32 v59, v59
    v_cvt_pk_bf16_f32 v28, v56, v57
    v_cvt_pk_bf16_f32 v29, v58, v59
    v_exp_f32 v60, v60
    v_exp_f32 v61, v61
    v_mfma_f32_32x32x16_bf16 v[96:111], v[16:19], v[24:27], v[96:111]
    ds_read_b128 v[16:19], v82 offset:43008
    v_exp_f32 v62, v62
    v_exp_f32 v63, v63
    v_cvt_pk_bf16_f32 v30, v60, v61
    v_cvt_pk_bf16_f32 v31, v62, v63
    s_setprio 2
    v_exp_f32 v32, v32
    v_exp_f32 v33, v33
    v_mfma_f32_32x32x16_bf16 v[96:111], v[20:23], v[28:31], v[96:111]
    ds_read_b128 v[20:23], v82 offset:43712
    v_exp_f32 v34, v34
    v_exp_f32 v35, v35
    v_cvt_pk_bf16_f32 v24, v32, v33
    v_cvt_pk_bf16_f32 v25, v34, v35
    v_exp_f32 v36, v36
    v_exp_f32 v37, v37
    v_mfma_f32_32x32x8_bf16 v[48:63], v[14:15], v[88:89], 0
    ds_read_b64 v[14:15], v81 offset:45696
    v_exp_f32 v38, v38
    v_exp_f32 v39, v39
    v_cvt_pk_bf16_f32 v26, v36, v37
    v_cvt_pk_bf16_f32 v27, v38, v39
    v_exp_f32 v40, v40
    v_exp_f32 v41, v41
    v_mfma_f32_32x32x16_bf16 v[48:63], v[10:13], v[84:87], v[48:63]
    ds_read_b64 v[10:11], v80 offset:45696
    ds_read_b64 v[12:13], v80 offset:45952
    v_exp_f32 v42, v42
    v_exp_f32 v43, v43
    v_cvt_pk_bf16_f32 v28, v40, v41
    v_cvt_pk_bf16_f32 v29, v42, v43
    v_exp_f32 v44, v44
    v_exp_f32 v45, v45
    s_waitcnt lgkmcnt(4)
    v_mfma_f32_32x32x16_bf16 v[64:79], v[16:19], v[24:27], v[64:79]
    v_exp_f32 v46, v46
    v_exp_f32 v47, v47
    v_cvt_pk_bf16_f32 v30, v44, v45
    v_cvt_pk_bf16_f32 v31, v46, v47
    v_exp_f32 v48, v48
    v_exp_f32 v49, v49
    s_waitcnt lgkmcnt(0)
    v_mfma_f32_32x32x16_bf16 v[64:79], v[20:23], v[28:31], v[64:79]
    v_exp_f32 v50, v50
    v_exp_f32 v51, v51
    v_cvt_pk_bf16_f32 v24, v48, v49
    v_cvt_pk_bf16_f32 v25, v50, v51
    v_exp_f32 v52, v52
    v_exp_f32 v53, v53
    v_mfma_f32_32x32x8_bf16 v[32:47], v[14:15], v[8:9], 0
    v_exp_f32 v54, v54
    v_exp_f32 v55, v55
    v_cvt_pk_bf16_f32 v26, v52, v53
    v_cvt_pk_bf16_f32 v27, v54, v55
    v_exp_f32 v56, v56
    v_exp_f32 v57, v57
    v_mfma_f32_32x32x16_bf16 v[32:47], v[10:13], v[4:7], v[32:47]
    v_exp_f32 v58, v58
    v_exp_f32 v59, v59
    v_cvt_pk_bf16_f32 v28, v56, v57
    v_cvt_pk_bf16_f32 v29, v58, v59
    v_exp_f32 v60, v60
    v_exp_f32 v61, v61
    v_mfma_f32_32x32x16_bf16 v[96:111], v[16:19], v[24:27], v[96:111]
    ds_read_b128 v[16:19], v82 offset:45696
    v_exp_f32 v62, v62
    v_exp_f32 v63, v63
    v_cvt_pk_bf16_f32 v30, v60, v61
    v_cvt_pk_bf16_f32 v31, v62, v63
    s_setprio 1
    v_exp_f32 v32, v32
    v_exp_f32 v33, v33
    v_mfma_f32_32x32x16_bf16 v[96:111], v[20:23], v[28:31], v[96:111]
    ds_read_b128 v[20:23], v82 offset:46400
    v_exp_f32 v34, v34
    v_exp_f32 v35, v35
    v_cvt_pk_bf16_f32 v24, v32, v33
    v_cvt_pk_bf16_f32 v25, v34, v35
    v_exp_f32 v36, v36
    v_exp_f32 v37, v37
    v_mfma_f32_32x32x8_bf16 v[48:63], v[14:15], v[88:89], 0
    ds_read_b64 v[14:15], v81 offset:48384
    v_exp_f32 v38, v38
    v_exp_f32 v39, v39
    v_cvt_pk_bf16_f32 v26, v36, v37
    v_cvt_pk_bf16_f32 v27, v38, v39
    v_exp_f32 v40, v40
    v_exp_f32 v41, v41
    v_mfma_f32_32x32x16_bf16 v[48:63], v[10:13], v[84:87], v[48:63]
    ds_read_b64 v[10:11], v80 offset:48384
    ds_read_b64 v[12:13], v80 offset:48640
    v_exp_f32 v42, v42
    v_exp_f32 v43, v43
    v_cvt_pk_bf16_f32 v28, v40, v41
    v_cvt_pk_bf16_f32 v29, v42, v43
    v_exp_f32 v44, v44
    v_exp_f32 v45, v45
    s_waitcnt lgkmcnt(4)
    v_mfma_f32_32x32x16_bf16 v[64:79], v[16:19], v[24:27], v[64:79]
    v_exp_f32 v46, v46
    v_exp_f32 v47, v47
    v_cvt_pk_bf16_f32 v30, v44, v45
    v_cvt_pk_bf16_f32 v31, v46, v47
    v_exp_f32 v48, v48
    v_exp_f32 v49, v49
    s_waitcnt lgkmcnt(0)
    v_mfma_f32_32x32x16_bf16 v[64:79], v[20:23], v[28:31], v[64:79]
    v_exp_f32 v50, v50
    v_exp_f32 v51, v51
    v_cvt_pk_bf16_f32 v24, v48, v49
    v_cvt_pk_bf16_f32 v25, v50, v51
    v_exp_f32 v52, v52
    v_exp_f32 v53, v53
    v_mfma_f32_32x32x8_bf16 v[32:47], v[14:15], v[8:9], 0
    v_exp_f32 v54, v54
    v_exp_f32 v55, v55
    v_cvt_pk_bf16_f32 v26, v52, v53
    v_cvt_pk_bf16_f32 v27, v54, v55
    v_exp_f32 v56, v56
    v_exp_f32 v57, v57
    v_mfma_f32_32x32x16_bf16 v[32:47], v[10:13], v[4:7], v[32:47]
    v_exp_f32 v58, v58
    v_exp_f32 v59, v59
    v_cvt_pk_bf16_f32 v28, v56, v57
    v_cvt_pk_bf16_f32 v29, v58, v59
    v_exp_f32 v60, v60
    v_exp_f32 v61, v61
    v_mfma_f32_32x32x16_bf16 v[96:111], v[16:19], v[24:27], v[96:111]
    ds_read_b128 v[16:19], v82 offset:48384
    v_exp_f32 v62, v62
    v_exp_f32 v63, v63
    v_cvt_pk_bf16_f32 v30, v60, v61
    v_cvt_pk_bf16_f32 v31, v62, v63
    s_setprio 0
    v_exp_f32 v32, v32
    v_exp_f32 v33, v33
    v_mfma_f32_32x32x16_bf16 v[96:111], v[20:23], v[28:31], v[96:111]
    ds_read_b128 v[20:23], v82 offset:49088
    v_exp_f32 v34, v34
    v_exp_f32 v35, v35
    v_cvt_pk_bf16_f32 v24, v32, v33
    v_cvt_pk_bf16_f32 v25, v34, v35
    v_exp_f32 v36, v36
    v_exp_f32 v37, v37
    v_mfma_f32_32x32x8_bf16 v[48:63], v[14:15], v[88:89], 0
    ds_read_b64 v[14:15], v81 offset:51072
    v_exp_f32 v38, v38
    v_exp_f32 v39, v39
    v_cvt_pk_bf16_f32 v26, v36, v37
    v_cvt_pk_bf16_f32 v27, v38, v39
    v_exp_f32 v40, v40
    v_exp_f32 v41, v41
    v_mfma_f32_32x32x16_bf16 v[48:63], v[10:13], v[84:87], v[48:63]
    ds_read_b64 v[10:11], v80 offset:51072
    ds_read_b64 v[12:13], v80 offset:51328
    v_exp_f32 v42, v42
    v_exp_f32 v43, v43
    v_cvt_pk_bf16_f32 v28, v40, v41
    v_cvt_pk_bf16_f32 v29, v42, v43
    v_exp_f32 v44, v44
    v_exp_f32 v45, v45
    s_waitcnt lgkmcnt(4)
    v_mfma_f32_32x32x16_bf16 v[64:79], v[16:19], v[24:27], v[64:79]
    v_exp_f32 v46, v46
    v_exp_f32 v47, v47
    v_cvt_pk_bf16_f32 v30, v44, v45
    v_cvt_pk_bf16_f32 v31, v46, v47
    v_exp_f32 v48, v48
    v_exp_f32 v49, v49
    s_waitcnt lgkmcnt(0)
    v_mfma_f32_32x32x16_bf16 v[64:79], v[20:23], v[28:31], v[64:79]
    v_exp_f32 v50, v50
    v_exp_f32 v51, v51
    v_cvt_pk_bf16_f32 v24, v48, v49
    v_cvt_pk_bf16_f32 v25, v50, v51
    v_exp_f32 v52, v52
    v_exp_f32 v53, v53
    v_mfma_f32_32x32x8_bf16 v[32:47], v[14:15], v[8:9], 0
    v_exp_f32 v54, v54
    v_exp_f32 v55, v55
    v_cvt_pk_bf16_f32 v26, v52, v53
    v_cvt_pk_bf16_f32 v27, v54, v55
    v_exp_f32 v56, v56
    v_exp_f32 v57, v57
    v_mfma_f32_32x32x16_bf16 v[32:47], v[10:13], v[4:7], v[32:47]
    v_exp_f32 v58, v58
    v_exp_f32 v59, v59
    v_cvt_pk_bf16_f32 v28, v56, v57
    v_cvt_pk_bf16_f32 v29, v58, v59
    v_exp_f32 v60, v60
    v_exp_f32 v61, v61
    v_mfma_f32_32x32x16_bf16 v[96:111], v[16:19], v[24:27], v[96:111]
    ds_read_b128 v[16:19], v82 offset:51072
    v_exp_f32 v62, v62
    v_exp_f32 v63, v63
    v_cvt_pk_bf16_f32 v30, v60, v61
    v_cvt_pk_bf16_f32 v31, v62, v63
    s_setprio 3
    v_exp_f32 v32, v32
    v_exp_f32 v33, v33
    v_mfma_f32_32x32x16_bf16 v[96:111], v[20:23], v[28:31], v[96:111]
    ds_read_b128 v[20:23], v82 offset:51776
    v_exp_f32 v34, v34
    v_exp_f32 v35, v35
    v_cvt_pk_bf16_f32 v24, v32, v33
    v_cvt_pk_bf16_f32 v25, v34, v35
    s_barrier
    v_exp_f32 v36, v36
    v_exp_f32 v37, v37
    v_mfma_f32_32x32x8_bf16 v[48:63], v[14:15], v[88:89], 0
    ds_read_b64 v[14:15], v81 offset:0
    v_exp_f32 v38, v38
    v_exp_f32 v39, v39
    v_cvt_pk_bf16_f32 v26, v36, v37
    v_cvt_pk_bf16_f32 v27, v38, v39
    v_exp_f32 v40, v40
    v_exp_f32 v41, v41
    v_mfma_f32_32x32x16_bf16 v[48:63], v[10:13], v[84:87], v[48:63]
    ds_read_b64 v[10:11], v80 offset:0
    ds_read_b64 v[12:13], v80 offset:256
    v_exp_f32 v42, v42
    v_exp_f32 v43, v43
    v_cvt_pk_bf16_f32 v28, v40, v41
    v_cvt_pk_bf16_f32 v29, v42, v43
    v_exp_f32 v44, v44
    v_exp_f32 v45, v45
    s_waitcnt lgkmcnt(4)
    v_mfma_f32_32x32x16_bf16 v[64:79], v[16:19], v[24:27], v[64:79]
    v_exp_f32 v46, v46
    v_exp_f32 v47, v47
    v_cvt_pk_bf16_f32 v30, v44, v45
    v_cvt_pk_bf16_f32 v31, v46, v47
    v_exp_f32 v48, v48
    v_exp_f32 v49, v49
    s_waitcnt lgkmcnt(0)
    v_mfma_f32_32x32x16_bf16 v[64:79], v[20:23], v[28:31], v[64:79]
    v_exp_f32 v50, v50
    v_exp_f32 v51, v51
    v_cvt_pk_bf16_f32 v24, v48, v49
    v_cvt_pk_bf16_f32 v25, v50, v51
    v_exp_f32 v52, v52
    v_exp_f32 v53, v53
    v_mfma_f32_32x32x8_bf16 v[32:47], v[14:15], v[8:9], 0
    v_exp_f32 v54, v54
    v_exp_f32 v55, v55
    v_cvt_pk_bf16_f32 v26, v52, v53
    v_cvt_pk_bf16_f32 v27, v54, v55
    v_exp_f32 v56, v56
    v_exp_f32 v57, v57
    v_mfma_f32_32x32x16_bf16 v[32:47], v[10:13], v[4:7], v[32:47]
    v_exp_f32 v58, v58
    v_exp_f32 v59, v59
    v_cvt_pk_bf16_f32 v28, v56, v57
    v_cvt_pk_bf16_f32 v29, v58, v59
    v_exp_f32 v60, v60
    v_exp_f32 v61, v61
    v_mfma_f32_32x32x16_bf16 v[96:111], v[16:19], v[24:27], v[96:111]
    ds_read_b128 v[16:19], v82 offset:0
    v_exp_f32 v62, v62
    v_exp_f32 v63, v63
    v_cvt_pk_bf16_f32 v30, v60, v61
    v_cvt_pk_bf16_f32 v31, v62, v63
    s_setprio 2
    v_exp_f32 v32, v32
    v_exp_f32 v33, v33
    v_mfma_f32_32x32x16_bf16 v[96:111], v[20:23], v[28:31], v[96:111]
    ds_read_b128 v[20:23], v82 offset:704
    v_exp_f32 v34, v34
    v_exp_f32 v35, v35
    v_cvt_pk_bf16_f32 v24, v32, v33
    v_cvt_pk_bf16_f32 v25, v34, v35
    v_exp_f32 v36, v36
    v_exp_f32 v37, v37
    v_mfma_f32_32x32x8_bf16 v[48:63], v[14:15], v[88:89], 0
    ds_read_b64 v[14:15], v81 offset:2688
    v_exp_f32 v38, v38
    v_exp_f32 v39, v39
    v_cvt_pk_bf16_f32 v26, v36, v37
    v_cvt_pk_bf16_f32 v27, v38, v39
    v_exp_f32 v40, v40
    v_exp_f32 v41, v41
    v_mfma_f32_32x32x16_bf16 v[48:63], v[10:13], v[84:87], v[48:63]
    ds_read_b64 v[10:11], v80 offset:2688
    ds_read_b64 v[12:13], v80 offset:2944
    v_exp_f32 v42, v42
    v_exp_f32 v43, v43
    v_cvt_pk_bf16_f32 v28, v40, v41
    v_cvt_pk_bf16_f32 v29, v42, v43
    v_exp_f32 v44, v44
    v_exp_f32 v45, v45
    s_waitcnt lgkmcnt(4)
    v_mfma_f32_32x32x16_bf16 v[64:79], v[16:19], v[24:27], v[64:79]
    v_exp_f32 v46, v46
    v_exp_f32 v47, v47
    v_cvt_pk_bf16_f32 v30, v44, v45
    v_cvt_pk_bf16_f32 v31, v46, v47
    v_exp_f32 v48, v48
    v_exp_f32 v49, v49
    s_waitcnt lgkmcnt(0)
    v_mfma_f32_32x32x16_bf16 v[64:79], v[20:23], v[28:31], v[64:79]
    v_exp_f32 v50, v50
    v_exp_f32 v51, v51
    v_cvt_pk_bf16_f32 v24, v48, v49
    v_cvt_pk_bf16_f32 v25, v50, v51
    v_exp_f32 v52, v52
    v_exp_f32 v53, v53
    v_mfma_f32_32x32x8_bf16 v[32:47], v[14:15], v[8:9], 0
    v_exp_f32 v54, v54
    v_exp_f32 v55, v55
    v_cvt_pk_bf16_f32 v26, v52, v53
    v_cvt_pk_bf16_f32 v27, v54, v55
    v_exp_f32 v56, v56
    v_exp_f32 v57, v57
    v_mfma_f32_32x32x16_bf16 v[32:47], v[10:13], v[4:7], v[32:47]
    v_exp_f32 v58, v58
    v_exp_f32 v59, v59
    v_cvt_pk_bf16_f32 v28, v56, v57
    v_cvt_pk_bf16_f32 v29, v58, v59
    v_exp_f32 v60, v60
    v_exp_f32 v61, v61
    v_mfma_f32_32x32x16_bf16 v[96:111], v[16:19], v[24:27], v[96:111]
    ds_read_b128 v[16:19], v82 offset:2688
    v_exp_f32 v62, v62
    v_exp_f32 v63, v63
    v_cvt_pk_bf16_f32 v30, v60, v61
    v_cvt_pk_bf16_f32 v31, v62, v63
    s_setprio 1
    v_exp_f32 v32, v32
    v_exp_f32 v33, v33
    v_mfma_f32_32x32x16_bf16 v[96:111], v[20:23], v[28:31], v[96:111]
    ds_read_b128 v[20:23], v82 offset:3392
    v_exp_f32 v34, v34
    v_exp_f32 v35, v35
    v_cvt_pk_bf16_f32 v24, v32, v33
    v_cvt_pk_bf16_f32 v25, v34, v35
    v_exp_f32 v36, v36
    v_exp_f32 v37, v37
    v_mfma_f32_32x32x8_bf16 v[48:63], v[14:15], v[88:89], 0
    ds_read_b64 v[14:15], v81 offset:5376
    v_exp_f32 v38, v38
    v_exp_f32 v39, v39
    v_cvt_pk_bf16_f32 v26, v36, v37
    v_cvt_pk_bf16_f32 v27, v38, v39
    v_exp_f32 v40, v40
    v_exp_f32 v41, v41
    v_mfma_f32_32x32x16_bf16 v[48:63], v[10:13], v[84:87], v[48:63]
    ds_read_b64 v[10:11], v80 offset:5376
    ds_read_b64 v[12:13], v80 offset:5632
    v_exp_f32 v42, v42
    v_exp_f32 v43, v43
    v_cvt_pk_bf16_f32 v28, v40, v41
    v_cvt_pk_bf16_f32 v29, v42, v43
    v_exp_f32 v44, v44
    v_exp_f32 v45, v45
    s_waitcnt lgkmcnt(4)
    v_mfma_f32_32x32x16_bf16 v[64:79], v[16:19], v[24:27], v[64:79]
    v_exp_f32 v46, v46
    v_exp_f32 v47, v47
    v_cvt_pk_bf16_f32 v30, v44, v45
    v_cvt_pk_bf16_f32 v31, v46, v47
    v_exp_f32 v48, v48
    v_exp_f32 v49, v49
    s_waitcnt lgkmcnt(0)
    v_mfma_f32_32x32x16_bf16 v[64:79], v[20:23], v[28:31], v[64:79]
    v_exp_f32 v50, v50
    v_exp_f32 v51, v51
    v_cvt_pk_bf16_f32 v24, v48, v49
    v_cvt_pk_bf16_f32 v25, v50, v51
    v_exp_f32 v52, v52
    v_exp_f32 v53, v53
    v_mfma_f32_32x32x8_bf16 v[32:47], v[14:15], v[8:9], 0
    v_exp_f32 v54, v54
    v_exp_f32 v55, v55
    v_cvt_pk_bf16_f32 v26, v52, v53
    v_cvt_pk_bf16_f32 v27, v54, v55
    v_exp_f32 v56, v56
    v_exp_f32 v57, v57
    v_mfma_f32_32x32x16_bf16 v[32:47], v[10:13], v[4:7], v[32:47]
    v_exp_f32 v58, v58
    v_exp_f32 v59, v59
    v_cvt_pk_bf16_f32 v28, v56, v57
    v_cvt_pk_bf16_f32 v29, v58, v59
    v_exp_f32 v60, v60
    v_exp_f32 v61, v61
    v_mfma_f32_32x32x16_bf16 v[96:111], v[16:19], v[24:27], v[96:111]
    ds_read_b128 v[16:19], v82 offset:5376
    v_exp_f32 v62, v62
    v_exp_f32 v63, v63
    v_cvt_pk_bf16_f32 v30, v60, v61
    v_cvt_pk_bf16_f32 v31, v62, v63
    s_setprio 0
    v_exp_f32 v32, v32
    v_exp_f32 v33, v33
    v_mfma_f32_32x32x16_bf16 v[96:111], v[20:23], v[28:31], v[96:111]
    ds_read_b128 v[20:23], v82 offset:6080
    v_exp_f32 v34, v34
    v_exp_f32 v35, v35
    v_cvt_pk_bf16_f32 v24, v32, v33
    v_cvt_pk_bf16_f32 v25, v34, v35
    v_exp_f32 v36, v36
    v_exp_f32 v37, v37
    v_mfma_f32_32x32x8_bf16 v[48:63], v[14:15], v[88:89], 0
    ds_read_b64 v[14:15], v81 offset:8064
    v_exp_f32 v38, v38
    v_exp_f32 v39, v39
    v_cvt_pk_bf16_f32 v26, v36, v37
    v_cvt_pk_bf16_f32 v27, v38, v39
    v_exp_f32 v40, v40
    v_exp_f32 v41, v41
    v_mfma_f32_32x32x16_bf16 v[48:63], v[10:13], v[84:87], v[48:63]
    ds_read_b64 v[10:11], v80 offset:8064
    ds_read_b64 v[12:13], v80 offset:8320
    v_exp_f32 v42, v42
    v_exp_f32 v43, v43
    v_cvt_pk_bf16_f32 v28, v40, v41
    v_cvt_pk_bf16_f32 v29, v42, v43
    v_exp_f32 v44, v44
    v_exp_f32 v45, v45
    s_waitcnt lgkmcnt(4)
    v_mfma_f32_32x32x16_bf16 v[64:79], v[16:19], v[24:27], v[64:79]
    v_exp_f32 v46, v46
    v_exp_f32 v47, v47
    v_cvt_pk_bf16_f32 v30, v44, v45
    v_cvt_pk_bf16_f32 v31, v46, v47
    v_exp_f32 v48, v48
    v_exp_f32 v49, v49
    s_waitcnt lgkmcnt(0)
    v_mfma_f32_32x32x16_bf16 v[64:79], v[20:23], v[28:31], v[64:79]
    v_exp_f32 v50, v50
    v_exp_f32 v51, v51
    v_cvt_pk_bf16_f32 v24, v48, v49
    v_cvt_pk_bf16_f32 v25, v50, v51
    v_exp_f32 v52, v52
    v_exp_f32 v53, v53
    v_mfma_f32_32x32x8_bf16 v[32:47], v[14:15], v[8:9], 0
    v_exp_f32 v54, v54
    v_exp_f32 v55, v55
    v_cvt_pk_bf16_f32 v26, v52, v53
    v_cvt_pk_bf16_f32 v27, v54, v55
    v_exp_f32 v56, v56
    v_exp_f32 v57, v57
    v_mfma_f32_32x32x16_bf16 v[32:47], v[10:13], v[4:7], v[32:47]
    v_exp_f32 v58, v58
    v_exp_f32 v59, v59
    v_cvt_pk_bf16_f32 v28, v56, v57
    v_cvt_pk_bf16_f32 v29, v58, v59
    v_exp_f32 v60, v60
    v_exp_f32 v61, v61
    v_mfma_f32_32x32x16_bf16 v[96:111], v[16:19], v[24:27], v[96:111]
    ds_read_b128 v[16:19], v82 offset:8064
    v_exp_f32 v62, v62
    v_exp_f32 v63, v63
    v_cvt_pk_bf16_f32 v30, v60, v61
    v_cvt_pk_bf16_f32 v31, v62, v63
    s_setprio 3
    v_exp_f32 v32, v32
    v_exp_f32 v33, v33
    v_mfma_f32_32x32x16_bf16 v[96:111], v[20:23], v[28:31], v[96:111]
    ds_read_b128 v[20:23], v82 offset:8768
    v_exp_f32 v34, v34
    v_exp_f32 v35, v35
    v_cvt_pk_bf16_f32 v24, v32, v33
    v_cvt_pk_bf16_f32 v25, v34, v35
    s_barrier
    v_exp_f32 v36, v36
    v_exp_f32 v37, v37
    v_mfma_f32_32x32x8_bf16 v[48:63], v[14:15], v[88:89], 0
    ds_read_b64 v[14:15], v81 offset:21504
    v_exp_f32 v38, v38
    v_exp_f32 v39, v39
    v_cvt_pk_bf16_f32 v26, v36, v37
    v_cvt_pk_bf16_f32 v27, v38, v39
    v_exp_f32 v40, v40
    v_exp_f32 v41, v41
    v_mfma_f32_32x32x16_bf16 v[48:63], v[10:13], v[84:87], v[48:63]
    ds_read_b64 v[10:11], v80 offset:21504
    ds_read_b64 v[12:13], v80 offset:21760
    v_exp_f32 v42, v42
    v_exp_f32 v43, v43
    v_cvt_pk_bf16_f32 v28, v40, v41
    v_cvt_pk_bf16_f32 v29, v42, v43
    v_exp_f32 v44, v44
    v_exp_f32 v45, v45
    s_waitcnt lgkmcnt(4)
    v_mfma_f32_32x32x16_bf16 v[64:79], v[16:19], v[24:27], v[64:79]
    v_exp_f32 v46, v46
    v_exp_f32 v47, v47
    v_cvt_pk_bf16_f32 v30, v44, v45
    v_cvt_pk_bf16_f32 v31, v46, v47
    v_exp_f32 v48, v48
    v_exp_f32 v49, v49
    s_waitcnt lgkmcnt(0)
    v_mfma_f32_32x32x16_bf16 v[64:79], v[20:23], v[28:31], v[64:79]
    v_exp_f32 v50, v50
    v_exp_f32 v51, v51
    v_cvt_pk_bf16_f32 v24, v48, v49
    v_cvt_pk_bf16_f32 v25, v50, v51
    v_exp_f32 v52, v52
    v_exp_f32 v53, v53
    v_mfma_f32_32x32x8_bf16 v[32:47], v[14:15], v[8:9], 0
    v_exp_f32 v54, v54
    v_exp_f32 v55, v55
    v_cvt_pk_bf16_f32 v26, v52, v53
    v_cvt_pk_bf16_f32 v27, v54, v55
    v_exp_f32 v56, v56
    v_exp_f32 v57, v57
    v_mfma_f32_32x32x16_bf16 v[32:47], v[10:13], v[4:7], v[32:47]
    v_exp_f32 v58, v58
    v_exp_f32 v59, v59
    v_cvt_pk_bf16_f32 v28, v56, v57
    v_cvt_pk_bf16_f32 v29, v58, v59
    v_exp_f32 v60, v60
    v_exp_f32 v61, v61
    v_mfma_f32_32x32x16_bf16 v[96:111], v[16:19], v[24:27], v[96:111]
    ds_read_b128 v[16:19], v82 offset:21504
    v_exp_f32 v62, v62
    v_exp_f32 v63, v63
    v_cvt_pk_bf16_f32 v30, v60, v61
    v_cvt_pk_bf16_f32 v31, v62, v63
    s_lshr_b32 s30, s12, 2
    s_lshl_b32 s30, s30, 11
    v_lshlrev_b32 v2, 4, v1
    s_mul_i32 s44, s42, 5120
    s_add_u32 s44, s44, 25018368
    s_add_u32 s44, s44, s30
    s_mul_i32 s43, s45, 40960
    s_add_u32 s43, s43, s44
    s_add_u32 s43, s43, 655360
    s_mul_i32 s33, s45, 163840
    s_add_u32 s44, s44, s33
    s_setprio 2
    v_exp_f32 v32, v32
    v_exp_f32 v33, v33
    v_mfma_f32_32x32x16_bf16 v[96:111], v[20:23], v[28:31], v[96:111]
    ds_read_b128 v[20:23], v82 offset:22208
    v_exp_f32 v34, v34
    v_exp_f32 v35, v35
    v_cvt_pk_bf16_f32 v24, v32, v33
    v_cvt_pk_bf16_f32 v25, v34, v35
    v_exp_f32 v36, v36
    v_exp_f32 v37, v37
    v_mfma_f32_32x32x8_bf16 v[48:63], v[14:15], v[88:89], 0
    ds_read_b64 v[14:15], v81 offset:24192
    v_exp_f32 v38, v38
    v_exp_f32 v39, v39
    v_cvt_pk_bf16_f32 v26, v36, v37
    v_cvt_pk_bf16_f32 v27, v38, v39
    v_exp_f32 v40, v40
    v_exp_f32 v41, v41
    v_mfma_f32_32x32x16_bf16 v[48:63], v[10:13], v[84:87], v[48:63]
    ds_read_b64 v[10:11], v80 offset:24192
    ds_read_b64 v[12:13], v80 offset:24448
    v_exp_f32 v42, v42
    v_exp_f32 v43, v43
    v_cvt_pk_bf16_f32 v28, v40, v41
    v_cvt_pk_bf16_f32 v29, v42, v43
    v_exp_f32 v44, v44
    v_exp_f32 v45, v45
    s_waitcnt lgkmcnt(4)
    v_mfma_f32_32x32x16_bf16 v[64:79], v[16:19], v[24:27], v[64:79]
    v_exp_f32 v46, v46
    v_exp_f32 v47, v47
    v_cvt_pk_bf16_f32 v30, v44, v45
    v_cvt_pk_bf16_f32 v31, v46, v47
    buffer_load_dwordx4 v[112:115], v2, s[8:11], s44 offen offset:0 sc1
    buffer_load_dwordx4 v[116:119], v2, s[8:11], s44 offen offset:1024 sc1
    s_add_u32 s44, s44, 20480
    v_exp_f32 v48, v48
    v_exp_f32 v49, v49
    s_waitcnt lgkmcnt(0)
    v_mfma_f32_32x32x16_bf16 v[64:79], v[20:23], v[28:31], v[64:79]
    v_exp_f32 v50, v50
    v_exp_f32 v51, v51
    v_cvt_pk_bf16_f32 v24, v48, v49
    v_cvt_pk_bf16_f32 v25, v50, v51
    v_exp_f32 v52, v52
    v_exp_f32 v53, v53
    v_mfma_f32_32x32x8_bf16 v[32:47], v[14:15], v[8:9], 0
    v_exp_f32 v54, v54
    v_exp_f32 v55, v55
    v_cvt_pk_bf16_f32 v26, v52, v53
    v_cvt_pk_bf16_f32 v27, v54, v55
    v_exp_f32 v56, v56
    v_exp_f32 v57, v57
    v_mfma_f32_32x32x16_bf16 v[32:47], v[10:13], v[4:7], v[32:47]
    v_exp_f32 v58, v58
    v_exp_f32 v59, v59
    v_cvt_pk_bf16_f32 v28, v56, v57
    v_cvt_pk_bf16_f32 v29, v58, v59
    v_exp_f32 v60, v60
    v_exp_f32 v61, v61
    v_mfma_f32_32x32x16_bf16 v[96:111], v[16:19], v[24:27], v[96:111]
    ds_read_b128 v[16:19], v82 offset:24192
    v_exp_f32 v62, v62
    v_exp_f32 v63, v63
    v_cvt_pk_bf16_f32 v30, v60, v61
    v_cvt_pk_bf16_f32 v31, v62, v63
    buffer_load_dwordx4 v[120:123], v2, s[8:11], s44 offen offset:0 sc1
    buffer_load_dwordx4 v[124:127], v2, s[8:11], s44 offen offset:1024 sc1
    s_add_u32 s44, s44, 20480
    s_setprio 1
    v_exp_f32 v32, v32
    v_exp_f32 v33, v33
    v_mfma_f32_32x32x16_bf16 v[96:111], v[20:23], v[28:31], v[96:111]
    ds_read_b128 v[20:23], v82 offset:24896
    v_exp_f32 v34, v34
    v_exp_f32 v35, v35
    v_cvt_pk_bf16_f32 v24, v32, v33
    v_cvt_pk_bf16_f32 v25, v34, v35
    v_exp_f32 v36, v36
    v_exp_f32 v37, v37
    v_mfma_f32_32x32x8_bf16 v[48:63], v[14:15], v[88:89], 0
    ds_read_b64 v[14:15], v81 offset:26880
    v_exp_f32 v38, v38
    v_exp_f32 v39, v39
    v_cvt_pk_bf16_f32 v26, v36, v37
    v_cvt_pk_bf16_f32 v27, v38, v39
    v_exp_f32 v40, v40
    v_exp_f32 v41, v41
    v_mfma_f32_32x32x16_bf16 v[48:63], v[10:13], v[84:87], v[48:63]
    ds_read_b64 v[10:11], v80 offset:26880
    ds_read_b64 v[12:13], v80 offset:27136
    v_exp_f32 v42, v42
    v_exp_f32 v43, v43
    v_cvt_pk_bf16_f32 v28, v40, v41
    v_cvt_pk_bf16_f32 v29, v42, v43
    v_exp_f32 v44, v44
    v_exp_f32 v45, v45
    s_waitcnt lgkmcnt(4)
    v_mfma_f32_32x32x16_bf16 v[64:79], v[16:19], v[24:27], v[64:79]
    v_exp_f32 v46, v46
    v_exp_f32 v47, v47
    v_cvt_pk_bf16_f32 v30, v44, v45
    v_cvt_pk_bf16_f32 v31, v46, v47
    buffer_load_dwordx4 v[128:131], v2, s[8:11], s44 offen offset:0 sc1
    buffer_load_dwordx4 v[132:135], v2, s[8:11], s44 offen offset:1024 sc1
    s_add_u32 s44, s44, 20480
    v_exp_f32 v48, v48
    v_exp_f32 v49, v49
    s_waitcnt lgkmcnt(0)
    v_mfma_f32_32x32x16_bf16 v[64:79], v[20:23], v[28:31], v[64:79]
    v_exp_f32 v50, v50
    v_exp_f32 v51, v51
    v_cvt_pk_bf16_f32 v24, v48, v49
    v_cvt_pk_bf16_f32 v25, v50, v51
    v_exp_f32 v52, v52
    v_exp_f32 v53, v53
    v_mfma_f32_32x32x8_bf16 v[32:47], v[14:15], v[8:9], 0
    v_exp_f32 v54, v54
    v_exp_f32 v55, v55
    v_cvt_pk_bf16_f32 v26, v52, v53
    v_cvt_pk_bf16_f32 v27, v54, v55
    v_exp_f32 v56, v56
    v_exp_f32 v57, v57
    v_mfma_f32_32x32x16_bf16 v[32:47], v[10:13], v[4:7], v[32:47]
    v_exp_f32 v58, v58
    v_exp_f32 v59, v59
    v_cvt_pk_bf16_f32 v28, v56, v57
    v_cvt_pk_bf16_f32 v29, v58, v59
    v_exp_f32 v60, v60
    v_exp_f32 v61, v61
    v_mfma_f32_32x32x16_bf16 v[96:111], v[16:19], v[24:27], v[96:111]
    ds_read_b128 v[16:19], v82 offset:26880
    v_exp_f32 v62, v62
    v_exp_f32 v63, v63
    v_cvt_pk_bf16_f32 v30, v60, v61
    v_cvt_pk_bf16_f32 v31, v62, v63
    buffer_load_dwordx4 v[136:139], v2, s[8:11], s44 offen offset:0 sc1
    buffer_load_dwordx4 v[140:143], v2, s[8:11], s44 offen offset:1024 sc1
    s_add_u32 s44, s44, 20480
    s_setprio 0
    v_exp_f32 v32, v32
    v_exp_f32 v33, v33
    v_mfma_f32_32x32x16_bf16 v[96:111], v[20:23], v[28:31], v[96:111]
    ds_read_b128 v[20:23], v82 offset:27584
    v_exp_f32 v34, v34
    v_exp_f32 v35, v35
    v_cvt_pk_bf16_f32 v24, v32, v33
    v_cvt_pk_bf16_f32 v25, v34, v35
    v_exp_f32 v36, v36
    v_exp_f32 v37, v37
    v_mfma_f32_32x32x8_bf16 v[48:63], v[14:15], v[88:89], 0
    ds_read_b64 v[14:15], v81 offset:29568
    v_exp_f32 v38, v38
    v_exp_f32 v39, v39
    v_cvt_pk_bf16_f32 v26, v36, v37
    v_cvt_pk_bf16_f32 v27, v38, v39
    v_exp_f32 v40, v40
    v_exp_f32 v41, v41
    v_mfma_f32_32x32x16_bf16 v[48:63], v[10:13], v[84:87], v[48:63]
    ds_read_b64 v[10:11], v80 offset:29568
    ds_read_b64 v[12:13], v80 offset:29824
    v_exp_f32 v42, v42
    v_exp_f32 v43, v43
    v_cvt_pk_bf16_f32 v28, v40, v41
    v_cvt_pk_bf16_f32 v29, v42, v43
    v_exp_f32 v44, v44
    v_exp_f32 v45, v45
    s_waitcnt lgkmcnt(4)
    v_mfma_f32_32x32x16_bf16 v[64:79], v[16:19], v[24:27], v[64:79]
    v_exp_f32 v46, v46
    v_exp_f32 v47, v47
    v_cvt_pk_bf16_f32 v30, v44, v45
    v_cvt_pk_bf16_f32 v31, v46, v47
    buffer_load_dwordx4 v[144:147], v2, s[8:11], s44 offen offset:0 sc1
    buffer_load_dwordx4 v[148:151], v2, s[8:11], s44 offen offset:1024 sc1
    s_add_u32 s44, s44, 20480
    v_exp_f32 v48, v48
    v_exp_f32 v49, v49
    s_waitcnt lgkmcnt(0)
    v_mfma_f32_32x32x16_bf16 v[64:79], v[20:23], v[28:31], v[64:79]
    v_exp_f32 v50, v50
    v_exp_f32 v51, v51
    v_cvt_pk_bf16_f32 v24, v48, v49
    v_cvt_pk_bf16_f32 v25, v50, v51
    v_exp_f32 v52, v52
    v_exp_f32 v53, v53
    v_mfma_f32_32x32x8_bf16 v[32:47], v[14:15], v[8:9], 0
    v_exp_f32 v54, v54
    v_exp_f32 v55, v55
    v_cvt_pk_bf16_f32 v26, v52, v53
    v_cvt_pk_bf16_f32 v27, v54, v55
    v_exp_f32 v56, v56
    v_exp_f32 v57, v57
    v_mfma_f32_32x32x16_bf16 v[32:47], v[10:13], v[4:7], v[32:47]
    v_exp_f32 v58, v58
    v_exp_f32 v59, v59
    v_cvt_pk_bf16_f32 v28, v56, v57
    v_cvt_pk_bf16_f32 v29, v58, v59
    v_exp_f32 v60, v60
    v_exp_f32 v61, v61
    v_mfma_f32_32x32x16_bf16 v[96:111], v[16:19], v[24:27], v[96:111]
    ds_read_b128 v[16:19], v82 offset:29568
    v_exp_f32 v62, v62
    v_exp_f32 v63, v63
    v_cvt_pk_bf16_f32 v30, v60, v61
    v_cvt_pk_bf16_f32 v31, v62, v63
    buffer_load_dwordx4 v[152:155], v2, s[8:11], s44 offen offset:0 sc1
    buffer_load_dwordx4 v[156:159], v2, s[8:11], s44 offen offset:1024 sc1
    s_add_u32 s44, s44, 20480
    s_setprio 3
    v_exp_f32 v32, v32
    v_exp_f32 v33, v33
    v_mfma_f32_32x32x16_bf16 v[96:111], v[20:23], v[28:31], v[96:111]
    ds_read_b128 v[20:23], v82 offset:30272
    v_exp_f32 v34, v34
    v_exp_f32 v35, v35
    v_cvt_pk_bf16_f32 v24, v32, v33
    v_cvt_pk_bf16_f32 v25, v34, v35
    s_barrier
    v_exp_f32 v36, v36
    v_exp_f32 v37, v37
    v_mfma_f32_32x32x8_bf16 v[48:63], v[14:15], v[88:89], 0
    ds_read_b64 v[14:15], v81 offset:43008
    v_exp_f32 v38, v38
    v_exp_f32 v39, v39
    v_cvt_pk_bf16_f32 v26, v36, v37
    v_cvt_pk_bf16_f32 v27, v38, v39
    v_exp_f32 v40, v40
    v_exp_f32 v41, v41
    v_mfma_f32_32x32x16_bf16 v[48:63], v[10:13], v[84:87], v[48:63]
    ds_read_b64 v[10:11], v80 offset:43008
    ds_read_b64 v[12:13], v80 offset:43264
    v_exp_f32 v42, v42
    v_exp_f32 v43, v43
    v_cvt_pk_bf16_f32 v28, v40, v41
    v_cvt_pk_bf16_f32 v29, v42, v43
    v_exp_f32 v44, v44
    v_exp_f32 v45, v45
    s_waitcnt lgkmcnt(4)
    v_mfma_f32_32x32x16_bf16 v[64:79], v[16:19], v[24:27], v[64:79]
    v_exp_f32 v46, v46
    v_exp_f32 v47, v47
    v_cvt_pk_bf16_f32 v30, v44, v45
    v_cvt_pk_bf16_f32 v31, v46, v47
    v_exp_f32 v48, v48
    v_exp_f32 v49, v49
    s_waitcnt lgkmcnt(0)
    v_mfma_f32_32x32x16_bf16 v[64:79], v[20:23], v[28:31], v[64:79]
    v_exp_f32 v50, v50
    v_exp_f32 v51, v51
    v_cvt_pk_bf16_f32 v24, v48, v49
    v_cvt_pk_bf16_f32 v25, v50, v51
    v_exp_f32 v52, v52
    v_exp_f32 v53, v53
    v_mfma_f32_32x32x8_bf16 v[32:47], v[14:15], v[8:9], 0
    v_exp_f32 v54, v54
    v_exp_f32 v55, v55
    v_cvt_pk_bf16_f32 v26, v52, v53
    v_cvt_pk_bf16_f32 v27, v54, v55
    v_exp_f32 v56, v56
    v_exp_f32 v57, v57
    v_mfma_f32_32x32x16_bf16 v[32:47], v[10:13], v[4:7], v[32:47]
    v_exp_f32 v58, v58
    v_exp_f32 v59, v59
    v_cvt_pk_bf16_f32 v28, v56, v57
    v_cvt_pk_bf16_f32 v29, v58, v59
    v_exp_f32 v60, v60
    v_exp_f32 v61, v61
    v_mfma_f32_32x32x16_bf16 v[96:111], v[16:19], v[24:27], v[96:111]
    ds_read_b128 v[16:19], v82 offset:43008
    v_exp_f32 v62, v62
    v_exp_f32 v63, v63
    v_cvt_pk_bf16_f32 v30, v60, v61
    v_cvt_pk_bf16_f32 v31, v62, v63
    s_setprio 2
    v_exp_f32 v32, v32
    v_exp_f32 v33, v33
    v_mfma_f32_32x32x16_bf16 v[96:111], v[20:23], v[28:31], v[96:111]
    ds_read_b128 v[20:23], v82 offset:43712
    v_exp_f32 v34, v34
    v_exp_f32 v35, v35
    v_cvt_pk_bf16_f32 v24, v32, v33
    v_cvt_pk_bf16_f32 v25, v34, v35
    v_exp_f32 v36, v36
    v_exp_f32 v37, v37
    v_mfma_f32_32x32x8_bf16 v[48:63], v[14:15], v[88:89], 0
    ds_read_b64 v[14:15], v81 offset:45696
    v_exp_f32 v38, v38
    v_exp_f32 v39, v39
    v_cvt_pk_bf16_f32 v26, v36, v37
    v_cvt_pk_bf16_f32 v27, v38, v39
    v_exp_f32 v40, v40
    v_exp_f32 v41, v41
    v_mfma_f32_32x32x16_bf16 v[48:63], v[10:13], v[84:87], v[48:63]
    ds_read_b64 v[10:11], v80 offset:45696
    ds_read_b64 v[12:13], v80 offset:45952
    v_exp_f32 v42, v42
    v_exp_f32 v43, v43
    v_cvt_pk_bf16_f32 v28, v40, v41
    v_cvt_pk_bf16_f32 v29, v42, v43
    v_exp_f32 v44, v44
    v_exp_f32 v45, v45
    s_waitcnt lgkmcnt(4)
    v_mfma_f32_32x32x16_bf16 v[64:79], v[16:19], v[24:27], v[64:79]
    v_exp_f32 v46, v46
    v_exp_f32 v47, v47
    v_cvt_pk_bf16_f32 v30, v44, v45
    v_cvt_pk_bf16_f32 v31, v46, v47
    v_exp_f32 v48, v48
    v_exp_f32 v49, v49
    s_waitcnt lgkmcnt(0)
    v_mfma_f32_32x32x16_bf16 v[64:79], v[20:23], v[28:31], v[64:79]
    v_exp_f32 v50, v50
    v_exp_f32 v51, v51
    v_cvt_pk_bf16_f32 v24, v48, v49
    v_cvt_pk_bf16_f32 v25, v50, v51
    v_exp_f32 v52, v52
    v_exp_f32 v53, v53
    v_mfma_f32_32x32x8_bf16 v[32:47], v[14:15], v[8:9], 0
    v_exp_f32 v54, v54
    v_exp_f32 v55, v55
    v_cvt_pk_bf16_f32 v26, v52, v53
    v_cvt_pk_bf16_f32 v27, v54, v55
    v_exp_f32 v56, v56
    v_exp_f32 v57, v57
    v_mfma_f32_32x32x16_bf16 v[32:47], v[10:13], v[4:7], v[32:47]
    v_exp_f32 v58, v58
    v_exp_f32 v59, v59
    v_cvt_pk_bf16_f32 v28, v56, v57
    v_cvt_pk_bf16_f32 v29, v58, v59
    v_exp_f32 v60, v60
    v_exp_f32 v61, v61
    v_mfma_f32_32x32x16_bf16 v[96:111], v[16:19], v[24:27], v[96:111]
    ds_read_b128 v[16:19], v82 offset:45696
    v_exp_f32 v62, v62
    v_exp_f32 v63, v63
    v_cvt_pk_bf16_f32 v30, v60, v61
    v_cvt_pk_bf16_f32 v31, v62, v63
    s_mov_b32 s36, s48
    s_mov_b32 s37, s49
    s_mov_b32 s38, 2621440
    s_mov_b32 s39, 0x00020000
    s_lshl_b32 s30, s12, 6
    v_add_u32 v164, s30, v1
    v_mul_u32_u24 v166, 3277, v164
    v_lshrrev_b32 v166, 16, v166
    v_mul_u32_u24 v165, 20, v166
    v_sub_u32 v164, v164, v165
    v_mul_u32_u24 v165, 1280, v166
    v_lshl_add_u32 v165, v164, 4, v165
    v_mul_u32_u24 v164, 1040, v164
    v_lshl_add_u32 v164, v166, 4, v164
    v_add_u32 v164, 64512, v164
    s_mul_i32 s17, s41, 40960
    s_mul_i32 s31, s42, 320
    s_add_u32 s17, s17, s31
    buffer_load_dwordx4 v[160:163], v165, s[36:39], s17 offen
    s_setprio 1
    v_exp_f32 v32, v32
    v_exp_f32 v33, v33
    v_mfma_f32_32x32x16_bf16 v[96:111], v[20:23], v[28:31], v[96:111]
    ds_read_b128 v[20:23], v82 offset:46400
    v_exp_f32 v34, v34
    v_exp_f32 v35, v35
    v_cvt_pk_bf16_f32 v24, v32, v33
    v_cvt_pk_bf16_f32 v25, v34, v35
    v_exp_f32 v36, v36
    v_exp_f32 v37, v37
    v_mfma_f32_32x32x8_bf16 v[48:63], v[14:15], v[88:89], 0
    ds_read_b64 v[14:15], v81 offset:48384
    v_exp_f32 v38, v38
    v_exp_f32 v39, v39
    v_cvt_pk_bf16_f32 v26, v36, v37
    v_cvt_pk_bf16_f32 v27, v38, v39
    v_exp_f32 v40, v40
    v_exp_f32 v41, v41
    v_mfma_f32_32x32x16_bf16 v[48:63], v[10:13], v[84:87], v[48:63]
    ds_read_b64 v[10:11], v80 offset:48384
    ds_read_b64 v[12:13], v80 offset:48640
    v_exp_f32 v42, v42
    v_exp_f32 v43, v43
    v_cvt_pk_bf16_f32 v28, v40, v41
    v_cvt_pk_bf16_f32 v29, v42, v43
    v_exp_f32 v44, v44
    v_exp_f32 v45, v45
    s_waitcnt lgkmcnt(4)
    v_mfma_f32_32x32x16_bf16 v[64:79], v[16:19], v[24:27], v[64:79]
    v_exp_f32 v46, v46
    v_exp_f32 v47, v47
    v_cvt_pk_bf16_f32 v30, v44, v45
    v_cvt_pk_bf16_f32 v31, v46, v47
    v_exp_f32 v48, v48
    v_exp_f32 v49, v49
    s_waitcnt lgkmcnt(0)
    v_mfma_f32_32x32x16_bf16 v[64:79], v[20:23], v[28:31], v[64:79]
    v_exp_f32 v50, v50
    v_exp_f32 v51, v51
    v_cvt_pk_bf16_f32 v24, v48, v49
    v_cvt_pk_bf16_f32 v25, v50, v51
    v_exp_f32 v52, v52
    v_exp_f32 v53, v53
    v_mfma_f32_32x32x8_bf16 v[32:47], v[14:15], v[8:9], 0
    v_exp_f32 v54, v54
    v_exp_f32 v55, v55
    v_cvt_pk_bf16_f32 v26, v52, v53
    v_cvt_pk_bf16_f32 v27, v54, v55
    v_exp_f32 v56, v56
    v_exp_f32 v57, v57
    v_mfma_f32_32x32x16_bf16 v[32:47], v[10:13], v[4:7], v[32:47]
    v_exp_f32 v58, v58
    v_exp_f32 v59, v59
    v_cvt_pk_bf16_f32 v28, v56, v57
    v_cvt_pk_bf16_f32 v29, v58, v59
    v_exp_f32 v60, v60
    v_exp_f32 v61, v61
    v_mfma_f32_32x32x16_bf16 v[96:111], v[16:19], v[24:27], v[96:111]
    ds_read_b128 v[16:19], v82 offset:48384
    v_exp_f32 v62, v62
    v_exp_f32 v63, v63
    v_cvt_pk_bf16_f32 v30, v60, v61
    v_cvt_pk_bf16_f32 v31, v62, v63
    s_mul_i32 s22, s15, 40960
    s_add_u32 s22, s22, 14942208
    s_lshl_b32 s31, s14, 10
    s_add_u32 s23, s31, s22
    s_lshl_b32 s32, s14, 8
    s_add_u32 s22, s22, s32
    s_add_u32 s22, s22, 32768
    s_lshl_b32 s30, s14, 3
    s_add_u32 s30, s30, s46
    s_lshl_b32 s30, s30, 5
    s_and_b32 s31, s15, 7
    s_add_u32 s30, s30, s31
    s_lshl_b32 s30, s30, 2
    s_add_u32 s21, s30, 28557312
    s_mov_b32 s20, 0x1f800000
    v_mov_b32 v94, 0x5f800000
    v_lshlrev_b32 v95, 3, v1
    s_setprio 0
    v_exp_f32 v32, v32
    v_exp_f32 v33, v33
    v_mfma_f32_32x32x16_bf16 v[96:111], v[20:23], v[28:31], v[96:111]
    ds_read_b128 v[20:23], v82 offset:49088
    v_exp_f32 v34, v34
    v_exp_f32 v35, v35
    v_cvt_pk_bf16_f32 v24, v32, v33
    v_cvt_pk_bf16_f32 v25, v34, v35
    v_exp_f32 v36, v36
    v_exp_f32 v37, v37
    v_mfma_f32_32x32x8_bf16 v[48:63], v[14:15], v[88:89], 0
    ds_read_b64 v[14:15], v81 offset:51072
    v_exp_f32 v38, v38
    v_exp_f32 v39, v39
    v_cvt_pk_bf16_f32 v26, v36, v37
    v_cvt_pk_bf16_f32 v27, v38, v39
    v_exp_f32 v40, v40
    v_exp_f32 v41, v41
    v_mfma_f32_32x32x16_bf16 v[48:63], v[10:13], v[84:87], v[48:63]
    ds_read_b64 v[10:11], v80 offset:51072
    ds_read_b64 v[12:13], v80 offset:51328
    v_exp_f32 v42, v42
    v_exp_f32 v43, v43
    v_cvt_pk_bf16_f32 v28, v40, v41
    v_cvt_pk_bf16_f32 v29, v42, v43
    v_exp_f32 v44, v44
    v_exp_f32 v45, v45
    s_waitcnt lgkmcnt(4)
    v_mfma_f32_32x32x16_bf16 v[64:79], v[16:19], v[24:27], v[64:79]
    v_exp_f32 v46, v46
    v_exp_f32 v47, v47
    v_cvt_pk_bf16_f32 v30, v44, v45
    v_cvt_pk_bf16_f32 v31, v46, v47
    v_exp_f32 v48, v48
    v_exp_f32 v49, v49
    s_waitcnt lgkmcnt(0)
    v_mfma_f32_32x32x16_bf16 v[64:79], v[20:23], v[28:31], v[64:79]
    v_exp_f32 v50, v50
    v_exp_f32 v51, v51
    v_cvt_pk_bf16_f32 v24, v48, v49
    v_cvt_pk_bf16_f32 v25, v50, v51
    v_exp_f32 v52, v52
    v_exp_f32 v53, v53
    v_mfma_f32_32x32x8_bf16 v[32:47], v[14:15], v[8:9], 0
    v_exp_f32 v54, v54
    v_exp_f32 v55, v55
    v_cvt_pk_bf16_f32 v26, v52, v53
    v_cvt_pk_bf16_f32 v27, v54, v55
    v_exp_f32 v56, v56
    v_exp_f32 v57, v57
    v_mfma_f32_32x32x16_bf16 v[32:47], v[10:13], v[4:7], v[32:47]
    v_exp_f32 v58, v58
    v_exp_f32 v59, v59
    v_cvt_pk_bf16_f32 v28, v56, v57
    v_cvt_pk_bf16_f32 v29, v58, v59
    v_exp_f32 v60, v60
    v_exp_f32 v61, v61
    v_mfma_f32_32x32x16_bf16 v[96:111], v[16:19], v[24:27], v[96:111]
    ds_read_b128 v[16:19], v82 offset:51072
    v_exp_f32 v62, v62
    v_exp_f32 v63, v63
    v_cvt_pk_bf16_f32 v30, v60, v61
    v_cvt_pk_bf16_f32 v31, v62, v63
    s_setprio 3
    v_exp_f32 v32, v32
    v_exp_f32 v33, v33
    v_mfma_f32_32x32x16_bf16 v[96:111], v[20:23], v[28:31], v[96:111]
    ds_read_b128 v[20:23], v82 offset:51776
    v_exp_f32 v34, v34
    v_exp_f32 v35, v35
    v_cvt_pk_bf16_f32 v24, v32, v33
    v_cvt_pk_bf16_f32 v25, v34, v35
    s_barrier
    v_exp_f32 v36, v36
    v_exp_f32 v37, v37
    v_mfma_f32_32x32x8_bf16 v[48:63], v[14:15], v[88:89], 0
    ds_read_b64 v[14:15], v81 offset:0
    v_exp_f32 v38, v38
    v_exp_f32 v39, v39
    v_cvt_pk_bf16_f32 v26, v36, v37
    v_cvt_pk_bf16_f32 v27, v38, v39
    v_exp_f32 v40, v40
    v_exp_f32 v41, v41
    v_mfma_f32_32x32x16_bf16 v[48:63], v[10:13], v[84:87], v[48:63]
    ds_read_b64 v[10:11], v80 offset:0
    ds_read_b64 v[12:13], v80 offset:256
    v_exp_f32 v42, v42
    v_exp_f32 v43, v43
    v_cvt_pk_bf16_f32 v28, v40, v41
    v_cvt_pk_bf16_f32 v29, v42, v43
    v_exp_f32 v44, v44
    v_exp_f32 v45, v45
    s_waitcnt lgkmcnt(4)
    v_mfma_f32_32x32x16_bf16 v[64:79], v[16:19], v[24:27], v[64:79]
    v_exp_f32 v46, v46
    v_exp_f32 v47, v47
    v_cvt_pk_bf16_f32 v30, v44, v45
    v_cvt_pk_bf16_f32 v31, v46, v47
    s_lshl_b32 s30, s12, 13
    s_add_u32 m0, s30, 89088
    s_nop 0
    buffer_load_dwordx4 v2, s[8:11], s44 offen sc1 lds
    buffer_load_dwordx4 v2, s[8:11], s44 offen offset:1024 sc1 lds
    s_add_u32 s44, s44, 20480
    v_exp_f32 v48, v48
    v_exp_f32 v49, v49
    s_waitcnt lgkmcnt(0)
    v_mfma_f32_32x32x16_bf16 v[64:79], v[20:23], v[28:31], v[64:79]
    v_exp_f32 v50, v50
    v_exp_f32 v51, v51
    v_cvt_pk_bf16_f32 v24, v48, v49
    v_cvt_pk_bf16_f32 v25, v50, v51
    v_exp_f32 v52, v52
    v_exp_f32 v53, v53
    v_mfma_f32_32x32x8_bf16 v[32:47], v[14:15], v[8:9], 0
    v_exp_f32 v54, v54
    v_exp_f32 v55, v55
    v_cvt_pk_bf16_f32 v26, v52, v53
    v_cvt_pk_bf16_f32 v27, v54, v55
    v_exp_f32 v56, v56
    v_exp_f32 v57, v57
    v_mfma_f32_32x32x16_bf16 v[32:47], v[10:13], v[4:7], v[32:47]
    v_exp_f32 v58, v58
    v_exp_f32 v59, v59
    v_cvt_pk_bf16_f32 v28, v56, v57
    v_cvt_pk_bf16_f32 v29, v58, v59
    v_exp_f32 v60, v60
    v_exp_f32 v61, v61
    v_mfma_f32_32x32x16_bf16 v[96:111], v[16:19], v[24:27], v[96:111]
    ds_read_b128 v[16:19], v82 offset:0
    v_exp_f32 v62, v62
    v_exp_f32 v63, v63
    v_cvt_pk_bf16_f32 v30, v60, v61
    v_cvt_pk_bf16_f32 v31, v62, v63
    s_lshl_b32 s30, s12, 13
    s_add_u32 m0, s30, 91136
    s_nop 0
    buffer_load_dwordx4 v2, s[8:11], s44 offen sc1 lds
    buffer_load_dwordx4 v2, s[8:11], s44 offen offset:1024 sc1 lds
    s_add_u32 s44, s44, 20480
    s_setprio 2
    v_exp_f32 v32, v32
    v_exp_f32 v33, v33
    v_mfma_f32_32x32x16_bf16 v[96:111], v[20:23], v[28:31], v[96:111]
    ds_read_b128 v[20:23], v82 offset:704
    v_exp_f32 v34, v34
    v_exp_f32 v35, v35
    v_cvt_pk_bf16_f32 v24, v32, v33
    v_cvt_pk_bf16_f32 v25, v34, v35
    v_exp_f32 v36, v36
    v_exp_f32 v37, v37
    v_mfma_f32_32x32x8_bf16 v[48:63], v[14:15], v[88:89], 0
    ds_read_b64 v[14:15], v81 offset:2688
    v_exp_f32 v38, v38
    v_exp_f32 v39, v39
    v_cvt_pk_bf16_f32 v26, v36, v37
    v_cvt_pk_bf16_f32 v27, v38, v39
    v_exp_f32 v40, v40
    v_exp_f32 v41, v41
    v_mfma_f32_32x32x16_bf16 v[48:63], v[10:13], v[84:87], v[48:63]
    ds_read_b64 v[10:11], v80 offset:2688
    ds_read_b64 v[12:13], v80 offset:2944
    v_exp_f32 v42, v42
    v_exp_f32 v43, v43
    v_cvt_pk_bf16_f32 v28, v40, v41
    v_cvt_pk_bf16_f32 v29, v42, v43
    v_exp_f32 v44, v44
    v_exp_f32 v45, v45
    s_waitcnt lgkmcnt(4)
    v_mfma_f32_32x32x16_bf16 v[64:79], v[16:19], v[24:27], v[64:79]
    v_exp_f32 v46, v46
    v_exp_f32 v47, v47
    v_cvt_pk_bf16_f32 v30, v44, v45
    v_cvt_pk_bf16_f32 v31, v46, v47
    s_lshl_b32 s30, s12, 13
    s_add_u32 m0, s30, 93184
    s_nop 0
    buffer_load_dwordx4 v2, s[8:11], s43 offen sc1 lds
    buffer_load_dwordx4 v2, s[8:11], s43 offen offset:1024 sc1 lds
    s_add_u32 s43, s43, 20480
    v_exp_f32 v48, v48
    v_exp_f32 v49, v49
    s_waitcnt lgkmcnt(0)
    v_mfma_f32_32x32x16_bf16 v[64:79], v[20:23], v[28:31], v[64:79]
    v_exp_f32 v50, v50
    v_exp_f32 v51, v51
    v_cvt_pk_bf16_f32 v24, v48, v49
    v_cvt_pk_bf16_f32 v25, v50, v51
    v_exp_f32 v52, v52
    v_exp_f32 v53, v53
    v_mfma_f32_32x32x8_bf16 v[32:47], v[14:15], v[8:9], 0
    v_exp_f32 v54, v54
    v_exp_f32 v55, v55
    v_cvt_pk_bf16_f32 v26, v52, v53
    v_cvt_pk_bf16_f32 v27, v54, v55
    v_exp_f32 v56, v56
    v_exp_f32 v57, v57
    v_mfma_f32_32x32x16_bf16 v[32:47], v[10:13], v[4:7], v[32:47]
    v_exp_f32 v58, v58
    v_exp_f32 v59, v59
    v_cvt_pk_bf16_f32 v28, v56, v57
    v_cvt_pk_bf16_f32 v29, v58, v59
    v_exp_f32 v60, v60
    v_exp_f32 v61, v61
    v_mfma_f32_32x32x16_bf16 v[96:111], v[16:19], v[24:27], v[96:111]
    ds_read_b128 v[16:19], v82 offset:2688
    v_exp_f32 v62, v62
    v_exp_f32 v63, v63
    v_cvt_pk_bf16_f32 v30, v60, v61
    v_cvt_pk_bf16_f32 v31, v62, v63
    s_lshl_b32 s30, s12, 13
    s_add_u32 m0, s30, 95232
    s_nop 0
    buffer_load_dwordx4 v2, s[8:11], s43 offen sc1 lds
    buffer_load_dwordx4 v2, s[8:11], s43 offen offset:1024 sc1 lds
    s_add_u32 s43, s43, 20480
    s_setprio 1
    v_exp_f32 v32, v32
    v_exp_f32 v33, v33
    v_mfma_f32_32x32x16_bf16 v[96:111], v[20:23], v[28:31], v[96:111]
    ds_read_b128 v[20:23], v82 offset:3392
    v_exp_f32 v34, v34
    v_exp_f32 v35, v35
    v_cvt_pk_bf16_f32 v24, v32, v33
    v_cvt_pk_bf16_f32 v25, v34, v35
    v_exp_f32 v36, v36
    v_exp_f32 v37, v37
    v_mfma_f32_32x32x8_bf16 v[48:63], v[14:15], v[88:89], 0
    ds_read_b64 v[14:15], v81 offset:5376
    v_exp_f32 v38, v38
    v_exp_f32 v39, v39
    v_cvt_pk_bf16_f32 v26, v36, v37
    v_cvt_pk_bf16_f32 v27, v38, v39
    v_exp_f32 v40, v40
    v_exp_f32 v41, v41
    v_mfma_f32_32x32x16_bf16 v[48:63], v[10:13], v[84:87], v[48:63]
    ds_read_b64 v[10:11], v80 offset:5376
    ds_read_b64 v[12:13], v80 offset:5632
    v_exp_f32 v42, v42
    v_exp_f32 v43, v43
    v_cvt_pk_bf16_f32 v28, v40, v41
    v_cvt_pk_bf16_f32 v29, v42, v43
    v_exp_f32 v44, v44
    v_exp_f32 v45, v45
    s_waitcnt lgkmcnt(4)
    v_mfma_f32_32x32x16_bf16 v[64:79], v[16:19], v[24:27], v[64:79]
    v_exp_f32 v46, v46
    v_exp_f32 v47, v47
    v_cvt_pk_bf16_f32 v30, v44, v45
    v_cvt_pk_bf16_f32 v31, v46, v47
    v_exp_f32 v48, v48
    v_exp_f32 v49, v49
    s_waitcnt lgkmcnt(0)
    v_mfma_f32_32x32x16_bf16 v[64:79], v[20:23], v[28:31], v[64:79]
    v_exp_f32 v50, v50
    v_exp_f32 v51, v51
    v_cvt_pk_bf16_f32 v24, v48, v49
    v_cvt_pk_bf16_f32 v25, v50, v51
    v_exp_f32 v52, v52
    v_exp_f32 v53, v53
    v_mfma_f32_32x32x8_bf16 v[32:47], v[14:15], v[8:9], 0
    v_exp_f32 v54, v54
    v_exp_f32 v55, v55
    v_cvt_pk_bf16_f32 v26, v52, v53
    v_cvt_pk_bf16_f32 v27, v54, v55
    v_exp_f32 v56, v56
    v_exp_f32 v57, v57
    v_mfma_f32_32x32x16_bf16 v[32:47], v[10:13], v[4:7], v[32:47]
    v_exp_f32 v58, v58
    v_exp_f32 v59, v59
    v_cvt_pk_bf16_f32 v28, v56, v57
    v_cvt_pk_bf16_f32 v29, v58, v59
    v_exp_f32 v60, v60
    v_exp_f32 v61, v61
    v_mfma_f32_32x32x16_bf16 v[96:111], v[16:19], v[24:27], v[96:111]
    ds_read_b128 v[16:19], v82 offset:5376
    v_exp_f32 v62, v62
    v_exp_f32 v63, v63
    v_cvt_pk_bf16_f32 v30, v60, v61
    v_cvt_pk_bf16_f32 v31, v62, v63
    s_setprio 0
    v_exp_f32 v32, v32
    v_exp_f32 v33, v33
    v_mfma_f32_32x32x16_bf16 v[96:111], v[20:23], v[28:31], v[96:111]
    ds_read_b128 v[20:23], v82 offset:6080
    v_exp_f32 v34, v34
    v_exp_f32 v35, v35
    v_cvt_pk_bf16_f32 v24, v32, v33
    v_cvt_pk_bf16_f32 v25, v34, v35
    v_exp_f32 v36, v36
    v_exp_f32 v37, v37
    v_mfma_f32_32x32x8_bf16 v[48:63], v[14:15], v[88:89], 0
    ds_read_b64 v[14:15], v81 offset:8064
    v_exp_f32 v38, v38
    v_exp_f32 v39, v39
    v_cvt_pk_bf16_f32 v26, v36, v37
    v_cvt_pk_bf16_f32 v27, v38, v39
    v_exp_f32 v40, v40
    v_exp_f32 v41, v41
    v_mfma_f32_32x32x16_bf16 v[48:63], v[10:13], v[84:87], v[48:63]
    ds_read_b64 v[10:11], v80 offset:8064
    ds_read_b64 v[12:13], v80 offset:8320
    v_exp_f32 v42, v42
    v_exp_f32 v43, v43
    v_cvt_pk_bf16_f32 v28, v40, v41
    v_cvt_pk_bf16_f32 v29, v42, v43
    v_exp_f32 v44, v44
    v_exp_f32 v45, v45
    s_waitcnt lgkmcnt(4)
    v_mfma_f32_32x32x16_bf16 v[64:79], v[16:19], v[24:27], v[64:79]
    v_exp_f32 v46, v46
    v_exp_f32 v47, v47
    v_cvt_pk_bf16_f32 v30, v44, v45
    v_cvt_pk_bf16_f32 v31, v46, v47
    v_exp_f32 v48, v48
    v_exp_f32 v49, v49
    s_waitcnt lgkmcnt(0)
    v_mfma_f32_32x32x16_bf16 v[64:79], v[20:23], v[28:31], v[64:79]
    v_exp_f32 v50, v50
    v_exp_f32 v51, v51
    v_cvt_pk_bf16_f32 v24, v48, v49
    v_cvt_pk_bf16_f32 v25, v50, v51
    v_exp_f32 v52, v52
    v_exp_f32 v53, v53
    v_mfma_f32_32x32x8_bf16 v[32:47], v[14:15], v[8:9], 0
    v_exp_f32 v54, v54
    v_exp_f32 v55, v55
    v_cvt_pk_bf16_f32 v26, v52, v53
    v_cvt_pk_bf16_f32 v27, v54, v55
    v_exp_f32 v56, v56
    v_exp_f32 v57, v57
    v_mfma_f32_32x32x16_bf16 v[32:47], v[10:13], v[4:7], v[32:47]
    v_exp_f32 v58, v58
    v_exp_f32 v59, v59
    v_cvt_pk_bf16_f32 v28, v56, v57
    v_cvt_pk_bf16_f32 v29, v58, v59
    v_exp_f32 v60, v60
    v_exp_f32 v61, v61
    v_mfma_f32_32x32x16_bf16 v[96:111], v[16:19], v[24:27], v[96:111]
    ds_read_b128 v[16:19], v82 offset:8064
    v_exp_f32 v62, v62
    v_exp_f32 v63, v63
    v_cvt_pk_bf16_f32 v30, v60, v61
    v_cvt_pk_bf16_f32 v31, v62, v63
    s_setprio 3
    v_exp_f32 v32, v32
    v_exp_f32 v33, v33
    v_mfma_f32_32x32x16_bf16 v[96:111], v[20:23], v[28:31], v[96:111]
    ds_read_b128 v[20:23], v82 offset:8768
    v_exp_f32 v34, v34
    v_exp_f32 v35, v35
    v_cvt_pk_bf16_f32 v24, v32, v33
    v_cvt_pk_bf16_f32 v25, v34, v35
    s_barrier
    v_exp_f32 v36, v36
    v_exp_f32 v37, v37
    v_mfma_f32_32x32x8_bf16 v[48:63], v[14:15], v[88:89], 0
    ds_read_b64 v[14:15], v81 offset:21504
    v_exp_f32 v38, v38
    v_exp_f32 v39, v39
    v_cvt_pk_bf16_f32 v26, v36, v37
    v_cvt_pk_bf16_f32 v27, v38, v39
    v_exp_f32 v40, v40
    v_exp_f32 v41, v41
    v_mfma_f32_32x32x16_bf16 v[48:63], v[10:13], v[84:87], v[48:63]
    ds_read_b64 v[10:11], v80 offset:21504
    ds_read_b64 v[12:13], v80 offset:21760
    v_exp_f32 v42, v42
    v_exp_f32 v43, v43
    v_cvt_pk_bf16_f32 v28, v40, v41
    v_cvt_pk_bf16_f32 v29, v42, v43
    v_exp_f32 v44, v44
    v_exp_f32 v45, v45
    s_waitcnt lgkmcnt(4)
    v_mfma_f32_32x32x16_bf16 v[64:79], v[16:19], v[24:27], v[64:79]
    v_exp_f32 v46, v46
    v_exp_f32 v47, v47
    v_cvt_pk_bf16_f32 v30, v44, v45
    v_cvt_pk_bf16_f32 v31, v46, v47
    v_exp_f32 v48, v48
    v_exp_f32 v49, v49
    s_waitcnt lgkmcnt(0)
    v_mfma_f32_32x32x16_bf16 v[64:79], v[20:23], v[28:31], v[64:79]
    v_exp_f32 v50, v50
    v_exp_f32 v51, v51
    v_cvt_pk_bf16_f32 v24, v48, v49
    v_cvt_pk_bf16_f32 v25, v50, v51
    v_exp_f32 v52, v52
    v_exp_f32 v53, v53
    v_mfma_f32_32x32x8_bf16 v[32:47], v[14:15], v[8:9], 0
    v_exp_f32 v54, v54
    v_exp_f32 v55, v55
    v_cvt_pk_bf16_f32 v26, v52, v53
    v_cvt_pk_bf16_f32 v27, v54, v55
    v_exp_f32 v56, v56
    v_exp_f32 v57, v57
    v_mfma_f32_32x32x16_bf16 v[32:47], v[10:13], v[4:7], v[32:47]
    v_exp_f32 v58, v58
    v_exp_f32 v59, v59
    v_cvt_pk_bf16_f32 v28, v56, v57
    v_cvt_pk_bf16_f32 v29, v58, v59
    v_exp_f32 v60, v60
    v_exp_f32 v61, v61
    v_mfma_f32_32x32x16_bf16 v[96:111], v[16:19], v[24:27], v[96:111]
    ds_read_b128 v[16:19], v82 offset:21504
    v_exp_f32 v62, v62
    v_exp_f32 v63, v63
    v_cvt_pk_bf16_f32 v30, v60, v61
    v_cvt_pk_bf16_f32 v31, v62, v63
    s_setprio 2
    v_exp_f32 v32, v32
    v_exp_f32 v33, v33
    v_mfma_f32_32x32x16_bf16 v[96:111], v[20:23], v[28:31], v[96:111]
    ds_read_b128 v[20:23], v82 offset:22208
    v_exp_f32 v34, v34
    v_exp_f32 v35, v35
    v_cvt_pk_bf16_f32 v24, v32, v33
    v_cvt_pk_bf16_f32 v25, v34, v35
    v_exp_f32 v36, v36
    v_exp_f32 v37, v37
    v_mfma_f32_32x32x8_bf16 v[48:63], v[14:15], v[88:89], 0
    ds_read_b64 v[14:15], v81 offset:24192
    v_exp_f32 v38, v38
    v_exp_f32 v39, v39
    v_cvt_pk_bf16_f32 v26, v36, v37
    v_cvt_pk_bf16_f32 v27, v38, v39
    v_exp_f32 v40, v40
    v_exp_f32 v41, v41
    v_mfma_f32_32x32x16_bf16 v[48:63], v[10:13], v[84:87], v[48:63]
    ds_read_b64 v[10:11], v80 offset:24192
    ds_read_b64 v[12:13], v80 offset:24448
    v_exp_f32 v42, v42
    v_exp_f32 v43, v43
    v_cvt_pk_bf16_f32 v28, v40, v41
    v_cvt_pk_bf16_f32 v29, v42, v43
    v_exp_f32 v44, v44
    v_exp_f32 v45, v45
    s_waitcnt lgkmcnt(4)
    v_mfma_f32_32x32x16_bf16 v[64:79], v[16:19], v[24:27], v[64:79]
    v_exp_f32 v46, v46
    v_exp_f32 v47, v47
    v_cvt_pk_bf16_f32 v30, v44, v45
    v_cvt_pk_bf16_f32 v31, v46, v47
    v_exp_f32 v48, v48
    v_exp_f32 v49, v49
    s_waitcnt lgkmcnt(0)
    v_mfma_f32_32x32x16_bf16 v[64:79], v[20:23], v[28:31], v[64:79]
    v_exp_f32 v50, v50
    v_exp_f32 v51, v51
    v_cvt_pk_bf16_f32 v24, v48, v49
    v_cvt_pk_bf16_f32 v25, v50, v51
    v_exp_f32 v52, v52
    v_exp_f32 v53, v53
    v_mfma_f32_32x32x8_bf16 v[32:47], v[14:15], v[8:9], 0
    v_exp_f32 v54, v54
    v_exp_f32 v55, v55
    v_cvt_pk_bf16_f32 v26, v52, v53
    v_cvt_pk_bf16_f32 v27, v54, v55
    v_exp_f32 v56, v56
    v_exp_f32 v57, v57
    v_mfma_f32_32x32x16_bf16 v[32:47], v[10:13], v[4:7], v[32:47]
    v_exp_f32 v58, v58
    v_exp_f32 v59, v59
    v_cvt_pk_bf16_f32 v28, v56, v57
    v_cvt_pk_bf16_f32 v29, v58, v59
    v_exp_f32 v60, v60
    v_exp_f32 v61, v61
    v_mfma_f32_32x32x16_bf16 v[96:111], v[16:19], v[24:27], v[96:111]
    ds_read_b128 v[16:19], v82 offset:24192
    v_exp_f32 v62, v62
    v_exp_f32 v63, v63
    v_cvt_pk_bf16_f32 v30, v60, v61
    v_cvt_pk_bf16_f32 v31, v62, v63
    s_setprio 1
    v_exp_f32 v32, v32
    v_exp_f32 v33, v33
    v_mfma_f32_32x32x16_bf16 v[96:111], v[20:23], v[28:31], v[96:111]
    ds_read_b128 v[20:23], v82 offset:24896
    v_exp_f32 v34, v34
    v_exp_f32 v35, v35
    v_cvt_pk_bf16_f32 v24, v32, v33
    v_cvt_pk_bf16_f32 v25, v34, v35
    v_exp_f32 v36, v36
    v_exp_f32 v37, v37
    v_mfma_f32_32x32x8_bf16 v[48:63], v[14:15], v[88:89], 0
    ds_read_b64 v[14:15], v81 offset:26880
    v_exp_f32 v38, v38
    v_exp_f32 v39, v39
    v_cvt_pk_bf16_f32 v26, v36, v37
    v_cvt_pk_bf16_f32 v27, v38, v39
    v_exp_f32 v40, v40
    v_exp_f32 v41, v41
    v_mfma_f32_32x32x16_bf16 v[48:63], v[10:13], v[84:87], v[48:63]
    ds_read_b64 v[10:11], v80 offset:26880
    ds_read_b64 v[12:13], v80 offset:27136
    v_exp_f32 v42, v42
    v_exp_f32 v43, v43
    v_cvt_pk_bf16_f32 v28, v40, v41
    v_cvt_pk_bf16_f32 v29, v42, v43
    v_exp_f32 v44, v44
    v_exp_f32 v45, v45
    s_waitcnt lgkmcnt(4)
    v_mfma_f32_32x32x16_bf16 v[64:79], v[16:19], v[24:27], v[64:79]
    v_exp_f32 v46, v46
    v_exp_f32 v47, v47
    v_cvt_pk_bf16_f32 v30, v44, v45
    v_cvt_pk_bf16_f32 v31, v46, v47
    v_exp_f32 v48, v48
    v_exp_f32 v49, v49
    s_waitcnt lgkmcnt(0)
    v_mfma_f32_32x32x16_bf16 v[64:79], v[20:23], v[28:31], v[64:79]
    v_exp_f32 v50, v50
    v_exp_f32 v51, v51
    v_cvt_pk_bf16_f32 v24, v48, v49
    v_cvt_pk_bf16_f32 v25, v50, v51
    v_exp_f32 v52, v52
    v_exp_f32 v53, v53
    v_mfma_f32_32x32x8_bf16 v[32:47], v[14:15], v[8:9], 0
    v_exp_f32 v54, v54
    v_exp_f32 v55, v55
    v_cvt_pk_bf16_f32 v26, v52, v53
    v_cvt_pk_bf16_f32 v27, v54, v55
    v_exp_f32 v56, v56
    v_exp_f32 v57, v57
    v_mfma_f32_32x32x16_bf16 v[32:47], v[10:13], v[4:7], v[32:47]
    v_exp_f32 v58, v58
    v_exp_f32 v59, v59
    v_cvt_pk_bf16_f32 v28, v56, v57
    v_cvt_pk_bf16_f32 v29, v58, v59
    v_exp_f32 v60, v60
    v_exp_f32 v61, v61
    v_mfma_f32_32x32x16_bf16 v[96:111], v[16:19], v[24:27], v[96:111]
    ds_read_b128 v[16:19], v82 offset:26880
    v_exp_f32 v62, v62
    v_exp_f32 v63, v63
    v_cvt_pk_bf16_f32 v30, v60, v61
    v_cvt_pk_bf16_f32 v31, v62, v63
    s_setprio 0
    v_exp_f32 v32, v32
    v_exp_f32 v33, v33
    v_mfma_f32_32x32x16_bf16 v[96:111], v[20:23], v[28:31], v[96:111]
    ds_read_b128 v[20:23], v82 offset:27584
    v_exp_f32 v34, v34
    v_exp_f32 v35, v35
    v_cvt_pk_bf16_f32 v24, v32, v33
    v_cvt_pk_bf16_f32 v25, v34, v35
    v_exp_f32 v36, v36
    v_exp_f32 v37, v37
    v_mfma_f32_32x32x8_bf16 v[48:63], v[14:15], v[88:89], 0
    ds_read_b64 v[14:15], v81 offset:29568
    v_exp_f32 v38, v38
    v_exp_f32 v39, v39
    v_cvt_pk_bf16_f32 v26, v36, v37
    v_cvt_pk_bf16_f32 v27, v38, v39
    v_exp_f32 v40, v40
    v_exp_f32 v41, v41
    v_mfma_f32_32x32x16_bf16 v[48:63], v[10:13], v[84:87], v[48:63]
    ds_read_b64 v[10:11], v80 offset:29568
    ds_read_b64 v[12:13], v80 offset:29824
    v_exp_f32 v42, v42
    v_exp_f32 v43, v43
    v_cvt_pk_bf16_f32 v28, v40, v41
    v_cvt_pk_bf16_f32 v29, v42, v43
    v_exp_f32 v44, v44
    v_exp_f32 v45, v45
    s_waitcnt lgkmcnt(4)
    v_mfma_f32_32x32x16_bf16 v[64:79], v[16:19], v[24:27], v[64:79]
    v_exp_f32 v46, v46
    v_exp_f32 v47, v47
    v_cvt_pk_bf16_f32 v30, v44, v45
    v_cvt_pk_bf16_f32 v31, v46, v47
    v_exp_f32 v48, v48
    v_exp_f32 v49, v49
    s_waitcnt lgkmcnt(0)
    v_mfma_f32_32x32x16_bf16 v[64:79], v[20:23], v[28:31], v[64:79]
    v_exp_f32 v50, v50
    v_exp_f32 v51, v51
    v_cvt_pk_bf16_f32 v24, v48, v49
    v_cvt_pk_bf16_f32 v25, v50, v51
    v_exp_f32 v52, v52
    v_exp_f32 v53, v53
    v_mfma_f32_32x32x8_bf16 v[32:47], v[14:15], v[8:9], 0
    v_exp_f32 v54, v54
    v_exp_f32 v55, v55
    v_cvt_pk_bf16_f32 v26, v52, v53
    v_cvt_pk_bf16_f32 v27, v54, v55
    v_exp_f32 v56, v56
    v_exp_f32 v57, v57
    v_mfma_f32_32x32x16_bf16 v[32:47], v[10:13], v[4:7], v[32:47]
    v_exp_f32 v58, v58
    v_exp_f32 v59, v59
    v_cvt_pk_bf16_f32 v28, v56, v57
    v_cvt_pk_bf16_f32 v29, v58, v59
    v_exp_f32 v60, v60
    v_exp_f32 v61, v61
    v_mfma_f32_32x32x16_bf16 v[96:111], v[16:19], v[24:27], v[96:111]
    ds_read_b128 v[16:19], v82 offset:29568
    v_exp_f32 v62, v62
    v_exp_f32 v63, v63
    v_cvt_pk_bf16_f32 v30, v60, v61
    v_cvt_pk_bf16_f32 v31, v62, v63
    s_setprio 3
    v_exp_f32 v32, v32
    v_exp_f32 v33, v33
    v_mfma_f32_32x32x16_bf16 v[96:111], v[20:23], v[28:31], v[96:111]
    ds_read_b128 v[20:23], v82 offset:30272
    v_exp_f32 v34, v34
    v_exp_f32 v35, v35
    v_cvt_pk_bf16_f32 v24, v32, v33
    v_cvt_pk_bf16_f32 v25, v34, v35
    v_exp_f32 v36, v36
    v_exp_f32 v37, v37
    v_mfma_f32_32x32x8_bf16 v[48:63], v[14:15], v[88:89], 0
    ds_read_b64 v[14:15], v81 offset:43008
    v_exp_f32 v38, v38
    v_exp_f32 v39, v39
    v_cvt_pk_bf16_f32 v26, v36, v37
    v_cvt_pk_bf16_f32 v27, v38, v39
    v_exp_f32 v40, v40
    v_exp_f32 v41, v41
    v_mfma_f32_32x32x16_bf16 v[48:63], v[10:13], v[84:87], v[48:63]
    ds_read_b64 v[10:11], v80 offset:43008
    ds_read_b64 v[12:13], v80 offset:43264
    v_exp_f32 v42, v42
    v_exp_f32 v43, v43
    v_cvt_pk_bf16_f32 v28, v40, v41
    v_cvt_pk_bf16_f32 v29, v42, v43
    v_exp_f32 v44, v44
    v_exp_f32 v45, v45
    s_waitcnt lgkmcnt(4)
    v_mfma_f32_32x32x16_bf16 v[64:79], v[16:19], v[24:27], v[64:79]
    v_exp_f32 v46, v46
    v_exp_f32 v47, v47
    v_cvt_pk_bf16_f32 v30, v44, v45
    v_cvt_pk_bf16_f32 v31, v46, v47
    v_exp_f32 v48, v48
    v_exp_f32 v49, v49
    s_waitcnt lgkmcnt(0)
    v_mfma_f32_32x32x16_bf16 v[64:79], v[20:23], v[28:31], v[64:79]
    v_exp_f32 v50, v50
    v_exp_f32 v51, v51
    v_cvt_pk_bf16_f32 v24, v48, v49
    v_cvt_pk_bf16_f32 v25, v50, v51
    v_exp_f32 v52, v52
    v_exp_f32 v53, v53
    v_mfma_f32_32x32x8_bf16 v[32:47], v[14:15], v[8:9], 0
    v_exp_f32 v54, v54
    v_exp_f32 v55, v55
    v_cvt_pk_bf16_f32 v26, v52, v53
    v_cvt_pk_bf16_f32 v27, v54, v55
    v_exp_f32 v56, v56
    v_exp_f32 v57, v57
    v_mfma_f32_32x32x16_bf16 v[32:47], v[10:13], v[4:7], v[32:47]
    v_exp_f32 v58, v58
    v_exp_f32 v59, v59
    v_cvt_pk_bf16_f32 v28, v56, v57
    v_cvt_pk_bf16_f32 v29, v58, v59
    v_exp_f32 v60, v60
    v_exp_f32 v61, v61
    v_mfma_f32_32x32x16_bf16 v[96:111], v[16:19], v[24:27], v[96:111]
    ds_read_b128 v[16:19], v82 offset:43008
    v_exp_f32 v62, v62
    v_exp_f32 v63, v63
    v_cvt_pk_bf16_f32 v30, v60, v61
    v_cvt_pk_bf16_f32 v31, v62, v63
    s_waitcnt lgkmcnt(0)
    s_nop 0
    v_mfma_f32_32x32x16_bf16 v[96:111], v[20:23], v[28:31], v[96:111]
    s_setprio 3
    s_mul_i32 s30, s12, 3072
    s_add_u32 s30, s30, 64512
    v_lshlrev_b32 v2, 4, v1
    v_add_u32 v3, s30, v2
    s_xor_b32 s30, s12, 4
    s_mul_i32 s30, s30, 3072
    s_add_u32 s30, s30, 64512
    v_add_u32 v2, s30, v2
    s_nop 2
    ds_write_b128 v3, v[96:99] offset:0
    ds_write_b128 v3, v[100:103] offset:1024
    ds_write_b128 v3, v[104:107] offset:2048
    s_waitcnt lgkmcnt(0)
    s_barrier
    ds_read_b128 v[96:99], v2 offset:0
    ds_read_b128 v[100:103], v2 offset:1024
    ds_read_b128 v[104:107], v2 offset:2048
    s_waitcnt lgkmcnt(2)
    v_pk_add_f32 v[64:65], v[64:65], v[96:97]
    v_pk_add_f32 v[66:67], v[66:67], v[98:99]
    s_waitcnt lgkmcnt(1)
    v_pk_add_f32 v[68:69], v[68:69], v[100:101]
    v_pk_add_f32 v[70:71], v[70:71], v[102:103]
    s_waitcnt lgkmcnt(0)
    v_pk_add_f32 v[72:73], v[72:73], v[104:105]
    v_pk_add_f32 v[74:75], v[74:75], v[106:107]
    v_mov_b32 v90, v72
    v_mov_b32 v91, v72
    v_mul_f32 v92, 0, v64
    v_mul_f32 v93, 0, v65
    v_permlane32_swap_b32 v90, v91
    v_fmac_f32 v92, 0, v66
    v_fmac_f32 v93, 0, v67
    v_fmac_f32 v92, 0, v68
    v_fmac_f32 v93, 0, v69
    v_fmac_f32 v92, 0, v70
    v_fmac_f32 v93, 0, v71
    v_fmac_f32 v92, 0, v72
    v_fmac_f32 v93, 0, v73
    v_fmac_f32 v92, 0, v74
    v_fmac_f32 v93, 0, v75
    v_med3_f32 v90, v91, s20, v94
    v_add_f32 v92, v92, v93
    v_add_f32 v90, v90, v92
    v_cmp_neq_f32 vcc, v90, v91
    v_rcp_f32 v91, v91
    s_cbranch_vccnz L_f_slow_49
L_f_fin_48:
    s_nop 1
    v_mul_f32 v64, v64, v91
    v_mul_f32 v65, v65, v91
    v_mul_f32 v66, v66, v91
    v_mul_f32 v67, v67, v91
    v_mul_f32 v68, v68, v91
    v_mul_f32 v69, v69, v91
    v_mul_f32 v70, v70, v91
    v_mul_f32 v71, v71, v91
    v_mul_f32 v72, v72, v91
    v_mul_f32 v73, v73, v91
    v_mul_f32 v74, v74, v91
    v_mul_f32 v75, v75, v91
    v_cvt_pk_bf16_f32 v32, v64, v65
    v_cvt_pk_bf16_f32 v33, v66, v67
    v_cvt_pk_bf16_f32 v34, v68, v69
    v_cvt_pk_bf16_f32 v35, v70, v71
    v_cvt_pk_bf16_f32 v36, v72, v73
    v_cvt_pk_bf16_f32 v37, v74, v75
    v_lshlrev_b32 v2, 4, v1
    buffer_store_dwordx4 v[32:35], v2, s[8:11], s23 offen sc1
    s_mov_b64 exec, s[24:25]
    buffer_store_dwordx2 v[36:37], v95, s[8:11], s22 offen sc1
    s_mov_b64 exec, -1
    s_barrier
    v_mov_b32 v90, s13
    v_mov_b32 v91, 0
    s_waitcnt vmcnt(0)
    s_mov_b64 exec, 1
    buffer_store_dword v90, v91, s[8:11], s21 offen sc1
    s_mov_b64 exec, -1
    s_lshl_b32 s30, s12, 13
    s_add_u32 s30, s30, 89088
    v_add_u32 v3, s30, v2
    ds_read_b128 v[96:99], v3 offset:0
    ds_read_b128 v[100:103], v3 offset:1024
    ds_read_b128 v[104:107], v3 offset:2048
    ds_read_b128 v[108:111], v3 offset:3072
    ds_read_b128 v[48:51], v3 offset:4096
    ds_read_b128 v[52:55], v3 offset:5120
    ds_read_b128 v[56:59], v3 offset:6144
    ds_read_b128 v[60:63], v3 offset:7168
    v_lshlrev_b32 v166, 4, v1
    s_mul_i32 s32, s45, 20800
    s_add_u32 s32, s32, 64512
    v_add_u32 v166, s32, v166
    s_lshr_b32 s30, s12, 2
    s_mul_i32 s30, s30, 8320
    v_add_u32 v166, s30, v166
    v_and_b32 v3, 3, v1
    v_lshlrev_b32 v3, 10, v3
    s_lshl_b32 s30, s12, 12
    s_lshr_b32 s31, s41, 3
    s_lshl_b32 s31, s31, 7
    s_add_u32 s30, s30, s31
    s_and_b32 s31, s41, 7
    s_lshl_b32 s31, s31, 2
    s_add_u32 s30, s30, s31
    s_add_u32 s30, s30, 28557312
    s_mul_i32 s43, s41, 40960
    s_add_u32 s43, s43, 14942208
    s_lshl_b32 s32, s12, 12
    s_lshl_b32 s33, s12, 10
    s_add_u32 s33, s33, 32768
    s_waitcnt lgkmcnt(0)
    s_barrier
    s_mov_b32 s31, 1048576
L_f_poll_51:
    buffer_load_dword v90, v3, s[8:11], s30 offen sc1
    s_waitcnt vmcnt(0)
    v_cmp_ne_u32 vcc, s13, v90
    s_nop 0
    s_cbranch_vccz L_f_polled_52
    s_sleep 8
    s_sub_u32 s31, s31, 1
    s_cmp_lg_u32 s31, 0
    s_cbranch_scc1 L_f_poll_51
L_f_polled_52:
    s_mov_b32 m0, s32
    s_add_u32 s30, s43, s32
    buffer_load_dwordx4 v2, s[8:11], s30 offen offset:0 sc1 lds
    buffer_load_dwordx4 v2, s[8:11], s30 offen offset:1024 sc1 lds
    buffer_load_dwordx4 v2, s[8:11], s30 offen offset:2048 sc1 lds
    buffer_load_dwordx4 v2, s[8:11], s30 offen offset:3072 sc1 lds
    s_mov_b32 m0, s33
    s_add_u32 s30, s43, s33
    buffer_load_dwordx4 v2, s[8:11], s30 offen offset:0 sc1 lds
    v_lshlrev_b32 v3, 4, v1
    s_lshl_b32 s30, s45, 13
    v_add_u32 v167, s30, v3
    s_lshl_b32 s30, s45, 11
    s_add_u32 s30, s30, 32768
    v_lshrrev_b32 v3, 1, v3
    v_add_u32 v3, s30, v3
    s_setprio 0
    s_waitcnt vmcnt(0) lgkmcnt(0)
    s_barrier
    ds_read_b128 v[16:19], v166 offset:0
    ds_read_b128 v[20:23], v166 offset:1040
    ds_read_b128 v[24:27], v166 offset:2080
    ds_read_b128 v[28:31], v166 offset:3120
    ds_read_b128 v[4:7], v167 offset:0
    ds_read_b128 v[8:11], v167 offset:1024
    ds_read_b128 v[12:15], v167 offset:2048
    ds_read_b128 v[64:67], v167 offset:3072
    ds_read_b128 v[68:71], v167 offset:4096
    ds_read_b128 v[72:75], v167 offset:5120
    ds_read_b128 v[76:79], v167 offset:6144
    ds_read_b128 v[80:83], v167 offset:7168
    ds_read2_b64 v[84:87], v3 offset0:0 offset1:64
    ds_read2_b64 v[88:91], v3 offset0:128 offset1:192
    ds_read_b128 v[32:35], v166 offset:4160
    ds_read_b128 v[36:39], v166 offset:5200
    ds_read_b128 v[40:43], v166 offset:6240
    ds_read_b128 v[44:47], v166 offset:7280
    s_waitcnt lgkmcnt(13)
    v_mfma_f32_32x32x16_bf16 v[16:31], v[112:115], v[4:7], v[16:31]
    s_waitcnt lgkmcnt(12)
    v_mfma_f32_32x32x16_bf16 v[16:31], v[120:123], v[8:11], v[16:31]
    s_waitcnt lgkmcnt(11)
    v_mfma_f32_32x32x16_bf16 v[16:31], v[128:131], v[12:15], v[16:31]
    s_waitcnt lgkmcnt(10)
    v_mfma_f32_32x32x16_bf16 v[16:31], v[136:139], v[64:67], v[16:31]
    s_waitcnt lgkmcnt(9)
    v_mfma_f32_32x32x16_bf16 v[16:31], v[144:147], v[68:71], v[16:31]
    s_waitcnt lgkmcnt(8)
    v_mfma_f32_32x32x16_bf16 v[16:31], v[152:155], v[72:75], v[16:31]
    s_waitcnt lgkmcnt(7)
    v_mfma_f32_32x32x16_bf16 v[16:31], v[96:99], v[76:79], v[16:31]
    s_waitcnt lgkmcnt(6)
    v_mfma_f32_32x32x16_bf16 v[16:31], v[104:107], v[80:83], v[16:31]
    s_waitcnt lgkmcnt(5)
    v_mfma_f32_32x32x16_bf16 v[16:31], v[48:51], v[84:87], v[16:31]
    s_waitcnt lgkmcnt(4)
    v_mfma_f32_32x32x16_bf16 v[16:31], v[56:59], v[88:91], v[16:31]
    s_waitcnt lgkmcnt(0)
    v_mfma_f32_32x32x16_bf16 v[32:47], v[116:119], v[4:7], v[32:47]
    v_mfma_f32_32x32x16_bf16 v[32:47], v[124:127], v[8:11], v[32:47]
    v_mfma_f32_32x32x16_bf16 v[32:47], v[132:135], v[12:15], v[32:47]
    s_nop 7
    ds_write_b128 v166, v[16:19] offset:0
    v_mfma_f32_32x32x16_bf16 v[32:47], v[140:143], v[64:67], v[32:47]
    ds_write_b128 v166, v[20:23] offset:1040
    v_mfma_f32_32x32x16_bf16 v[32:47], v[148:151], v[68:71], v[32:47]
    ds_write_b128 v166, v[24:27] offset:2080
    v_mfma_f32_32x32x16_bf16 v[32:47], v[156:159], v[72:75], v[32:47]
    ds_write_b128 v166, v[28:31] offset:3120
    v_mfma_f32_32x32x16_bf16 v[32:47], v[100:103], v[76:79], v[32:47]
    v_mfma_f32_32x32x16_bf16 v[32:47], v[108:111], v[80:83], v[32:47]
    v_mfma_f32_32x32x16_bf16 v[32:47], v[52:55], v[84:87], v[32:47]
    v_mfma_f32_32x32x16_bf16 v[32:47], v[60:63], v[88:91], v[32:47]
    s_nop 11
    ds_write_b128 v166, v[32:35] offset:4160
    ds_write_b128 v166, v[36:39] offset:5200
    ds_write_b128 v166, v[40:43] offset:6240
    ds_write_b128 v166, v[44:47] offset:7280
    s_waitcnt lgkmcnt(0)
    s_barrier
    s_cmp_ge_u32 s12, 10
    s_cbranch_scc1 L_f_end_3
    ds_read_b128 v[96:99], v164 offset:0
    ds_read_b128 v[100:103], v164 offset:512
    ds_read_b128 v[104:107], v164 offset:20800
    ds_read_b128 v[108:111], v164 offset:21312
    ds_read_b128 v[112:115], v164 offset:41600
    ds_read_b128 v[116:119], v164 offset:42112
    ds_read_b128 v[120:123], v164 offset:62400
    ds_read_b128 v[124:127], v164 offset:62912
    s_mov_b32 s36, s54
    s_mov_b32 s37, s55
    v_lshlrev_b32 v128, 16, v160
    v_and_b32 v129, 0xffff0000, v160
    v_lshlrev_b32 v130, 16, v161
    v_and_b32 v131, 0xffff0000, v161
    v_lshlrev_b32 v132, 16, v162
    v_and_b32 v133, 0xffff0000, v162
    v_lshlrev_b32 v134, 16, v163
    v_and_b32 v135, 0xffff0000, v163
    s_waitcnt lgkmcnt(6)
    v_pk_add_f32 v[128:129], v[128:129], v[96:97]
    v_pk_add_f32 v[130:131], v[130:131], v[98:99]
    v_pk_add_f32 v[132:133], v[132:133], v[100:101]
    v_pk_add_f32 v[134:135], v[134:135], v[102:103]
    s_waitcnt lgkmcnt(4)
    v_pk_add_f32 v[128:129], v[128:129], v[104:105]
    v_pk_add_f32 v[130:131], v[130:131], v[106:107]
    v_pk_add_f32 v[132:133], v[132:133], v[108:109]
    v_pk_add_f32 v[134:135], v[134:135], v[110:111]
    s_waitcnt lgkmcnt(2)
    v_pk_add_f32 v[128:129], v[128:129], v[112:113]
    v_pk_add_f32 v[130:131], v[130:131], v[114:115]
    v_pk_add_f32 v[132:133], v[132:133], v[116:117]
    v_pk_add_f32 v[134:135], v[134:135], v[118:119]
    s_waitcnt lgkmcnt(0)
    v_pk_add_f32 v[128:129], v[128:129], v[120:121]
    v_pk_add_f32 v[130:131], v[130:131], v[122:123]
    v_pk_add_f32 v[132:133], v[132:133], v[124:125]
    v_pk_add_f32 v[134:135], v[134:135], v[126:127]
    v_cvt_pk_bf16_f32 v96, v128, v129
    v_cvt_pk_bf16_f32 v97, v130, v131
    v_cvt_pk_bf16_f32 v98, v132, v133
    v_cvt_pk_bf16_f32 v99, v134, v135
    buffer_store_dwordx4 v[96:99], v165, s[36:39], s17 offen sc1
    s_branch L_f_end_3
L_f_slow_49:
    s_mul_i32 s31, s14, 1280
    s_add_u32 s31, s31, 2621440
    s_mul_i32 s32, s14, 320
    s_add_u32 s32, s32, 5242880
    v_and_b32 v2, 31, v1
    v_lshrrev_b32 v3, 5, v1
    v_and_b32 v81, 7, v1
    v_bfe_u32 v80, v1, 3, 1
    v_lshl_add_u32 v81, v80, 4, v81
    v_bfe_u32 v80, v1, 4, 1
    v_lshl_add_u32 v81, v80, 3, v81
    v_lshlrev_b32 v81, 3, v81
    v_lshl_add_u32 v80, v3, 9, v81
    v_mul_u32_u24 v3, 10240, v3
    v_lshl_add_u32 v82, v2, 4, v3
    v_add_u32 v83, 20480, v82
    v_mov_b32 v92, 0xff800000
    s_mov_b32 s16, 0
    v_mov_b32 v64, 0
    v_mov_b32 v65, 0
    v_mov_b32 v66, 0
    v_mov_b32 v67, 0
    v_mov_b32 v68, 0
    v_mov_b32 v69, 0
    v_mov_b32 v70, 0
    v_mov_b32 v71, 0
    v_mov_b32 v72, 0
    v_mov_b32 v73, 0
    v_mov_b32 v74, 0
    v_mov_b32 v75, 0
    v_mov_b32 v76, 0
    v_mov_b32 v77, 0
    v_mov_b32 v78, 0
    v_mov_b32 v79, 0
    v_mov_b32 v16, 0x3f803f80
    v_mov_b32 v17, 0x3f803f80
    v_mov_b32 v18, 0x3f803f80
    v_mov_b32 v19, 0x3f803f80
    v_mov_b32 v20, 0x3f803f80
    v_mov_b32 v21, 0x3f803f80
    v_mov_b32 v22, 0x3f803f80
    v_mov_b32 v23, 0x3f803f80
L_f_slowloop_53:
    buffer_load_dwordx2 v[10:11], v80, s[8:11], s31 offen sc1
    buffer_load_dwordx2 v[12:13], v80, s[8:11], s31 offen offset:256 sc1
    buffer_load_dwordx2 v[14:15], v81, s[8:11], s31 offen offset:1024 sc1
    s_mov_b64 exec, s[28:29]
    buffer_load_dwordx4 v[16:19], v82, s[8:11], s32 offen sc1
    buffer_load_dwordx4 v[20:23], v83, s[8:11], s32 offen sc1
    s_mov_b64 exec, -1
    s_waitcnt vmcnt(0)
    v_mfma_f32_32x32x8_bf16 v[32:47], v[14:15], v[8:9], 0
    v_mfma_f32_32x32x16_bf16 v[32:47], v[10:13], v[4:7], v[32:47]
    s_nop 11
    v_max3_f32 v90, v32, v33, v92
    v_max3_f32 v90, v34, v35, v90
    v_max3_f32 v90, v36, v37, v90
    v_max3_f32 v90, v38, v39, v90
    v_max3_f32 v90, v40, v41, v90
    v_max3_f32 v90, v42, v43, v90
    v_max3_f32 v90, v44, v45, v90
    v_max3_f32 v90, v46, v47, v90
    v_mov_b32 v91, v90
    s_nop 1
    v_permlane32_swap_b32 v90, v91
    v_max_f32 v90, v90, v91
    v_sub_f32 v93, v92, v90
    v_exp_f32 v93, v93
    v_mov_b32 v92, v90
    v_mul_f32 v64, v64, v93
    v_mul_f32 v65, v65, v93
    v_mul_f32 v66, v66, v93
    v_mul_f32 v67, v67, v93
    v_mul_f32 v68, v68, v93
    v_mul_f32 v69, v69, v93
    v_mul_f32 v70, v70, v93
    v_mul_f32 v71, v71, v93
    v_mul_f32 v72, v72, v93
    v_mul_f32 v73, v73, v93
    v_mul_f32 v74, v74, v93
    v_mul_f32 v75, v75, v93
    v_mul_f32 v76, v76, v93
    v_mul_f32 v77, v77, v93
    v_mul_f32 v78, v78, v93
    v_mul_f32 v79, v79, v93
    v_sub_f32 v32, v32, v92
    v_sub_f32 v33, v33, v92
    v_sub_f32 v34, v34, v92
    v_sub_f32 v35, v35, v92
    v_sub_f32 v36, v36, v92
    v_sub_f32 v37, v37, v92
    v_sub_f32 v38, v38, v92
    v_sub_f32 v39, v39, v92
    v_sub_f32 v40, v40, v92
    v_sub_f32 v41, v41, v92
    v_sub_f32 v42, v42, v92
    v_sub_f32 v43, v43, v92
    v_sub_f32 v44, v44, v92
    v_sub_f32 v45, v45, v92
    v_sub_f32 v46, v46, v92
    v_sub_f32 v47, v47, v92
    v_exp_f32 v32, v32
    v_exp_f32 v33, v33
    v_exp_f32 v34, v34
    v_exp_f32 v35, v35
    v_exp_f32 v36, v36
    v_exp_f32 v37, v37
    v_exp_f32 v38, v38
    v_exp_f32 v39, v39
    v_exp_f32 v40, v40
    v_exp_f32 v41, v41
    v_exp_f32 v42, v42
    v_exp_f32 v43, v43
    v_exp_f32 v44, v44
    v_exp_f32 v45, v45
    v_exp_f32 v46, v46
    v_exp_f32 v47, v47
    v_cvt_pk_bf16_f32 v24, v32, v33
    v_cvt_pk_bf16_f32 v25, v34, v35
    v_cvt_pk_bf16_f32 v26, v36, v37
    v_cvt_pk_bf16_f32 v27, v38, v39
    v_cvt_pk_bf16_f32 v28, v40, v41
    v_cvt_pk_bf16_f32 v29, v42, v43
    v_cvt_pk_bf16_f32 v30, v44, v45
    v_cvt_pk_bf16_f32 v31, v46, v47
    v_mfma_f32_32x32x16_bf16 v[64:79], v[16:19], v[24:27], v[64:79]
    s_nop 0
    v_mfma_f32_32x32x16_bf16 v[64:79], v[20:23], v[28:31], v[64:79]
    s_add_u32 s31, s31, 40960
    s_add_u32 s32, s32, 40960
    s_add_u32 s16, s16, 1
    s_cmp_lt_u32 s16, 64
    s_cbranch_scc1 L_f_slowloop_53
    s_nop 6
    v_mov_b32 v90, v72
    v_mov_b32 v91, v72
    s_nop 1
    v_permlane32_swap_b32 v90, v91
    v_rcp_f32 v91, v91
    s_branch L_f_fin_48
L_f_ffn_46:
    s_and_b32 s3, s2, 7
    s_lshr_b32 s6, s2, 3
    s_lshr_b32 s7, s6, 3
    s_lshl_b32 s14, s3, 2
    s_add_u32 s14, s14, s7
    s_and_b32 s46, s6, 7
    s_and_b32 s15, s12, 3
    s_lshl_b32 s15, s15, 1
    s_bfe_u32 s7, s12, 0x10002
    s_add_u32 s15, s15, s7
    s_lshl_b32 s7, s46, 3
    s_add_u32 s15, s15, s7
    s_and_b32 s42, s6, 3
    s_lshr_b32 s6, s6, 2
    s_lshl_b32 s3, s3, 3
    s_add_u32 s41, s3, s6
    s_and_b32 s45, s12, 3
    s_mul_i32 s30, s14, 20
    s_add_u32 s31, s30, 19
    s_lshr_b32 s30, s30, 6
    s_lshr_b32 s31, s31, 6
    s_sub_u32 s31, s31, s30
    v_lshrrev_b32 v3, 5, v1
    v_mul_u32_u24 v2, s31, v3
    v_add_u32 v2, s30, v2
    v_and_b32 v4, 1, v2
    v_lshrrev_b32 v2, 1, v2
    v_lshlrev_b32 v2, 11, v2
    v_lshl_add_u32 v2, v4, 3, v2
    s_setprio 0
    s_mov_b32 s20, 0xffffffff
    s_mov_b32 s21, 0xf3ffffcf
    s_mov_b32 s22, 0xfffcffff
    s_mov_b32 s23, 0x3f
    v_and_b32 v8, 1, v1
    v_lshl_add_u32 v12, v8, 2, v2
    v_bfe_u32 v13, v1, 1, 4
    v_lshl_add_u32 v12, v13, 7, v12
    v_and_b32 v13, 3, v1
    v_min_u32 v13, 2, v13
    v_mul_u32_u24 v13, 10240, v13
    v_add_u32 v13, v13, v2
    v_and_b32 v14, 1, v1
    v_mul_u32_u24 v14, 10240, v14
    v_add_u32 v14, v14, v2
    s_mov_b32 s40, s45
    s_mul_i32 s30, s40, 81920
    s_mul_i32 s31, s14, 1280
    s_add_u32 s31, s31, s30
    s_add_u32 s31, s31, 2621440
    s_mul_i32 s32, s14, 320
    s_add_u32 s32, s32, s30
    s_add_u32 s32, s32, 5242880
    v_lshlrev_b32 v2, 4, v1
    v_add_u32 v3, 4096, v2
    v_add_u32 v4, s31, v2
    v_add_u32 v8, 4294967280, v1
    v_max_i32 v8, 0, v8
    v_mul_u32_u24 v9, 2979, v8
    v_lshrrev_b32 v9, 16, v9
    v_mul_u32_u24 v10, 22, v9
    v_sub_u32 v10, v8, v10
    v_mul_u32_u24 v9, 10240, v9
    v_lshl_add_u32 v9, v10, 4, v9
    v_add_u32 v9, s32, v9
    v_add_u32 v5, 4294966272, v9
    v_add_u32 v8, 48, v1
    v_max_i32 v8, 0, v8
    v_mul_u32_u24 v9, 2979, v8
    v_lshrrev_b32 v9, 16, v9
    v_mul_u32_u24 v10, 22, v9
    v_sub_u32 v10, v8, v10
    v_mul_u32_u24 v9, 10240, v9
    v_lshl_add_u32 v9, v10, 4, v9
    v_add_u32 v9, s32, v9
    v_add_u32 v6, 4294965248, v9
    s_mov_b64 exec, 0xffff
    v_mov_b32 v5, v4
    s_mov_b64 exec, -1
    s_mul_i32 s18, s40, 5376
    s_lshl_b32 s30, s46, 2
    s_add_u32 s30, s30, s40
    s_add_u32 s31, s30, 4
    s_and_b32 s31, s31, 31
    s_and_b32 s32, s30, 1
    s_lshl_b32 s32, s32, 2
    s_lshr_b32 s30, s30, 1
    s_lshl_b32 s30, s30, 7
    s_add_u32 s30, s30, s32
    s_and_b32 s32, s31, 1
    s_lshl_b32 s32, s32, 2
    s_lshr_b32 s31, s31, 1
    s_lshl_b32 s31, s31, 7
    s_add_u32 s31, s31, s32
    s_add_u32 s43, s30, 28491776
    s_add_u32 s44, s31, 28502016
    s_lshl_b32 s30, s46, 2
    s_add_u32 s30, s30, s40
    s_mul_i32 s30, s30, 81920
    s_mul_i32 s31, s14, 1280
    s_add_u32 s30, s30, s31
    s_add_u32 s19, s30, 0
    s_mul_i32 s16, s40, 2560
    s_add_u32 s16, s16, 89088
    v_add_u32 v15, 39680, v2
    v_mov_b32 v7, v15
    s_mov_b64 exec, 0xffff
    v_mov_b32 v7, v2
    s_mov_b64 exec, -1
    v_mov_b32 v8, 163832
    s_setprio 3
    s_barrier
    s_barrier
    ds_read_b32 v8, v8
    s_waitcnt lgkmcnt(0)
    v_readfirstlane_b32 s13, v8
    s_mov_b32 s33, 1048576
L_f_poll_54:
    buffer_load_dword v8, v13, s[8:11], s43 offen sc1
    s_waitcnt vmcnt(0)
    v_cmp_ne_u32 vcc, s13, v8
    s_nop 0
    s_cbranch_vccz L_f_polled_55
    s_sleep 8
    s_sub_u32 s33, s33, 1
    s_cmp_lg_u32 s33, 0
    s_cbranch_scc1 L_f_poll_54
L_f_polled_55:
    s_mov_b32 m0, s16
    s_nop 0
    buffer_load_dwordx4 v2, s[8:11], s19 offen sc1 lds
    buffer_load_dwordx4 v7, s[8:11], s19 offen offset:1024 sc1 lds
    s_mov_b32 exec_hi, 0
    buffer_load_dwordx4 v15, s[8:11], s19 offen offset:2048 sc1 lds
    s_mov_b64 exec, -1
    s_add_u32 m0, s18, 0
    s_add_u32 s17, s46, 0
    s_and_b32 s17, s17, 7
    s_mul_i32 s17, s17, 327680
    s_add_u32 s17, s17, 0
    buffer_load_dwordx4 v4, s[8:11], s17 offen sc1 lds
    s_mov_b64 exec, s[20:21]
    buffer_load_dwordx4 v5, s[8:11], s17 offen offset:1024 sc1 lds
    s_mov_b64 exec, s[22:23]
    buffer_load_dwordx4 v6, s[8:11], s17 offen offset:2048 sc1 lds
    s_mov_b64 exec, -1
    s_add_u32 m0, s18, 2688
    s_add_u32 s17, s46, 0
    s_and_b32 s17, s17, 7
    s_mul_i32 s17, s17, 327680
    s_add_u32 s17, s17, 40960
    buffer_load_dwordx4 v4, s[8:11], s17 offen sc1 lds
    s_mov_b64 exec, s[20:21]
    buffer_load_dwordx4 v5, s[8:11], s17 offen offset:1024 sc1 lds
    s_mov_b64 exec, s[22:23]
    buffer_load_dwordx4 v6, s[8:11], s17 offen offset:2048 sc1 lds
    s_mov_b64 exec, -1
    s_waitcnt vmcnt(0)
    s_barrier
    s_mov_b32 s33, 1048576
L_f_poll_56:
    buffer_load_dword v8, v14, s[8:11], s44 offen sc1
    s_waitcnt vmcnt(0)
    v_cmp_ne_u32 vcc, s13, v8
    s_nop 0
    s_cbranch_vccz L_f_polled_57
    s_sleep 8
    s_sub_u32 s33, s33, 1
    s_cmp_lg_u32 s33, 0
    s_cbranch_scc1 L_f_poll_56
L_f_polled_57:
    s_add_u32 m0, s18, 21504
    s_add_u32 s17, s46, 1
    s_and_b32 s17, s17, 7
    s_mul_i32 s17, s17, 327680
    s_add_u32 s17, s17, 0
    buffer_load_dwordx4 v4, s[8:11], s17 offen sc1 lds
    s_mov_b64 exec, s[20:21]
    buffer_load_dwordx4 v5, s[8:11], s17 offen offset:1024 sc1 lds
    s_mov_b64 exec, s[22:23]
    buffer_load_dwordx4 v6, s[8:11], s17 offen offset:2048 sc1 lds
    s_mov_b64 exec, -1
    s_add_u32 m0, s18, 24192
    s_add_u32 s17, s46, 1
    s_and_b32 s17, s17, 7
    s_mul_i32 s17, s17, 327680
    s_add_u32 s17, s17, 40960
    buffer_load_dwordx4 v4, s[8:11], s17 offen sc1 lds
    s_mov_b64 exec, s[20:21]
    buffer_load_dwordx4 v5, s[8:11], s17 offen offset:1024 sc1 lds
    s_mov_b64 exec, s[22:23]
    buffer_load_dwordx4 v6, s[8:11], s17 offen offset:2048 sc1 lds
    s_mov_b64 exec, -1
    s_setprio 0
    s_mul_i32 s30, s40, 27
    s_mul_i32 s43, s41, 110592
    s_lshl_b32 s31, s30, 10
    s_add_u32 s43, s43, s31
    s_add_u32 s43, s43, 7864320
    s_mul_i32 s44, s30, 20480
    s_mul_i32 s31, s42, 5120
    s_add_u32 s44, s44, s31
    s_add_u32 s44, s44, 22806528
    s_cmp_lg_u32 s40, 0
    s_cbranch_scc1 L_f_nobump_58
    s_mov_b32 s30, 28502016
    s_mov_b32 s31, 28512256
    s_mov_b32 s33, 1048576
L_f_poll_59:
    buffer_load_dword v8, v12, s[8:11], s30 offen sc1
    buffer_load_dword v9, v12, s[8:11], s31 offen sc1
    s_waitcnt vmcnt(0)
    v_xor_b32 v8, s13, v8
    v_xor_b32 v9, s13, v9
    v_or_b32 v8, v8, v9
    v_cmp_ne_u32 vcc, 0, v8
    s_nop 0
    s_cbranch_vccz L_f_polled_60
    s_sleep 8
    s_sub_u32 s33, s33, 1
    s_cmp_lg_u32 s33, 0
    s_cbranch_scc1 L_f_poll_59
L_f_polled_60:
    s_cmp_lg_u32 s2, 0
    s_cbranch_scc1 L_f_nobump_58
    s_mov_b32 s30, 28590080
    v_mov_b32 v8, s13
    v_mov_b32 v9, 0
    s_waitcnt vmcnt(0)
    s_mov_b64 exec, 1
    buffer_store_dword v8, v9, s[8:11], s30 offen sc1
    s_mov_b64 exec, -1
    s_waitcnt vmcnt(0)
L_f_nobump_58:
    s_waitcnt vmcnt(0)
    s_barrier
    s_add_u32 m0, s18, 43008
    s_add_u32 s17, s46, 2
    s_and_b32 s17, s17, 7
    s_mul_i32 s17, s17, 327680
    s_add_u32 s17, s17, 0
    buffer_load_dwordx4 v4, s[8:11], s17 offen sc1 lds
    s_mov_b64 exec, s[20:21]
    buffer_load_dwordx4 v5, s[8:11], s17 offen offset:1024 sc1 lds
    s_mov_b64 exec, s[22:23]
    buffer_load_dwordx4 v6, s[8:11], s17 offen offset:2048 sc1 lds
    s_mov_b64 exec, -1
    s_add_u32 m0, s18, 45696
    s_add_u32 s17, s46, 2
    s_and_b32 s17, s17, 7
    s_mul_i32 s17, s17, 327680
    s_add_u32 s17, s17, 40960
    buffer_load_dwordx4 v4, s[8:11], s17 offen sc1 lds
    s_mov_b64 exec, s[20:21]
    buffer_load_dwordx4 v5, s[8:11], s17 offen offset:1024 sc1 lds
    s_mov_b64 exec, s[22:23]
    buffer_load_dwordx4 v6, s[8:11], s17 offen offset:2048 sc1 lds
    s_mov_b64 exec, -1
    s_waitcnt vmcnt(0)
    s_barrier
    s_add_u32 m0, s18, 0
    s_add_u32 s17, s46, 3
    s_and_b32 s17, s17, 7
    s_mul_i32 s17, s17, 327680
    s_add_u32 s17, s17, 0
    buffer_load_dwordx4 v4, s[8:11], s17 offen sc1 lds
    s_mov_b64 exec, s[20:21]
    buffer_load_dwordx4 v5, s[8:11], s17 offen offset:1024 sc1 lds
    s_mov_b64 exec, s[22:23]
    buffer_load_dwordx4 v6, s[8:11], s17 offen offset:2048 sc1 lds
    s_mov_b64 exec, -1
    s_add_u32 m0, s18, 2688
    s_add_u32 s17, s46, 3
    s_and_b32 s17, s17, 7
    s_mul_i32 s17, s17, 327680
    s_add_u32 s17, s17, 40960
    buffer_load_dwordx4 v4, s[8:11], s17 offen sc1 lds
    s_mov_b64 exec, s[20:21]
    buffer_load_dwordx4 v5, s[8:11], s17 offen offset:1024 sc1 lds
    s_mov_b64 exec, s[22:23]
    buffer_load_dwordx4 v6, s[8:11], s17 offen offset:2048 sc1 lds
    s_mov_b64 exec, -1
    s_setprio 3
    v_min_u32 v12, 26, v1
    v_and_b32 v13, 1, v12
    v_lshrrev_b32 v12, 1, v12
    v_lshlrev_b32 v12, 11, v12
    v_lshl_add_u32 v12, v13, 3, v12
    s_lshr_b32 s30, s41, 2
    s_lshl_b32 s30, s30, 7
    s_bfe_u32 s31, s41, 0x10001
    s_lshl_b32 s31, s31, 2
    s_add_u32 s30, s30, s31
    s_add_u32 s30, s30, 28491792
    v_and_b32 v13, 7, v1
    v_lshlrev_b32 v13, 2, v13
    v_lshrrev_b32 v14, 3, v1
    v_lshl_add_u32 v13, v14, 7, v13
    s_mov_b32 s31, 28524544
    s_mov_b32 s32, 28525568
    s_mov_b32 s33, 1048576
L_f_poll_61:
    buffer_load_dword v8, v12, s[8:11], s30 offen sc1
    buffer_load_dword v9, v13, s[8:11], s31 offen sc1
    buffer_load_dword v10, v13, s[8:11], s32 offen sc1
    s_waitcnt vmcnt(0)
    v_xor_b32 v8, s13, v8
    v_xor_b32 v9, s13, v9
    v_xor_b32 v10, s13, v10
    v_or_b32 v8, v8, v9
    v_or_b32 v8, v8, v10
    v_cmp_ne_u32 vcc, 0, v8
    s_nop 0
    s_cbranch_vccz L_f_polled_62
    s_sleep 8
    s_sub_u32 s33, s33, 1
    s_cmp_lg_u32 s33, 0
    s_cbranch_scc1 L_f_poll_61
L_f_polled_62:
    s_setprio 0
    buffer_load_dwordx4 v[96:99], v2, s[8:11], s43 offen sc1
    buffer_load_dwordx4 v[100:103], v2, s[8:11], s44 offen offset:0 sc1
    buffer_load_dwordx4 v[104:107], v2, s[8:11], s44 offen offset:1024 sc1
    buffer_load_dwordx4 v[108:111], v2, s[8:11], s44 offen offset:2048 sc1
    buffer_load_dwordx4 v[112:115], v2, s[8:11], s44 offen offset:3072 sc1
    buffer_load_dwordx4 v[116:119], v3, s[8:11], s44 offen sc1
    s_add_u32 s43, s43, 1024
    s_add_u32 s44, s44, 20480
    buffer_load_dwordx4 v[120:123], v2, s[8:11], s43 offen sc1
    buffer_load_dwordx4 v[124:127], v2, s[8:11], s44 offen offset:0 sc1
    buffer_load_dwordx4 v[128:131], v2, s[8:11], s44 offen offset:1024 sc1
    buffer_load_dwordx4 v[132:135], v2, s[8:11], s44 offen offset:2048 sc1
    buffer_load_dwordx4 v[136:139], v2, s[8:11], s44 offen offset:3072 sc1
    buffer_load_dwordx4 v[140:143], v3, s[8:11], s44 offen sc1
    s_add_u32 s43, s43, 1024
    s_add_u32 s44, s44, 20480
    buffer_load_dwordx4 v[144:147], v2, s[8:11], s43 offen sc1
    buffer_load_dwordx4 v[148:151], v2, s[8:11], s44 offen offset:0 sc1
    buffer_load_dwordx4 v[152:155], v2, s[8:11], s44 offen offset:1024 sc1
    buffer_load_dwordx4 v[156:159], v2, s[8:11], s44 offen offset:2048 sc1
    buffer_load_dwordx4 v[160:163], v2, s[8:11], s44 offen offset:3072 sc1
    buffer_load_dwordx4 v[164:167], v3, s[8:11], s44 offen sc1
    s_add_u32 s43, s43, 1024
    s_add_u32 s44, s44, 20480
    s_waitcnt vmcnt(12)
    v_mfma_f32_32x32x16_bf16 v[16:31], v[100:103], v[96:99], 0
    buffer_load_dwordx4 v[100:103], v2, s[8:11], s44 offen offset:0 sc1
    v_mfma_f32_32x32x16_bf16 v[32:47], v[104:107], v[96:99], 0
    buffer_load_dwordx4 v[104:107], v2, s[8:11], s44 offen offset:1024 sc1
    v_mfma_f32_32x32x16_bf16 v[48:63], v[108:111], v[96:99], 0
    buffer_load_dwordx4 v[108:111], v2, s[8:11], s44 offen offset:2048 sc1
    v_mfma_f32_32x32x16_bf16 v[64:79], v[112:115], v[96:99], 0
    buffer_load_dwordx4 v[112:115], v2, s[8:11], s44 offen offset:3072 sc1
    v_mfma_f32_32x32x16_bf16 v[80:95], v[116:119], v[96:99], 0
    buffer_load_dwordx4 v[116:119], v3, s[8:11], s44 offen sc1
    buffer_load_dwordx4 v[96:99], v2, s[8:11], s43 offen sc1
    s_add_u32 s43, s43, 1024
    s_add_u32 s44, s44, 20480
    s_waitcnt vmcnt(12)
    v_mfma_f32_32x32x16_bf16 v[16:31], v[124:127], v[120:123], v[16:31]
    buffer_load_dwordx4 v[124:127], v2, s[8:11], s44 offen offset:0 sc1
    v_mfma_f32_32x32x16_bf16 v[32:47], v[128:131], v[120:123], v[32:47]
    buffer_load_dwordx4 v[128:131], v2, s[8:11], s44 offen offset:1024 sc1
    v_mfma_f32_32x32x16_bf16 v[48:63], v[132:135], v[120:123], v[48:63]
    buffer_load_dwordx4 v[132:135], v2, s[8:11], s44 offen offset:2048 sc1
    v_mfma_f32_32x32x16_bf16 v[64:79], v[136:139], v[120:123], v[64:79]
    buffer_load_dwordx4 v[136:139], v2, s[8:11], s44 offen offset:3072 sc1
    v_mfma_f32_32x32x16_bf16 v[80:95], v[140:143], v[120:123], v[80:95]
    buffer_load_dwordx4 v[140:143], v3, s[8:11], s44 offen sc1
    buffer_load_dwordx4 v[120:123], v2, s[8:11], s43 offen sc1
    s_add_u32 s43, s43, 1024
    s_add_u32 s44, s44, 20480
    s_barrier
    s_add_u32 m0, s18, 21504
    s_add_u32 s17, s46, 4
    s_and_b32 s17, s17, 7
    s_mul_i32 s17, s17, 327680
    s_add_u32 s17, s17, 0
    buffer_load_dwordx4 v4, s[8:11], s17 offen sc1 lds
    s_mov_b64 exec, s[20:21]
    buffer_load_dwordx4 v5, s[8:11], s17 offen offset:1024 sc1 lds
    s_mov_b64 exec, s[22:23]
    buffer_load_dwordx4 v6, s[8:11], s17 offen offset:2048 sc1 lds
    s_mov_b64 exec, -1
    s_add_u32 m0, s18, 24192
    s_add_u32 s17, s46, 4
    s_and_b32 s17, s17, 7
    s_mul_i32 s17, s17, 327680
    s_add_u32 s17, s17, 40960
    buffer_load_dwordx4 v4, s[8:11], s17 offen sc1 lds
    s_mov_b64 exec, s[20:21]
    buffer_load_dwordx4 v5, s[8:11], s17 offen offset:1024 sc1 lds
    s_mov_b64 exec, s[22:23]
    buffer_load_dwordx4 v6, s[8:11], s17 offen offset:2048 sc1 lds
    s_mov_b64 exec, -1
    s_waitcnt vmcnt(18)
    v_mfma_f32_32x32x16_bf16 v[16:31], v[148:151], v[144:147], v[16:31]
    buffer_load_dwordx4 v[148:151], v2, s[8:11], s44 offen offset:0 sc1
    v_mfma_f32_32x32x16_bf16 v[32:47], v[152:155], v[144:147], v[32:47]
    buffer_load_dwordx4 v[152:155], v2, s[8:11], s44 offen offset:1024 sc1
    v_mfma_f32_32x32x16_bf16 v[48:63], v[156:159], v[144:147], v[48:63]
    buffer_load_dwordx4 v[156:159], v2, s[8:11], s44 offen offset:2048 sc1
    v_mfma_f32_32x32x16_bf16 v[64:79], v[160:163], v[144:147], v[64:79]
    buffer_load_dwordx4 v[160:163], v2, s[8:11], s44 offen offset:3072 sc1
    v_mfma_f32_32x32x16_bf16 v[80:95], v[164:167], v[144:147], v[80:95]
    buffer_load_dwordx4 v[164:167], v3, s[8:11], s44 offen sc1
    buffer_load_dwordx4 v[144:147], v2, s[8:11], s43 offen sc1
    s_add_u32 s43, s43, 1024
    s_add_u32 s44, s44, 20480
    s_waitcnt vmcnt(18)
    v_mfma_f32_32x32x16_bf16 v[16:31], v[100:103], v[96:99], v[16:31]
    buffer_load_dwordx4 v[100:103], v2, s[8:11], s44 offen offset:0 sc1
    v_mfma_f32_32x32x16_bf16 v[32:47], v[104:107], v[96:99], v[32:47]
    buffer_load_dwordx4 v[104:107], v2, s[8:11], s44 offen offset:1024 sc1
    v_mfma_f32_32x32x16_bf16 v[48:63], v[108:111], v[96:99], v[48:63]
    buffer_load_dwordx4 v[108:111], v2, s[8:11], s44 offen offset:2048 sc1
    v_mfma_f32_32x32x16_bf16 v[64:79], v[112:115], v[96:99], v[64:79]
    buffer_load_dwordx4 v[112:115], v2, s[8:11], s44 offen offset:3072 sc1
    v_mfma_f32_32x32x16_bf16 v[80:95], v[116:119], v[96:99], v[80:95]
    buffer_load_dwordx4 v[116:119], v3, s[8:11], s44 offen sc1
    buffer_load_dwordx4 v[96:99], v2, s[8:11], s43 offen sc1
    s_add_u32 s43, s43, 1024
    s_add_u32 s44, s44, 20480
    s_waitcnt vmcnt(18)
    v_mfma_f32_32x32x16_bf16 v[16:31], v[124:127], v[120:123], v[16:31]
    buffer_load_dwordx4 v[124:127], v2, s[8:11], s44 offen offset:0 sc1
    v_mfma_f32_32x32x16_bf16 v[32:47], v[128:131], v[120:123], v[32:47]
    buffer_load_dwordx4 v[128:131], v2, s[8:11], s44 offen offset:1024 sc1
    v_mfma_f32_32x32x16_bf16 v[48:63], v[132:135], v[120:123], v[48:63]
    buffer_load_dwordx4 v[132:135], v2, s[8:11], s44 offen offset:2048 sc1
    v_mfma_f32_32x32x16_bf16 v[64:79], v[136:139], v[120:123], v[64:79]
    buffer_load_dwordx4 v[136:139], v2, s[8:11], s44 offen offset:3072 sc1
    v_mfma_f32_32x32x16_bf16 v[80:95], v[140:143], v[120:123], v[80:95]
    buffer_load_dwordx4 v[140:143], v3, s[8:11], s44 offen sc1
    buffer_load_dwordx4 v[120:123], v2, s[8:11], s43 offen sc1
    s_add_u32 s43, s43, 1024
    s_add_u32 s44, s44, 20480
    s_waitcnt vmcnt(12)
    v_mfma_f32_32x32x16_bf16 v[16:31], v[148:151], v[144:147], v[16:31]
    buffer_load_dwordx4 v[148:151], v2, s[8:11], s44 offen offset:0 sc1
    v_mfma_f32_32x32x16_bf16 v[32:47], v[152:155], v[144:147], v[32:47]
    buffer_load_dwordx4 v[152:155], v2, s[8:11], s44 offen offset:1024 sc1
    v_mfma_f32_32x32x16_bf16 v[48:63], v[156:159], v[144:147], v[48:63]
    buffer_load_dwordx4 v[156:159], v2, s[8:11], s44 offen offset:2048 sc1
    v_mfma_f32_32x32x16_bf16 v[64:79], v[160:163], v[144:147], v[64:79]
    buffer_load_dwordx4 v[160:163], v2, s[8:11], s44 offen offset:3072 sc1
    v_mfma_f32_32x32x16_bf16 v[80:95], v[164:167], v[144:147], v[80:95]
    buffer_load_dwordx4 v[164:167], v3, s[8:11], s44 offen sc1
    buffer_load_dwordx4 v[144:147], v2, s[8:11], s43 offen sc1
    s_add_u32 s43, s43, 1024
    s_add_u32 s44, s44, 20480
    s_barrier
    s_add_u32 m0, s18, 43008
    s_add_u32 s17, s46, 5
    s_and_b32 s17, s17, 7
    s_mul_i32 s17, s17, 327680
    s_add_u32 s17, s17, 0
    buffer_load_dwordx4 v4, s[8:11], s17 offen sc1 lds
    s_mov_b64 exec, s[20:21]
    buffer_load_dwordx4 v5, s[8:11], s17 offen offset:1024 sc1 lds
    s_mov_b64 exec, s[22:23]
    buffer_load_dwordx4 v6, s[8:11], s17 offen offset:2048 sc1 lds
    s_mov_b64 exec, -1
    s_add_u32 m0, s18, 45696
    s_add_u32 s17, s46, 5
    s_and_b32 s17, s17, 7
    s_mul_i32 s17, s17, 327680
    s_add_u32 s17, s17, 40960
    buffer_load_dwordx4 v4, s[8:11], s17 offen sc1 lds
    s_mov_b64 exec, s[20:21]
    buffer_load_dwordx4 v5, s[8:11], s17 offen offset:1024 sc1 lds
    s_mov_b64 exec, s[22:23]
    buffer_load_dwordx4 v6, s[8:11], s17 offen offset:2048 sc1 lds
    s_mov_b64 exec, -1
    s_waitcnt vmcnt(18)
    v_mfma_f32_32x32x16_bf16 v[16:31], v[100:103], v[96:99], v[16:31]
    buffer_load_dwordx4 v[100:103], v2, s[8:11], s44 offen offset:0 sc1
    v_mfma_f32_32x32x16_bf16 v[32:47], v[104:107], v[96:99], v[32:47]
    buffer_load_dwordx4 v[104:107], v2, s[8:11], s44 offen offset:1024 sc1
    v_mfma_f32_32x32x16_bf16 v[48:63], v[108:111], v[96:99], v[48:63]
    buffer_load_dwordx4 v[108:111], v2, s[8:11], s44 offen offset:2048 sc1
    v_mfma_f32_32x32x16_bf16 v[64:79], v[112:115], v[96:99], v[64:79]
    buffer_load_dwordx4 v[112:115], v2, s[8:11], s44 offen offset:3072 sc1
    v_mfma_f32_32x32x16_bf16 v[80:95], v[116:119], v[96:99], v[80:95]
    buffer_load_dwordx4 v[116:119], v3, s[8:11], s44 offen sc1
    buffer_load_dwordx4 v[96:99], v2, s[8:11], s43 offen sc1
    s_add_u32 s43, s43, 1024
    s_add_u32 s44, s44, 20480
    s_waitcnt vmcnt(18)
    v_mfma_f32_32x32x16_bf16 v[16:31], v[124:127], v[120:123], v[16:31]
    buffer_load_dwordx4 v[124:127], v2, s[8:11], s44 offen offset:0 sc1
    v_mfma_f32_32x32x16_bf16 v[32:47], v[128:131], v[120:123], v[32:47]
    buffer_load_dwordx4 v[128:131], v2, s[8:11], s44 offen offset:1024 sc1
    v_mfma_f32_32x32x16_bf16 v[48:63], v[132:135], v[120:123], v[48:63]
    buffer_load_dwordx4 v[132:135], v2, s[8:11], s44 offen offset:2048 sc1
    v_mfma_f32_32x32x16_bf16 v[64:79], v[136:139], v[120:123], v[64:79]
    buffer_load_dwordx4 v[136:139], v2, s[8:11], s44 offen offset:3072 sc1
    v_mfma_f32_32x32x16_bf16 v[80:95], v[140:143], v[120:123], v[80:95]
    buffer_load_dwordx4 v[140:143], v3, s[8:11], s44 offen sc1
    buffer_load_dwordx4 v[120:123], v2, s[8:11], s43 offen sc1
    s_add_u32 s43, s43, 1024
    s_add_u32 s44, s44, 20480
    s_waitcnt vmcnt(18)
    v_mfma_f32_32x32x16_bf16 v[16:31], v[148:151], v[144:147], v[16:31]
    buffer_load_dwordx4 v[148:151], v2, s[8:11], s44 offen offset:0 sc1
    v_mfma_f32_32x32x16_bf16 v[32:47], v[152:155], v[144:147], v[32:47]
    buffer_load_dwordx4 v[152:155], v2, s[8:11], s44 offen offset:1024 sc1
    v_mfma_f32_32x32x16_bf16 v[48:63], v[156:159], v[144:147], v[48:63]
    buffer_load_dwordx4 v[156:159], v2, s[8:11], s44 offen offset:2048 sc1
    v_mfma_f32_32x32x16_bf16 v[64:79], v[160:163], v[144:147], v[64:79]
    buffer_load_dwordx4 v[160:163], v2, s[8:11], s44 offen offset:3072 sc1
    v_mfma_f32_32x32x16_bf16 v[80:95], v[164:167], v[144:147], v[80:95]
    buffer_load_dwordx4 v[164:167], v3, s[8:11], s44 offen sc1
    buffer_load_dwordx4 v[144:147], v2, s[8:11], s43 offen sc1
    s_add_u32 s43, s43, 1024
    s_add_u32 s44, s44, 20480
    s_waitcnt vmcnt(12)
    v_mfma_f32_32x32x16_bf16 v[16:31], v[100:103], v[96:99], v[16:31]
    buffer_load_dwordx4 v[100:103], v2, s[8:11], s44 offen offset:0 sc1
    v_mfma_f32_32x32x16_bf16 v[32:47], v[104:107], v[96:99], v[32:47]
    buffer_load_dwordx4 v[104:107], v2, s[8:11], s44 offen offset:1024 sc1
    v_mfma_f32_32x32x16_bf16 v[48:63], v[108:111], v[96:99], v[48:63]
    buffer_load_dwordx4 v[108:111], v2, s[8:11], s44 offen offset:2048 sc1
    v_mfma_f32_32x32x16_bf16 v[64:79], v[112:115], v[96:99], v[64:79]
    buffer_load_dwordx4 v[112:115], v2, s[8:11], s44 offen offset:3072 sc1
    v_mfma_f32_32x32x16_bf16 v[80:95], v[116:119], v[96:99], v[80:95]
    buffer_load_dwordx4 v[116:119], v3, s[8:11], s44 offen sc1
    buffer_load_dwordx4 v[96:99], v2, s[8:11], s43 offen sc1
    s_add_u32 s43, s43, 1024
    s_add_u32 s44, s44, 20480
    s_barrier
    s_add_u32 m0, s18, 0
    s_add_u32 s17, s46, 6
    s_and_b32 s17, s17, 7
    s_mul_i32 s17, s17, 327680
    s_add_u32 s17, s17, 0
    buffer_load_dwordx4 v4, s[8:11], s17 offen sc1 lds
    s_mov_b64 exec, s[20:21]
    buffer_load_dwordx4 v5, s[8:11], s17 offen offset:1024 sc1 lds
    s_mov_b64 exec, s[22:23]
    buffer_load_dwordx4 v6, s[8:11], s17 offen offset:2048 sc1 lds
    s_mov_b64 exec, -1
    s_add_u32 m0, s18, 2688
    s_add_u32 s17, s46, 6
    s_and_b32 s17, s17, 7
    s_mul_i32 s17, s17, 327680
    s_add_u32 s17, s17, 40960
    buffer_load_dwordx4 v4, s[8:11], s17 offen sc1 lds
    s_mov_b64 exec, s[20:21]
    buffer_load_dwordx4 v5, s[8:11], s17 offen offset:1024 sc1 lds
    s_mov_b64 exec, s[22:23]
    buffer_load_dwordx4 v6, s[8:11], s17 offen offset:2048 sc1 lds
    s_mov_b64 exec, -1
    s_waitcnt vmcnt(18)
    v_mfma_f32_32x32x16_bf16 v[16:31], v[124:127], v[120:123], v[16:31]
    buffer_load_dwordx4 v[124:127], v2, s[8:11], s44 offen offset:0 sc1
    v_mfma_f32_32x32x16_bf16 v[32:47], v[128:131], v[120:123], v[32:47]
    buffer_load_dwordx4 v[128:131], v2, s[8:11], s44 offen offset:1024 sc1
    v_mfma_f32_32x32x16_bf16 v[48:63], v[132:135], v[120:123], v[48:63]
    buffer_load_dwordx4 v[132:135], v2, s[8:11], s44 offen offset:2048 sc1
    v_mfma_f32_32x32x16_bf16 v[64:79], v[136:139], v[120:123], v[64:79]
    buffer_load_dwordx4 v[136:139], v2, s[8:11], s44 offen offset:3072 sc1
    v_mfma_f32_32x32x16_bf16 v[80:95], v[140:143], v[120:123], v[80:95]
    buffer_load_dwordx4 v[140:143], v3, s[8:11], s44 offen sc1
    buffer_load_dwordx4 v[120:123], v2, s[8:11], s43 offen sc1
    s_add_u32 s43, s43, 1024
    s_add_u32 s44, s44, 20480
    s_waitcnt vmcnt(18)
    v_mfma_f32_32x32x16_bf16 v[16:31], v[148:151], v[144:147], v[16:31]
    buffer_load_dwordx4 v[148:151], v2, s[8:11], s44 offen offset:0 sc1
    v_mfma_f32_32x32x16_bf16 v[32:47], v[152:155], v[144:147], v[32:47]
    buffer_load_dwordx4 v[152:155], v2, s[8:11], s44 offen offset:1024 sc1
    v_mfma_f32_32x32x16_bf16 v[48:63], v[156:159], v[144:147], v[48:63]
    buffer_load_dwordx4 v[156:159], v2, s[8:11], s44 offen offset:2048 sc1
    v_mfma_f32_32x32x16_bf16 v[64:79], v[160:163], v[144:147], v[64:79]
    buffer_load_dwordx4 v[160:163], v2, s[8:11], s44 offen offset:3072 sc1
    v_mfma_f32_32x32x16_bf16 v[80:95], v[164:167], v[144:147], v[80:95]
    buffer_load_dwordx4 v[164:167], v3, s[8:11], s44 offen sc1
    buffer_load_dwordx4 v[144:147], v2, s[8:11], s43 offen sc1
    s_add_u32 s43, s43, 1024
    s_add_u32 s44, s44, 20480
    s_waitcnt vmcnt(18)
    v_mfma_f32_32x32x16_bf16 v[16:31], v[100:103], v[96:99], v[16:31]
    buffer_load_dwordx4 v[100:103], v2, s[8:11], s44 offen offset:0 sc1
    v_mfma_f32_32x32x16_bf16 v[32:47], v[104:107], v[96:99], v[32:47]
    buffer_load_dwordx4 v[104:107], v2, s[8:11], s44 offen offset:1024 sc1
    v_mfma_f32_32x32x16_bf16 v[48:63], v[108:111], v[96:99], v[48:63]
    buffer_load_dwordx4 v[108:111], v2, s[8:11], s44 offen offset:2048 sc1
    v_mfma_f32_32x32x16_bf16 v[64:79], v[112:115], v[96:99], v[64:79]
    buffer_load_dwordx4 v[112:115], v2, s[8:11], s44 offen offset:3072 sc1
    v_mfma_f32_32x32x16_bf16 v[80:95], v[116:119], v[96:99], v[80:95]
    buffer_load_dwordx4 v[116:119], v3, s[8:11], s44 offen sc1
    buffer_load_dwordx4 v[96:99], v2, s[8:11], s43 offen sc1
    s_add_u32 s43, s43, 1024
    s_add_u32 s44, s44, 20480
    s_waitcnt vmcnt(12)
    v_mfma_f32_32x32x16_bf16 v[16:31], v[124:127], v[120:123], v[16:31]
    buffer_load_dwordx4 v[124:127], v2, s[8:11], s44 offen offset:0 sc1
    v_mfma_f32_32x32x16_bf16 v[32:47], v[128:131], v[120:123], v[32:47]
    buffer_load_dwordx4 v[128:131], v2, s[8:11], s44 offen offset:1024 sc1
    v_mfma_f32_32x32x16_bf16 v[48:63], v[132:135], v[120:123], v[48:63]
    buffer_load_dwordx4 v[132:135], v2, s[8:11], s44 offen offset:2048 sc1
    v_mfma_f32_32x32x16_bf16 v[64:79], v[136:139], v[120:123], v[64:79]
    buffer_load_dwordx4 v[136:139], v2, s[8:11], s44 offen offset:3072 sc1
    v_mfma_f32_32x32x16_bf16 v[80:95], v[140:143], v[120:123], v[80:95]
    buffer_load_dwordx4 v[140:143], v3, s[8:11], s44 offen sc1
    buffer_load_dwordx4 v[120:123], v2, s[8:11], s43 offen sc1
    s_add_u32 s43, s43, 1024
    s_add_u32 s44, s44, 20480
    s_barrier
    s_add_u32 m0, s18, 21504
    s_add_u32 s17, s46, 7
    s_and_b32 s17, s17, 7
    s_mul_i32 s17, s17, 327680
    s_add_u32 s17, s17, 0
    buffer_load_dwordx4 v4, s[8:11], s17 offen sc1 lds
    s_mov_b64 exec, s[20:21]
    buffer_load_dwordx4 v5, s[8:11], s17 offen offset:1024 sc1 lds
    s_mov_b64 exec, s[22:23]
    buffer_load_dwordx4 v6, s[8:11], s17 offen offset:2048 sc1 lds
    s_mov_b64 exec, -1
    s_add_u32 m0, s18, 24192
    s_add_u32 s17, s46, 7
    s_and_b32 s17, s17, 7
    s_mul_i32 s17, s17, 327680
    s_add_u32 s17, s17, 40960
    buffer_load_dwordx4 v4, s[8:11], s17 offen sc1 lds
    s_mov_b64 exec, s[20:21]
    buffer_load_dwordx4 v5, s[8:11], s17 offen offset:1024 sc1 lds
    s_mov_b64 exec, s[22:23]
    buffer_load_dwordx4 v6, s[8:11], s17 offen offset:2048 sc1 lds
    s_mov_b64 exec, -1
    s_waitcnt vmcnt(18)
    v_mfma_f32_32x32x16_bf16 v[16:31], v[148:151], v[144:147], v[16:31]
    buffer_load_dwordx4 v[148:151], v2, s[8:11], s44 offen offset:0 sc1
    v_mfma_f32_32x32x16_bf16 v[32:47], v[152:155], v[144:147], v[32:47]
    buffer_load_dwordx4 v[152:155], v2, s[8:11], s44 offen offset:1024 sc1
    v_mfma_f32_32x32x16_bf16 v[48:63], v[156:159], v[144:147], v[48:63]
    buffer_load_dwordx4 v[156:159], v2, s[8:11], s44 offen offset:2048 sc1
    v_mfma_f32_32x32x16_bf16 v[64:79], v[160:163], v[144:147], v[64:79]
    buffer_load_dwordx4 v[160:163], v2, s[8:11], s44 offen offset:3072 sc1
    v_mfma_f32_32x32x16_bf16 v[80:95], v[164:167], v[144:147], v[80:95]
    buffer_load_dwordx4 v[164:167], v3, s[8:11], s44 offen sc1
    buffer_load_dwordx4 v[144:147], v2, s[8:11], s43 offen sc1
    s_add_u32 s43, s43, 1024
    s_add_u32 s44, s44, 20480
    s_waitcnt vmcnt(18)
    v_mfma_f32_32x32x16_bf16 v[16:31], v[100:103], v[96:99], v[16:31]
    buffer_load_dwordx4 v[100:103], v2, s[8:11], s44 offen offset:0 sc1
    v_mfma_f32_32x32x16_bf16 v[32:47], v[104:107], v[96:99], v[32:47]
    buffer_load_dwordx4 v[104:107], v2, s[8:11], s44 offen offset:1024 sc1
    v_mfma_f32_32x32x16_bf16 v[48:63], v[108:111], v[96:99], v[48:63]
    buffer_load_dwordx4 v[108:111], v2, s[8:11], s44 offen offset:2048 sc1
    v_mfma_f32_32x32x16_bf16 v[64:79], v[112:115], v[96:99], v[64:79]
    buffer_load_dwordx4 v[112:115], v2, s[8:11], s44 offen offset:3072 sc1
    v_mfma_f32_32x32x16_bf16 v[80:95], v[116:119], v[96:99], v[80:95]
    buffer_load_dwordx4 v[116:119], v3, s[8:11], s44 offen sc1
    buffer_load_dwordx4 v[96:99], v2, s[8:11], s43 offen sc1
    s_add_u32 s43, s43, 1024
    s_add_u32 s44, s44, 20480
    s_waitcnt vmcnt(18)
    v_mfma_f32_32x32x16_bf16 v[16:31], v[124:127], v[120:123], v[16:31]
    buffer_load_dwordx4 v[124:127], v2, s[8:11], s44 offen offset:0 sc1
    v_mfma_f32_32x32x16_bf16 v[32:47], v[128:131], v[120:123], v[32:47]
    buffer_load_dwordx4 v[128:131], v2, s[8:11], s44 offen offset:1024 sc1
    v_mfma_f32_32x32x16_bf16 v[48:63], v[132:135], v[120:123], v[48:63]
    buffer_load_dwordx4 v[132:135], v2, s[8:11], s44 offen offset:2048 sc1
    v_mfma_f32_32x32x16_bf16 v[64:79], v[136:139], v[120:123], v[64:79]
    buffer_load_dwordx4 v[136:139], v2, s[8:11], s44 offen offset:3072 sc1
    v_mfma_f32_32x32x16_bf16 v[80:95], v[140:143], v[120:123], v[80:95]
    buffer_load_dwordx4 v[140:143], v3, s[8:11], s44 offen sc1
    buffer_load_dwordx4 v[120:123], v2, s[8:11], s43 offen sc1
    s_add_u32 s43, s43, 1024
    s_add_u32 s44, s44, 20480
    s_waitcnt vmcnt(18)
    s_barrier
    s_waitcnt vmcnt(12)
    v_mfma_f32_32x32x16_bf16 v[16:31], v[148:151], v[144:147], v[16:31]
    buffer_load_dwordx4 v[148:151], v2, s[8:11], s44 offen offset:0 sc1
    v_mfma_f32_32x32x16_bf16 v[32:47], v[152:155], v[144:147], v[32:47]
    buffer_load_dwordx4 v[152:155], v2, s[8:11], s44 offen offset:1024 sc1
    v_mfma_f32_32x32x16_bf16 v[48:63], v[156:159], v[144:147], v[48:63]
    buffer_load_dwordx4 v[156:159], v2, s[8:11], s44 offen offset:2048 sc1
    v_mfma_f32_32x32x16_bf16 v[64:79], v[160:163], v[144:147], v[64:79]
    buffer_load_dwordx4 v[160:163], v2, s[8:11], s44 offen offset:3072 sc1
    v_mfma_f32_32x32x16_bf16 v[80:95], v[164:167], v[144:147], v[80:95]
    buffer_load_dwordx4 v[164:167], v3, s[8:11], s44 offen sc1
    buffer_load_dwordx4 v[144:147], v2, s[8:11], s43 offen sc1
    s_add_u32 s43, s43, 1024
    s_add_u32 s44, s44, 20480
    s_waitcnt vmcnt(12)
    v_mfma_f32_32x32x16_bf16 v[16:31], v[100:103], v[96:99], v[16:31]
    buffer_load_dwordx4 v[100:103], v2, s[8:11], s44 offen offset:0 sc1
    v_mfma_f32_32x32x16_bf16 v[32:47], v[104:107], v[96:99], v[32:47]
    buffer_load_dwordx4 v[104:107], v2, s[8:11], s44 offen offset:1024 sc1
    v_mfma_f32_32x32x16_bf16 v[48:63], v[108:111], v[96:99], v[48:63]
    buffer_load_dwordx4 v[108:111], v2, s[8:11], s44 offen offset:2048 sc1
    v_mfma_f32_32x32x16_bf16 v[64:79], v[112:115], v[96:99], v[64:79]
    buffer_load_dwordx4 v[112:115], v2, s[8:11], s44 offen offset:3072 sc1
    v_mfma_f32_32x32x16_bf16 v[80:95], v[116:119], v[96:99], v[80:95]
    buffer_load_dwordx4 v[116:119], v3, s[8:11], s44 offen sc1
    buffer_load_dwordx4 v[96:99], v2, s[8:11], s43 offen sc1
    s_add_u32 s43, s43, 1024
    s_add_u32 s44, s44, 20480
    s_waitcnt vmcnt(12)
    v_mfma_f32_32x32x16_bf16 v[16:31], v[124:127], v[120:123], v[16:31]
    buffer_load_dwordx4 v[124:127], v2, s[8:11], s44 offen offset:0 sc1
    v_mfma_f32_32x32x16_bf16 v[32:47], v[128:131], v[120:123], v[32:47]
    buffer_load_dwordx4 v[128:131], v2, s[8:11], s44 offen offset:1024 sc1
    v_mfma_f32_32x32x16_bf16 v[48:63], v[132:135], v[120:123], v[48:63]
    buffer_load_dwordx4 v[132:135], v2, s[8:11], s44 offen offset:2048 sc1
    v_mfma_f32_32x32x16_bf16 v[64:79], v[136:139], v[120:123], v[64:79]
    buffer_load_dwordx4 v[136:139], v2, s[8:11], s44 offen offset:3072 sc1
    v_mfma_f32_32x32x16_bf16 v[80:95], v[140:143], v[120:123], v[80:95]
    buffer_load_dwordx4 v[140:143], v3, s[8:11], s44 offen sc1
    buffer_load_dwordx4 v[120:123], v2, s[8:11], s43 offen sc1
    s_add_u32 s43, s43, 1024
    s_add_u32 s44, s44, 20480
    s_barrier
    s_barrier
    s_waitcnt vmcnt(12)
    v_mfma_f32_32x32x16_bf16 v[16:31], v[148:151], v[144:147], v[16:31]
    buffer_load_dwordx4 v[148:151], v2, s[8:11], s44 offen offset:0 sc1
    v_mfma_f32_32x32x16_bf16 v[32:47], v[152:155], v[144:147], v[32:47]
    buffer_load_dwordx4 v[152:155], v2, s[8:11], s44 offen offset:1024 sc1
    v_mfma_f32_32x32x16_bf16 v[48:63], v[156:159], v[144:147], v[48:63]
    buffer_load_dwordx4 v[156:159], v2, s[8:11], s44 offen offset:2048 sc1
    v_mfma_f32_32x32x16_bf16 v[64:79], v[160:163], v[144:147], v[64:79]
    buffer_load_dwordx4 v[160:163], v2, s[8:11], s44 offen offset:3072 sc1
    v_mfma_f32_32x32x16_bf16 v[80:95], v[164:167], v[144:147], v[80:95]
    buffer_load_dwordx4 v[164:167], v3, s[8:11], s44 offen sc1
    buffer_load_dwordx4 v[144:147], v2, s[8:11], s43 offen sc1
    s_add_u32 s43, s43, 1024
    s_add_u32 s44, s44, 20480
    s_waitcnt vmcnt(12)
    v_mfma_f32_32x32x16_bf16 v[16:31], v[100:103], v[96:99], v[16:31]
    buffer_load_dwordx4 v[100:103], v2, s[8:11], s44 offen offset:0 sc1
    v_mfma_f32_32x32x16_bf16 v[32:47], v[104:107], v[96:99], v[32:47]
    buffer_load_dwordx4 v[104:107], v2, s[8:11], s44 offen offset:1024 sc1
    v_mfma_f32_32x32x16_bf16 v[48:63], v[108:111], v[96:99], v[48:63]
    buffer_load_dwordx4 v[108:111], v2, s[8:11], s44 offen offset:2048 sc1
    v_mfma_f32_32x32x16_bf16 v[64:79], v[112:115], v[96:99], v[64:79]
    buffer_load_dwordx4 v[112:115], v2, s[8:11], s44 offen offset:3072 sc1
    v_mfma_f32_32x32x16_bf16 v[80:95], v[116:119], v[96:99], v[80:95]
    buffer_load_dwordx4 v[116:119], v3, s[8:11], s44 offen sc1
    buffer_load_dwordx4 v[96:99], v2, s[8:11], s43 offen sc1
    s_add_u32 s43, s43, 1024
    s_add_u32 s44, s44, 20480
    s_waitcnt vmcnt(12)
    v_mfma_f32_32x32x16_bf16 v[16:31], v[124:127], v[120:123], v[16:31]
    buffer_load_dwordx4 v[124:127], v2, s[8:11], s44 offen offset:0 sc1
    v_mfma_f32_32x32x16_bf16 v[32:47], v[128:131], v[120:123], v[32:47]
    buffer_load_dwordx4 v[128:131], v2, s[8:11], s44 offen offset:1024 sc1
    v_mfma_f32_32x32x16_bf16 v[48:63], v[132:135], v[120:123], v[48:63]
    buffer_load_dwordx4 v[132:135], v2, s[8:11], s44 offen offset:2048 sc1
    v_mfma_f32_32x32x16_bf16 v[64:79], v[136:139], v[120:123], v[64:79]
    buffer_load_dwordx4 v[136:139], v2, s[8:11], s44 offen offset:3072 sc1
    v_mfma_f32_32x32x16_bf16 v[80:95], v[140:143], v[120:123], v[80:95]
    buffer_load_dwordx4 v[140:143], v3, s[8:11], s44 offen sc1
    buffer_load_dwordx4 v[120:123], v2, s[8:11], s43 offen sc1
    s_add_u32 s43, s43, 1024
    s_add_u32 s44, s44, 20480
    s_waitcnt vmcnt(12)
    v_mfma_f32_32x32x16_bf16 v[16:31], v[148:151], v[144:147], v[16:31]
    buffer_load_dwordx4 v[148:151], v2, s[8:11], s44 offen offset:0 sc1
    v_mfma_f32_32x32x16_bf16 v[32:47], v[152:155], v[144:147], v[32:47]
    buffer_load_dwordx4 v[152:155], v2, s[8:11], s44 offen offset:1024 sc1
    v_mfma_f32_32x32x16_bf16 v[48:63], v[156:159], v[144:147], v[48:63]
    buffer_load_dwordx4 v[156:159], v2, s[8:11], s44 offen offset:2048 sc1
    v_mfma_f32_32x32x16_bf16 v[64:79], v[160:163], v[144:147], v[64:79]
    buffer_load_dwordx4 v[160:163], v2, s[8:11], s44 offen offset:3072 sc1
    v_mfma_f32_32x32x16_bf16 v[80:95], v[164:167], v[144:147], v[80:95]
    buffer_load_dwordx4 v[164:167], v3, s[8:11], s44 offen sc1
    buffer_load_dwordx4 v[144:147], v2, s[8:11], s43 offen sc1
    s_add_u32 s43, s43, 1024
    s_add_u32 s44, s44, 20480
    s_waitcnt vmcnt(12)
    v_mfma_f32_32x32x16_bf16 v[16:31], v[100:103], v[96:99], v[16:31]
    v_mfma_f32_32x32x16_bf16 v[32:47], v[104:107], v[96:99], v[32:47]
    v_mfma_f32_32x32x16_bf16 v[48:63], v[108:111], v[96:99], v[48:63]
    v_mfma_f32_32x32x16_bf16 v[64:79], v[112:115], v[96:99], v[64:79]
    v_mfma_f32_32x32x16_bf16 v[80:95], v[116:119], v[96:99], v[80:95]
    s_mul_i32 s44, s42, 5120
    s_add_u32 s44, s44, 25018368
    s_add_u32 s44, s44, 4096
    s_mul_i32 s43, s45, 40960
    s_add_u32 s43, s43, s44
    s_add_u32 s43, s43, 655360
    s_mul_i32 s33, s45, 163840
    s_add_u32 s44, s44, s33
    buffer_load_dwordx4 v[96:99], v2, s[8:11], s44 offen sc1
    s_add_u32 s44, s44, 20480
    buffer_load_dwordx4 v[100:103], v2, s[8:11], s44 offen sc1
    s_add_u32 s44, s44, 20480
    buffer_load_dwordx4 v[104:107], v2, s[8:11], s44 offen sc1
    s_add_u32 s44, s44, 20480
    buffer_load_dwordx4 v[108:111], v2, s[8:11], s44 offen sc1
    s_add_u32 s44, s44, 20480
    s_waitcnt vmcnt(10)
    v_mfma_f32_32x32x16_bf16 v[16:31], v[124:127], v[120:123], v[16:31]
    v_mfma_f32_32x32x16_bf16 v[32:47], v[128:131], v[120:123], v[32:47]
    v_mfma_f32_32x32x16_bf16 v[48:63], v[132:135], v[120:123], v[48:63]
    v_mfma_f32_32x32x16_bf16 v[64:79], v[136:139], v[120:123], v[64:79]
    v_mfma_f32_32x32x16_bf16 v[80:95], v[140:143], v[120:123], v[80:95]
    buffer_load_dwordx4 v[120:123], v2, s[8:11], s44 offen sc1
    s_add_u32 s44, s44, 20480
    buffer_load_dwordx4 v[124:127], v2, s[8:11], s44 offen sc1
    s_add_u32 s44, s44, 20480
    buffer_load_dwordx4 v[128:131], v2, s[8:11], s44 offen sc1
    s_add_u32 s44, s44, 20480
    buffer_load_dwordx4 v[132:135], v2, s[8:11], s44 offen sc1
    s_add_u32 s44, s44, 20480
    s_waitcnt vmcnt(8)
    v_mfma_f32_32x32x16_bf16 v[16:31], v[148:151], v[144:147], v[16:31]
    v_mfma_f32_32x32x16_bf16 v[32:47], v[152:155], v[144:147], v[32:47]
    v_mfma_f32_32x32x16_bf16 v[48:63], v[156:159], v[144:147], v[48:63]
    v_mfma_f32_32x32x16_bf16 v[64:79], v[160:163], v[144:147], v[64:79]
    v_mfma_f32_32x32x16_bf16 v[80:95], v[164:167], v[144:147], v[80:95]
    s_barrier
    s_mov_b32 s44, s43
    buffer_load_dwordx4 v[144:147], v2, s[8:11], s44 offen sc1
    s_add_u32 s44, s44, 20480
    buffer_load_dwordx4 v[148:151], v2, s[8:11], s44 offen sc1
    s_add_u32 s44, s44, 20480
    s_mov_b32 s36, s48
    s_mov_b32 s37, s49
    s_mov_b32 s38, 2621440
    s_mov_b32 s39, 0x00020000
    s_lshl_b32 s30, s12, 6
    v_add_u32 v164, s30, v1
    v_mul_u32_u24 v166, 3277, v164
    v_lshrrev_b32 v166, 16, v166
    v_mul_u32_u24 v165, 20, v166
    v_sub_u32 v164, v164, v165
    v_mul_u32_u24 v165, 1280, v166
    v_lshl_add_u32 v165, v164, 4, v165
    v_mul_u32_u24 v164, 1040, v164
    v_lshl_add_u32 v164, v166, 4, v164
    v_add_u32 v164, 64512, v164
    s_mul_i32 s17, s41, 40960
    s_mul_i32 s31, s42, 320
    s_add_u32 s17, s17, s31
    buffer_load_dwordx4 v[160:163], v165, s[36:39], s17 offen
    v_lshlrev_b32 v166, 4, v1
    s_mul_i32 s32, s45, 20800
    s_add_u32 s32, s32, 64512
    v_add_u32 v166, s32, v166
    ds_write_b128 v166, v[16:19] offset:0
    ds_write_b128 v166, v[20:23] offset:1040
    ds_write_b128 v166, v[24:27] offset:2080
    ds_write_b128 v166, v[28:31] offset:3120
    ds_write_b128 v166, v[32:35] offset:4160
    ds_write_b128 v166, v[36:39] offset:5200
    ds_write_b128 v166, v[40:43] offset:6240
    ds_write_b128 v166, v[44:47] offset:7280
    ds_write_b128 v166, v[48:51] offset:8320
    ds_write_b128 v166, v[52:55] offset:9360
    ds_write_b128 v166, v[56:59] offset:10400
    ds_write_b128 v166, v[60:63] offset:11440
    ds_write_b128 v166, v[64:67] offset:12480
    ds_write_b128 v166, v[68:71] offset:13520
    ds_write_b128 v166, v[72:75] offset:14560
    ds_write_b128 v166, v[76:79] offset:15600
    v_lshlrev_b32 v3, 4, v1
    s_lshl_b32 s30, s45, 13
    v_add_u32 v167, s30, v3
    s_lshl_b32 s30, s45, 11
    s_add_u32 s30, s30, 32768
    v_lshrrev_b32 v3, 1, v3
    v_add_u32 v3, s30, v3
    s_setprio 3
    s_waitcnt vmcnt(0) lgkmcnt(0)
    s_barrier
    ds_read_b128 v[16:19], v167 offset:0
    ds_read_b128 v[20:23], v167 offset:1024
    ds_read_b128 v[24:27], v167 offset:2048
    ds_read_b128 v[28:31], v167 offset:3072
    ds_read_b128 v[32:35], v167 offset:4096
    ds_read_b128 v[36:39], v167 offset:5120
    ds_read_b128 v[40:43], v167 offset:6144
    ds_read_b128 v[44:47], v167 offset:7168
    ds_read2_b64 v[48:51], v3 offset0:0 offset1:64
    ds_read2_b64 v[52:55], v3 offset0:128 offset1:192
    s_waitcnt lgkmcnt(9)
    v_mfma_f32_32x32x16_bf16 v[80:95], v[96:99], v[16:19], v[80:95]
    s_waitcnt lgkmcnt(8)
    v_mfma_f32_32x32x16_bf16 v[80:95], v[100:103], v[20:23], v[80:95]
    s_waitcnt lgkmcnt(7)
    v_mfma_f32_32x32x16_bf16 v[80:95], v[104:107], v[24:27], v[80:95]
    s_waitcnt lgkmcnt(6)
    v_mfma_f32_32x32x16_bf16 v[80:95], v[108:111], v[28:31], v[80:95]
    s_waitcnt lgkmcnt(5)
    v_mfma_f32_32x32x16_bf16 v[80:95], v[120:123], v[32:35], v[80:95]
    s_waitcnt lgkmcnt(4)
    v_mfma_f32_32x32x16_bf16 v[80:95], v[124:127], v[36:39], v[80:95]
    s_waitcnt lgkmcnt(3)
    v_mfma_f32_32x32x16_bf16 v[80:95], v[128:131], v[40:43], v[80:95]
    s_waitcnt lgkmcnt(2)
    v_mfma_f32_32x32x16_bf16 v[80:95], v[132:135], v[44:47], v[80:95]
    s_waitcnt lgkmcnt(1)
    v_mfma_f32_32x32x16_bf16 v[80:95], v[144:147], v[48:51], v[80:95]
    s_waitcnt lgkmcnt(0)
    v_mfma_f32_32x32x16_bf16 v[80:95], v[148:151], v[52:55], v[80:95]
    s_nop 11
    ds_write_b128 v166, v[80:83] offset:16640
    ds_write_b128 v166, v[84:87] offset:17680
    ds_write_b128 v166, v[88:91] offset:18720
    ds_write_b128 v166, v[92:95] offset:19760
    s_waitcnt lgkmcnt(0)
    s_barrier
    s_cmp_ge_u32 s12, 10
    s_cbranch_scc1 L_f_end_3
    ds_read_b128 v[96:99], v164 offset:0
    ds_read_b128 v[100:103], v164 offset:512
    ds_read_b128 v[104:107], v164 offset:20800
    ds_read_b128 v[108:111], v164 offset:21312
    ds_read_b128 v[112:115], v164 offset:41600
    ds_read_b128 v[116:119], v164 offset:42112
    ds_read_b128 v[120:123], v164 offset:62400
    ds_read_b128 v[124:127], v164 offset:62912
    s_mov_b32 s36, s54
    s_mov_b32 s37, s55
    v_lshlrev_b32 v128, 16, v160
    v_and_b32 v129, 0xffff0000, v160
    v_lshlrev_b32 v130, 16, v161
    v_and_b32 v131, 0xffff0000, v161
    v_lshlrev_b32 v132, 16, v162
    v_and_b32 v133, 0xffff0000, v162
    v_lshlrev_b32 v134, 16, v163
    v_and_b32 v135, 0xffff0000, v163
    s_waitcnt lgkmcnt(6)
    v_pk_add_f32 v[128:129], v[128:129], v[96:97]
    v_pk_add_f32 v[130:131], v[130:131], v[98:99]
    v_pk_add_f32 v[132:133], v[132:133], v[100:101]
    v_pk_add_f32 v[134:135], v[134:135], v[102:103]
    s_waitcnt lgkmcnt(4)
    v_pk_add_f32 v[128:129], v[128:129], v[104:105]
    v_pk_add_f32 v[130:131], v[130:131], v[106:107]
    v_pk_add_f32 v[132:133], v[132:133], v[108:109]
    v_pk_add_f32 v[134:135], v[134:135], v[110:111]
    s_waitcnt lgkmcnt(2)
    v_pk_add_f32 v[128:129], v[128:129], v[112:113]
    v_pk_add_f32 v[130:131], v[130:131], v[114:115]
    v_pk_add_f32 v[132:133], v[132:133], v[116:117]
    v_pk_add_f32 v[134:135], v[134:135], v[118:119]
    s_waitcnt lgkmcnt(0)
    v_pk_add_f32 v[128:129], v[128:129], v[120:121]
    v_pk_add_f32 v[130:131], v[130:131], v[122:123]
    v_pk_add_f32 v[132:133], v[132:133], v[124:125]
    v_pk_add_f32 v[134:135], v[134:135], v[126:127]
    v_cvt_pk_bf16_f32 v96, v128, v129
    v_cvt_pk_bf16_f32 v97, v130, v131
    v_cvt_pk_bf16_f32 v98, v132, v133
    v_cvt_pk_bf16_f32 v99, v134, v135
    buffer_store_dwordx4 v[96:99], v165, s[36:39], s17 offen sc1
    s_branch L_f_end_3
L_f_end_3:
L_f_exit_1:
    s_endpgm
L_code_end:
.section .rodata,"a"
.p2align 6
.amdhsa_kernel parallel_sum__softmax_full_mha__dense_activation_silu__prompt_kernel
  .amdhsa_next_free_vgpr 168
  .amdhsa_next_free_sgpr 100
  .amdhsa_accum_offset 168
  .amdhsa_group_segment_fixed_size 0
  .amdhsa_kernarg_size 72
  .amdhsa_user_sgpr_count 2
  .amdhsa_user_sgpr_kernarg_segment_ptr 1
  .amdhsa_system_sgpr_workgroup_id_x 1
  .amdhsa_float_denorm_mode_32 3
.end_amdhsa_kernel
```
